```python
import torch

def _softmax(x, axis=-1):
    return torch.softmax(x, dim=axis)
def _gelu(x):
    return torch.nn.functional.gelu(x, approximate="tanh")
def _silu(x):
    return torch.nn.functional.silu(x)
def _sigmoid(x):
    return torch.sigmoid(x)
def _layernorm(x, axis=-1, eps=1e-5):
    m = x.mean(dim=axis, keepdim=True)
    v = x.var(dim=axis, keepdim=True, unbiased=False)
    return (x - m) / torch.sqrt(v + eps)
def _scatter_add(tgt, idx, src, axis=0):
    return tgt.clone().index_add_(axis, idx, src)
def _segment_sum(src, seg, n):
    out = torch.zeros((n,) + src.shape[1:], dtype=src.dtype)
    return out.index_add_(0, seg, src)
def _pad(x, pw):
    flat = tuple(v for pair in reversed(pw) for v in pair)
    return torch.nn.functional.pad(x, flat)

kernel_name = 'concat_heads__sliding_block__softmax_full_mha__prompt'

def setup_inputs():

    _w = (lambda a: (lambda t: t.to(torch.bfloat16) if t.is_floating_point() else t)(torch.as_tensor(a)))
    def _A_setup():
        B, S, D = 1, 2048, 448
        return {
            "x": _w((lambda *s: torch.randn(*s, dtype=torch.bfloat16) * 0.2)(B, S, D)),
            "wqkv": _w((lambda *s: torch.randn(*s, dtype=torch.bfloat16) * 0.8)(D, 3 * D)),
            "wo": _w((lambda *s: torch.randn(*s, dtype=torch.bfloat16) * 3.2)(D, D)),
        }
    _A_in = _A_setup()

    def _B_setup():
        B, S, D = 1, 2048, 448
        return {
            "x": _w((lambda *s: torch.randn(*s, dtype=torch.bfloat16) * 0.2)(B, S, D)),
            "wqkv": _w((lambda *s: torch.randn(*s, dtype=torch.bfloat16) * 0.8)(D, 3 * D)),
            "wo": _w((lambda *s: torch.randn(*s, dtype=torch.bfloat16) * 3.2)(D, D)),
        }
    _B_in = _B_setup()

    return {
        "A_x": _A_in["x"],
        "A_wqkv": _A_in["wqkv"],
        "A_wo": _A_in["wo"],
        "B_x": _B_in["x"],
        "B_wqkv": _B_in["wqkv"],
        "B_wo": _B_in["wo"],
    }

def reference(A_x, A_wqkv, A_wo, B_x, B_wqkv, B_wo):
    def _A_ref(x, wqkv, wo):
        B, S, D = x.shape
        H = 16; Dh = D // H; W = 256
        qkv = (lambda x, *d: x.permute(*d))((x @ wqkv).reshape(B, S, 3, H, Dh), 2, 0, 3, 1, 4)
        q, k, v = qkv[0], qkv[1], qkv[2]
        scores = torch.einsum("bhqd,bhkd->bhqk", q, k) * (Dh ** -0.5)
        idx = torch.arange(S)
        mask = (idx[:, None] - idx[None, :] >= 0) & (idx[:, None] - idx[None, :] < W)
        scores = torch.where(mask[None, None], scores, -1e9)
        p = _softmax(scores, axis=-1)
        o = torch.einsum("bhqk,bhkd->bhqd", p, v)
        return (lambda x, *d: x.permute(*d))(o, 0, 2, 1, 3).reshape(B, S, D) @ wo

    def _B_ref(x, wqkv, wo):
        B, S, D = x.shape
        H = 16; Dh = D // H
        qkv = (lambda x, *d: x.permute(*d))((x @ wqkv).reshape(B, S, 3, H, Dh), 2, 0, 3, 1, 4)
        q, k, v = qkv[0], qkv[1], qkv[2]
        scale = Dh ** -0.5
        scores = torch.einsum("bhqd,bhkd->bhqk", q, k) * scale
        p = _softmax(scores, axis=-1)
        o = torch.einsum("bhqk,bhkd->bhqd", p, v)
        return (lambda x, *d: x.permute(*d))(o, 0, 2, 1, 3).reshape(B, S, D) @ wo

    a = _A_ref(A_x, A_wqkv, A_wo)
    b = _B_ref(B_x, B_wqkv, B_wo)
    return torch.concatenate([a, b], axis=-1)
```

```asm
; @launch grid=(256,1,1) block=(512,1,1) lds=163840
.amdgcn_target "amdgcn-amd-amdhsa--gfx950"
.text
.globl concat_heads__sliding_block__softmax_full_mha__prompt_kernel
.p2align 8
.type concat_heads__sliding_block__softmax_full_mha__prompt_kernel,@function
concat_heads__sliding_block__softmax_full_mha__prompt_kernel:
  s_cmp_ge_u32 s2, 256
  s_cbranch_scc1 Lexit
  s_load_dwordx16 s[4:19], s[0:1], 0
  s_load_dwordx2 s[20:21], s[0:1], 64
  v_lshrrev_b32 v1, 6, v0
  v_and_b32 v0, 63, v0
  s_nop 0
  v_readfirstlane_b32 s3, v1
  s_and_b32 s40, s2, 7
  s_lshr_b32 s41, s2, 3
  s_lshr_b32 s22, s40, 1
  s_lshl_b32 s22, s22, 2
  s_and_b32 s42, s41, 3
  s_add_u32 s22, s22, s42
  s_and_b32 s23, s40, 1
  s_lshl_b32 s23, s23, 3
  s_lshr_b32 s42, s41, 2
  s_add_u32 s23, s23, s42
  s_add_u32 s69, s23, 1
  s_and_b32 s69, s69, 7
  s_and_b32 s42, s23, 8
  s_or_b32 s69, s69, s42
  s_cmp_lt_u32 s3, 4
  s_cbranch_scc1 Lcompute
Lloader:
  s_sub_u32 s43, s3, 4
  s_lshl_b32 s44, s22, 7
  s_lshl_b32 s45, s43, 5
  s_add_u32 s44, s44, s45
  v_lshrrev_b32 v10, 3, v0
  v_add_u32 v10, s44, v10
  v_mul_u32_u24 v10, 896, v10
  v_lshrrev_b32 v11, 4, v0
  v_and_b32 v12, 7, v0
  v_xor_b32 v12, v12, v11
  v_lshl_add_u32 v2, v12, 4, v10
  v_xor_b32 v12, 4, v12
  v_lshl_add_u32 v3, v12, 4, v10
  v_add_u32 v3, 7168, v3
  v_add_u32 v4, 14336, v2
  v_add_u32 v5, 14336, v3
  s_lshl_b32 s46, s43, 12
  s_lshl_b32 s47, s43, 10
  s_add_u32 s47, s47, 65536
  s_lshl_b32 s44, s43, 6
  s_mul_i32 s50, s23, 168
  s_mul_i32 s51, s69, 168
  v_add_u32 v10, s44, v0
  v_mul_u32_u24 v11, 5958, v10
  v_lshrrev_b32 v11, 16, v11
  v_mul_u32_u24 v12, 11, v11
  v_sub_u32 v12, v10, v12
  v_and_b32 v13, 48, v11
  v_and_b32 v14, 3, v11
  v_lshl_add_u32 v13, v14, 2, v13
  v_bfe_u32 v14, v11, 2, 2
  v_add_u32 v13, v13, v14
  v_mul_u32_u24 v13, 2688, v13
  v_lshl_add_u32 v6, v12, 4, v13
  s_waitcnt lgkmcnt(0)
  s_mov_b32 s24, s10
  s_mov_b32 s25, s11
  s_mov_b32 s26, 1835008
  s_mov_b32 s27, 0x20000
  s_mov_b32 s28, s12
  s_mov_b32 s29, s13
  s_mov_b32 s30, 1204224
  s_mov_b32 s31, 0x20000
  s_add_u32 s52, s23, s22
  s_mul_i32 s53, s52, 37
  s_lshr_b32 s53, s53, 8
  s_mul_i32 s53, s53, 7
  s_sub_u32 s52, s52, s53
  s_lshl_b32 s48, s52, 7
  s_mul_i32 s49, s52, 172032
  s_add_u32 s49, s49, s50
  s_add_u32 s52, s52, 1
  s_cmp_eq_u32 s52, 7
  s_cselect_b32 s52, 0, s52
  s_add_u32 m0, s46, 0
  s_nop 0
  buffer_load_dwordx4 v2, s[24:27], s48 offen lds
  s_add_u32 m0, s46, 1024
  s_nop 0
  buffer_load_dwordx4 v3, s[24:27], s48 offen lds
  s_add_u32 m0, s46, 2048
  s_nop 0
  buffer_load_dwordx4 v4, s[24:27], s48 offen lds
  s_add_u32 m0, s46, 3072
  s_nop 0
  buffer_load_dwordx4 v5, s[24:27], s48 offen lds
  s_add_u32 m0, s47, 0
  s_nop 0
  buffer_load_dwordx4 v6, s[28:31], s49 offen lds
  v_add_u32 v10, s44, v0
  v_add_u32 v10, 256, v10
  v_mul_u32_u24 v11, 5958, v10
  v_lshrrev_b32 v11, 16, v11
  v_mul_u32_u24 v12, 11, v11
  v_sub_u32 v12, v10, v12
  v_and_b32 v13, 48, v11
  v_and_b32 v14, 3, v11
  v_lshl_add_u32 v13, v14, 2, v13
  v_bfe_u32 v14, v11, 2, 2
  v_add_u32 v13, v13, v14
  v_mul_u32_u24 v13, 2688, v13
  v_lshl_add_u32 v7, v12, 4, v13
  s_add_u32 m0, s47, 4096
  s_nop 0
  buffer_load_dwordx4 v7, s[28:31], s49 offen lds
  v_add_u32 v10, s44, v0
  v_add_u32 v10, 512, v10
  v_mul_u32_u24 v11, 5958, v10
  v_lshrrev_b32 v11, 16, v11
  v_mul_u32_u24 v12, 11, v11
  v_sub_u32 v12, v10, v12
  v_and_b32 v13, 48, v11
  v_and_b32 v14, 3, v11
  v_lshl_add_u32 v13, v14, 2, v13
  v_bfe_u32 v14, v11, 2, 2
  v_add_u32 v13, v13, v14
  v_mul_u32_u24 v13, 2688, v13
  v_lshl_add_u32 v8, v12, 4, v13
  s_cmp_eq_u32 s43, 3
  s_cbranch_scc1 Lqs_1
  s_add_u32 m0, s47, 8192
  s_nop 0
  buffer_load_dwordx4 v8, s[28:31], s49 offen lds
Lqs_1:
  s_mov_b32 s32, s4
  s_mov_b32 s33, s5
  s_mov_b32 s34, 1835008
  s_mov_b32 s35, 0x20000
  s_mov_b32 s36, s6
  s_mov_b32 s37, s7
  s_mov_b32 s38, 1204224
  s_mov_b32 s39, 0x20000
  s_add_u32 s64, s20, 16777216
  s_addc_u32 s65, s21, 0
  s_mov_b32 s66, 16384
  s_mov_b32 s67, 0x20000
  s_and_b32 s40, s2, 7
  s_bfe_u32 s41, s2, 0x10003
  s_lshl_b32 s40, s40, 1
  s_add_u32 s40, s40, s41
  v_min_u32 v30, 2, v0
  v_lshlrev_b32 v30, 4, v30
  v_add_u32 v30, s40, v30
  v_mul_u32_u24 v30, 43, v30
  v_lshrrev_b32 v30, 7, v30
  v_lshlrev_b32 v31, 8, v30
  v_add_u32 v203, 4096, v31
  s_lshl_b32 s48, s52, 7
  s_mul_i32 s49, s52, 172032
  s_add_u32 s49, s49, s50
  s_add_u32 s52, s52, 1
  s_cmp_eq_u32 s52, 7
  s_cselect_b32 s52, 0, s52
  s_add_u32 m0, s46, 16384
  s_nop 0
  buffer_load_dwordx4 v2, s[24:27], s48 offen lds
  s_add_u32 m0, s46, 17408
  s_nop 0
  buffer_load_dwordx4 v3, s[24:27], s48 offen lds
  s_add_u32 m0, s46, 18432
  s_nop 0
  buffer_load_dwordx4 v4, s[24:27], s48 offen lds
  s_add_u32 m0, s46, 19456
  s_nop 0
  buffer_load_dwordx4 v5, s[24:27], s48 offen lds
  s_add_u32 m0, s47, 11264
  s_nop 0
  buffer_load_dwordx4 v6, s[28:31], s49 offen lds
  s_add_u32 m0, s47, 15360
  s_nop 0
  buffer_load_dwordx4 v7, s[28:31], s49 offen lds
  s_cmp_eq_u32 s43, 3
  s_cbranch_scc1 Lqs_2
  s_add_u32 m0, s47, 19456
  s_nop 0
  buffer_load_dwordx4 v8, s[28:31], s49 offen lds
Lqs_2:
  s_lshl_b32 s48, s52, 7
  s_mul_i32 s49, s52, 172032
  s_add_u32 s49, s49, s50
  s_add_u32 s52, s52, 1
  s_cmp_eq_u32 s52, 7
  s_cselect_b32 s52, 0, s52
  s_add_u32 m0, s46, 32768
  s_nop 0
  buffer_load_dwordx4 v2, s[24:27], s48 offen lds
  s_add_u32 m0, s46, 33792
  s_nop 0
  buffer_load_dwordx4 v3, s[24:27], s48 offen lds
  s_add_u32 m0, s46, 34816
  s_nop 0
  buffer_load_dwordx4 v4, s[24:27], s48 offen lds
  s_add_u32 m0, s46, 35840
  s_nop 0
  buffer_load_dwordx4 v5, s[24:27], s48 offen lds
  s_add_u32 m0, s47, 22528
  s_nop 0
  buffer_load_dwordx4 v6, s[28:31], s49 offen lds
  s_add_u32 m0, s47, 26624
  s_nop 0
  buffer_load_dwordx4 v7, s[28:31], s49 offen lds
  s_cmp_eq_u32 s43, 3
  s_cbranch_scc1 Lqs_3
  s_add_u32 m0, s47, 30720
  s_nop 0
  buffer_load_dwordx4 v8, s[28:31], s49 offen lds
Lqs_3:
  s_waitcnt vmcnt(12)
  s_barrier
  s_lshl_b32 s48, s52, 7
  s_mul_i32 s49, s52, 172032
  s_add_u32 s49, s49, s50
  s_add_u32 s52, s52, 1
  s_cmp_eq_u32 s52, 7
  s_cselect_b32 s52, 0, s52
  s_add_u32 m0, s46, 49152
  s_nop 0
  buffer_load_dwordx4 v2, s[24:27], s48 offen lds
  s_add_u32 m0, s46, 50176
  s_nop 0
  buffer_load_dwordx4 v3, s[24:27], s48 offen lds
  s_add_u32 m0, s46, 51200
  s_nop 0
  buffer_load_dwordx4 v4, s[24:27], s48 offen lds
  s_add_u32 m0, s46, 52224
  s_nop 0
  buffer_load_dwordx4 v5, s[24:27], s48 offen lds
  s_add_u32 m0, s47, 33792
  s_nop 0
  buffer_load_dwordx4 v6, s[28:31], s49 offen lds
  s_add_u32 m0, s47, 37888
  s_nop 0
  buffer_load_dwordx4 v7, s[28:31], s49 offen lds
  s_cmp_eq_u32 s43, 3
  s_cbranch_scc1 Lqs_4
  s_add_u32 m0, s47, 41984
  s_nop 0
  buffer_load_dwordx4 v8, s[28:31], s49 offen lds
Lqs_4:
  s_waitcnt vmcnt(12)
  s_barrier
  s_lshl_b32 s48, s52, 7
  s_mul_i32 s49, s52, 172032
  s_add_u32 s49, s49, s50
  s_add_u32 s52, s52, 1
  s_cmp_eq_u32 s52, 7
  s_cselect_b32 s52, 0, s52
  s_add_u32 m0, s46, 0
  s_nop 0
  buffer_load_dwordx4 v2, s[24:27], s48 offen lds
  s_add_u32 m0, s46, 1024
  s_nop 0
  buffer_load_dwordx4 v3, s[24:27], s48 offen lds
  s_add_u32 m0, s46, 2048
  s_nop 0
  buffer_load_dwordx4 v4, s[24:27], s48 offen lds
  s_add_u32 m0, s46, 3072
  s_nop 0
  buffer_load_dwordx4 v5, s[24:27], s48 offen lds
  s_add_u32 m0, s47, 0
  s_nop 0
  buffer_load_dwordx4 v6, s[28:31], s49 offen lds
  s_add_u32 m0, s47, 4096
  s_nop 0
  buffer_load_dwordx4 v7, s[28:31], s49 offen lds
  s_cmp_eq_u32 s43, 3
  s_cbranch_scc1 Lqs_5
  s_add_u32 m0, s47, 8192
  s_nop 0
  buffer_load_dwordx4 v8, s[28:31], s49 offen lds
Lqs_5:
  s_waitcnt vmcnt(12)
  s_barrier
  s_lshl_b32 s48, s52, 7
  s_mul_i32 s49, s52, 172032
  s_add_u32 s49, s49, s50
  s_add_u32 s52, s52, 1
  s_cmp_eq_u32 s52, 7
  s_cselect_b32 s52, 0, s52
  s_add_u32 m0, s46, 16384
  s_nop 0
  buffer_load_dwordx4 v2, s[24:27], s48 offen lds
  s_add_u32 m0, s46, 17408
  s_nop 0
  buffer_load_dwordx4 v3, s[24:27], s48 offen lds
  s_add_u32 m0, s46, 18432
  s_nop 0
  buffer_load_dwordx4 v4, s[24:27], s48 offen lds
  s_add_u32 m0, s46, 19456
  s_nop 0
  buffer_load_dwordx4 v5, s[24:27], s48 offen lds
  s_add_u32 m0, s47, 11264
  s_nop 0
  buffer_load_dwordx4 v6, s[28:31], s49 offen lds
  s_add_u32 m0, s47, 15360
  s_nop 0
  buffer_load_dwordx4 v7, s[28:31], s49 offen lds
  s_cmp_eq_u32 s43, 3
  s_cbranch_scc1 Lqs_6
  s_add_u32 m0, s47, 19456
  s_nop 0
  buffer_load_dwordx4 v8, s[28:31], s49 offen lds
Lqs_6:
  s_waitcnt vmcnt(12)
  s_barrier
  s_lshl_b32 s48, s52, 7
  s_mul_i32 s49, s52, 172032
  s_add_u32 s49, s49, s50
  s_add_u32 s52, s52, 1
  s_cmp_eq_u32 s52, 7
  s_cselect_b32 s52, 0, s52
  s_add_u32 m0, s46, 32768
  s_nop 0
  buffer_load_dwordx4 v2, s[24:27], s48 offen lds
  s_add_u32 m0, s46, 33792
  s_nop 0
  buffer_load_dwordx4 v3, s[24:27], s48 offen lds
  s_add_u32 m0, s46, 34816
  s_nop 0
  buffer_load_dwordx4 v4, s[24:27], s48 offen lds
  s_add_u32 m0, s46, 35840
  s_nop 0
  buffer_load_dwordx4 v5, s[24:27], s48 offen lds
  s_add_u32 m0, s47, 22528
  s_nop 0
  buffer_load_dwordx4 v6, s[28:31], s49 offen lds
  s_add_u32 m0, s47, 26624
  s_nop 0
  buffer_load_dwordx4 v7, s[28:31], s49 offen lds
  s_cmp_eq_u32 s43, 3
  s_cbranch_scc1 Lqs_7
  s_add_u32 m0, s47, 30720
  s_nop 0
  buffer_load_dwordx4 v8, s[28:31], s49 offen lds
Lqs_7:
  s_waitcnt vmcnt(12)
  s_barrier
  s_add_u32 s52, s69, s22
  s_mul_i32 s53, s52, 37
  s_lshr_b32 s53, s53, 8
  s_mul_i32 s53, s53, 7
  s_sub_u32 s52, s52, s53
  s_lshl_b32 s48, s52, 7
  s_mul_i32 s49, s52, 172032
  s_add_u32 s49, s49, s51
  s_add_u32 s52, s52, 1
  s_cmp_eq_u32 s52, 7
  s_cselect_b32 s52, 0, s52
  s_add_u32 m0, s46, 49152
  s_nop 0
  buffer_load_dwordx4 v2, s[32:35], s48 offen lds
  s_add_u32 m0, s46, 50176
  s_nop 0
  buffer_load_dwordx4 v3, s[32:35], s48 offen lds
  s_add_u32 m0, s46, 51200
  s_nop 0
  buffer_load_dwordx4 v4, s[32:35], s48 offen lds
  s_add_u32 m0, s46, 52224
  s_nop 0
  buffer_load_dwordx4 v5, s[32:35], s48 offen lds
  s_add_u32 m0, s47, 33792
  s_nop 0
  buffer_load_dwordx4 v6, s[36:39], s49 offen lds
  s_add_u32 m0, s47, 37888
  s_nop 0
  buffer_load_dwordx4 v7, s[36:39], s49 offen lds
  s_cmp_eq_u32 s43, 3
  s_cbranch_scc1 Lqs_8
  s_add_u32 m0, s47, 41984
  s_nop 0
  buffer_load_dwordx4 v8, s[36:39], s49 offen lds
Lqs_8:
  s_waitcnt vmcnt(12)
  s_barrier
  s_lshl_b32 s48, s52, 7
  s_mul_i32 s49, s52, 172032
  s_add_u32 s49, s49, s51
  s_add_u32 s52, s52, 1
  s_cmp_eq_u32 s52, 7
  s_cselect_b32 s52, 0, s52
  s_add_u32 m0, s46, 0
  s_nop 0
  buffer_load_dwordx4 v2, s[32:35], s48 offen lds
  s_add_u32 m0, s46, 1024
  s_nop 0
  buffer_load_dwordx4 v3, s[32:35], s48 offen lds
  s_add_u32 m0, s46, 2048
  s_nop 0
  buffer_load_dwordx4 v4, s[32:35], s48 offen lds
  s_add_u32 m0, s46, 3072
  s_nop 0
  buffer_load_dwordx4 v5, s[32:35], s48 offen lds
  s_add_u32 m0, s47, 0
  s_nop 0
  buffer_load_dwordx4 v6, s[36:39], s49 offen lds
  s_add_u32 m0, s47, 4096
  s_nop 0
  buffer_load_dwordx4 v7, s[36:39], s49 offen lds
  s_cmp_eq_u32 s43, 3
  s_cbranch_scc1 Lqs_9
  s_add_u32 m0, s47, 8192
  s_nop 0
  buffer_load_dwordx4 v8, s[36:39], s49 offen lds
Lqs_9:
  s_waitcnt vmcnt(12)
  s_barrier
  s_lshl_b32 s48, s52, 7
  s_mul_i32 s49, s52, 172032
  s_add_u32 s49, s49, s51
  s_add_u32 s52, s52, 1
  s_cmp_eq_u32 s52, 7
  s_cselect_b32 s52, 0, s52
  s_add_u32 m0, s46, 16384
  s_nop 0
  buffer_load_dwordx4 v2, s[32:35], s48 offen lds
  s_add_u32 m0, s46, 17408
  s_nop 0
  buffer_load_dwordx4 v3, s[32:35], s48 offen lds
  s_add_u32 m0, s46, 18432
  s_nop 0
  buffer_load_dwordx4 v4, s[32:35], s48 offen lds
  s_add_u32 m0, s46, 19456
  s_nop 0
  buffer_load_dwordx4 v5, s[32:35], s48 offen lds
  s_add_u32 m0, s47, 11264
  s_nop 0
  buffer_load_dwordx4 v6, s[36:39], s49 offen lds
  s_add_u32 m0, s47, 15360
  s_nop 0
  buffer_load_dwordx4 v7, s[36:39], s49 offen lds
  s_cmp_eq_u32 s43, 3
  s_cbranch_scc1 Lqs_10
  s_add_u32 m0, s47, 19456
  s_nop 0
  buffer_load_dwordx4 v8, s[36:39], s49 offen lds
Lqs_10:
  s_waitcnt vmcnt(12)
  s_barrier
  s_lshl_b32 s48, s52, 7
  s_mul_i32 s49, s52, 172032
  s_add_u32 s49, s49, s51
  s_add_u32 s52, s52, 1
  s_cmp_eq_u32 s52, 7
  s_cselect_b32 s52, 0, s52
  s_add_u32 m0, s46, 32768
  s_nop 0
  buffer_load_dwordx4 v2, s[32:35], s48 offen lds
  s_add_u32 m0, s46, 33792
  s_nop 0
  buffer_load_dwordx4 v3, s[32:35], s48 offen lds
  s_add_u32 m0, s46, 34816
  s_nop 0
  buffer_load_dwordx4 v4, s[32:35], s48 offen lds
  s_add_u32 m0, s46, 35840
  s_nop 0
  buffer_load_dwordx4 v5, s[32:35], s48 offen lds
  s_add_u32 m0, s47, 22528
  s_nop 0
  buffer_load_dwordx4 v6, s[36:39], s49 offen lds
  s_add_u32 m0, s47, 26624
  s_nop 0
  buffer_load_dwordx4 v7, s[36:39], s49 offen lds
  s_cmp_eq_u32 s43, 3
  s_cbranch_scc1 Lqs_11
  s_add_u32 m0, s47, 30720
  s_nop 0
  buffer_load_dwordx4 v8, s[36:39], s49 offen lds
Lqs_11:
  s_waitcnt vmcnt(12)
  s_barrier
  s_lshl_b32 s48, s52, 7
  s_mul_i32 s49, s52, 172032
  s_add_u32 s49, s49, s51
  s_add_u32 s52, s52, 1
  s_cmp_eq_u32 s52, 7
  s_cselect_b32 s52, 0, s52
  s_add_u32 m0, s46, 49152
  s_nop 0
  buffer_load_dwordx4 v2, s[32:35], s48 offen lds
  s_add_u32 m0, s46, 50176
  s_nop 0
  buffer_load_dwordx4 v3, s[32:35], s48 offen lds
  s_add_u32 m0, s46, 51200
  s_nop 0
  buffer_load_dwordx4 v4, s[32:35], s48 offen lds
  s_add_u32 m0, s46, 52224
  s_nop 0
  buffer_load_dwordx4 v5, s[32:35], s48 offen lds
  s_add_u32 m0, s47, 33792
  s_nop 0
  buffer_load_dwordx4 v6, s[36:39], s49 offen lds
  s_add_u32 m0, s47, 37888
  s_nop 0
  buffer_load_dwordx4 v7, s[36:39], s49 offen lds
  s_cmp_eq_u32 s43, 3
  s_cbranch_scc1 Lqs_12
  s_add_u32 m0, s47, 41984
  s_nop 0
  buffer_load_dwordx4 v8, s[36:39], s49 offen lds
Lqs_12:
  s_waitcnt vmcnt(12)
  s_barrier
  s_lshl_b32 s48, s52, 7
  s_mul_i32 s49, s52, 172032
  s_add_u32 s49, s49, s51
  s_add_u32 s52, s52, 1
  s_cmp_eq_u32 s52, 7
  s_cselect_b32 s52, 0, s52
  s_add_u32 m0, s46, 0
  s_nop 0
  buffer_load_dwordx4 v2, s[32:35], s48 offen lds
  s_add_u32 m0, s46, 1024
  s_nop 0
  buffer_load_dwordx4 v3, s[32:35], s48 offen lds
  s_add_u32 m0, s46, 2048
  s_nop 0
  buffer_load_dwordx4 v4, s[32:35], s48 offen lds
  s_add_u32 m0, s46, 3072
  s_nop 0
  buffer_load_dwordx4 v5, s[32:35], s48 offen lds
  s_add_u32 m0, s47, 0
  s_nop 0
  buffer_load_dwordx4 v6, s[36:39], s49 offen lds
  s_add_u32 m0, s47, 4096
  s_nop 0
  buffer_load_dwordx4 v7, s[36:39], s49 offen lds
  s_cmp_eq_u32 s43, 3
  s_cbranch_scc1 Lqs_13
  s_add_u32 m0, s47, 8192
  s_nop 0
  buffer_load_dwordx4 v8, s[36:39], s49 offen lds
Lqs_13:
  s_waitcnt vmcnt(12)
  s_barrier
  s_lshl_b32 s48, s52, 7
  s_mul_i32 s49, s52, 172032
  s_add_u32 s49, s49, s51
  s_add_u32 s52, s52, 1
  s_cmp_eq_u32 s52, 7
  s_cselect_b32 s52, 0, s52
  s_add_u32 m0, s46, 16384
  s_nop 0
  buffer_load_dwordx4 v2, s[32:35], s48 offen lds
  s_add_u32 m0, s46, 17408
  s_nop 0
  buffer_load_dwordx4 v3, s[32:35], s48 offen lds
  s_add_u32 m0, s46, 18432
  s_nop 0
  buffer_load_dwordx4 v4, s[32:35], s48 offen lds
  s_add_u32 m0, s46, 19456
  s_nop 0
  buffer_load_dwordx4 v5, s[32:35], s48 offen lds
  s_add_u32 m0, s47, 11264
  s_nop 0
  buffer_load_dwordx4 v6, s[36:39], s49 offen lds
  s_add_u32 m0, s47, 15360
  s_nop 0
  buffer_load_dwordx4 v7, s[36:39], s49 offen lds
  s_cmp_eq_u32 s43, 3
  s_cbranch_scc1 Lqs_14
  s_add_u32 m0, s47, 19456
  s_nop 0
  buffer_load_dwordx4 v8, s[36:39], s49 offen lds
Lqs_14:
  s_and_b32 s40, s2, 7
  s_bfe_u32 s41, s2, 0x10003
  s_lshl_b32 s40, s40, 1
  s_add_u32 s40, s40, s41
  s_lshl_b32 s47, s40, 18
  s_add_u32 s47, s47, 8388608
  s_add_u32 s32, s20, s47
  s_addc_u32 s33, s21, 0
  s_mov_b32 s34, 0x40000
  s_mov_b32 s35, 0x20000
  s_lshl_b32 s55, s3, 12
  s_lshr_b32 s41, s2, 4
  s_and_b32 s42, s3, 3
  s_lshr_b32 s43, s3, 2
  v_lshlrev_b32 v2, 4, v0
  s_lshl_b32 s44, s40, 6
  s_lshl_b32 s45, s41, 2
  s_add_u32 s45, s45, s42
  s_add_u32 s44, s44, s45
  s_lshl_b32 s44, s44, 11
  s_mov_b32 s24, s20
  s_mov_b32 s25, s21
  s_mov_b32 s26, 4194304
  s_mov_b32 s27, 0x20000
  s_sub_u32 s28, s32, 0x400000
  s_subb_u32 s29, s33, 0
  s_mov_b32 s30, 0x40000
  s_mov_b32 s31, 0x20000
  s_add_u32 s36, s20, 12582912
  s_addc_u32 s37, s21, 0
  s_mov_b32 s38, 4194304
  s_mov_b32 s39, 0x20000
  v_min_u32 v30, 2, v0
  v_lshlrev_b32 v30, 4, v30
  v_add_u32 v30, s40, v30
  v_mul_u32_u24 v30, 43, v30
  v_lshrrev_b32 v30, 7, v30
  v_lshlrev_b32 v31, 8, v30
  v_add_u32 v203, 4096, v31
  s_lshl_b32 s47, s41, 2
  s_add_u32 s47, s47, s3
  s_sub_u32 s47, s47, 8
  s_lshl_b32 s50, s47, 12
  s_cmp_lt_i32 s47, 0
  s_cselect_b32 s50, 0x40000000, s50
  v_add_u32 v28, s50, v2
  s_add_u32 s47, s47, 8
  s_lshl_b32 s50, s47, 12
  v_add_u32 v29, s50, v2
  s_lshl_b32 s47, s42, 12
  v_add_u32 v3, s47, v2
  s_lshl_b32 s47, s43, 14
  v_add_u32 v4, s47, v2
  v_add_u32 v5, 32768, v4
  v_add_u32 v6, 131072, v3
  s_lshl_b32 s47, s42, 8
  s_add_u32 s47, s47, 147456
  v_lshlrev_b32 v7, 2, v0
  v_add_u32 v7, s47, v7
  s_lshl_b32 s47, s42, 11
  s_add_u32 s51, s47, 131072
  v_add_u32 v200, s51, v2
  v_and_b32 v24, 31, v0
  v_lshrrev_b32 v25, 5, v0
  v_lshlrev_b32 v25, 2, v25
  v_sub_u32 v24, v24, v25
  v_mov_b32 v25, 0xf149f2ca
  s_mov_b32 s60, 0
  s_mov_b32 s61, -1
  s_mov_b32 s56, s20
  s_mov_b32 s57, s21
  s_mov_b32 s58, 16777216
  s_mov_b32 s59, 0x20000
  s_waitcnt vmcnt(12)
  s_barrier
  v_cmp_gt_i32 vcc, 0, v24
  s_nop 1
  v_cndmask_b32_e64 v32, v25, 0, vcc
  v_cmp_gt_i32 vcc, 1, v24
  s_nop 1
  v_cndmask_b32_e64 v33, v25, 0, vcc
  v_cmp_gt_i32 vcc, 2, v24
  s_nop 1
  v_cndmask_b32_e64 v34, v25, 0, vcc
  v_cmp_gt_i32 vcc, 3, v24
  s_nop 1
  v_cndmask_b32_e64 v35, v25, 0, vcc
  v_cmp_gt_i32 vcc, 8, v24
  s_nop 1
  v_cndmask_b32_e64 v36, v25, 0, vcc
  v_cmp_gt_i32 vcc, 9, v24
  s_nop 1
  v_cndmask_b32_e64 v37, v25, 0, vcc
  v_cmp_gt_i32 vcc, 10, v24
  s_nop 1
  v_cndmask_b32_e64 v38, v25, 0, vcc
  v_cmp_gt_i32 vcc, 11, v24
  s_nop 1
  v_cndmask_b32_e64 v39, v25, 0, vcc
  v_cmp_gt_i32 vcc, 16, v24
  s_nop 1
  v_cndmask_b32_e64 v40, v25, 0, vcc
  v_cmp_gt_i32 vcc, 17, v24
  s_nop 1
  v_cndmask_b32_e64 v41, v25, 0, vcc
  v_cmp_gt_i32 vcc, 18, v24
  s_nop 1
  v_cndmask_b32_e64 v42, v25, 0, vcc
  v_cmp_gt_i32 vcc, 19, v24
  s_nop 1
  v_cndmask_b32_e64 v43, v25, 0, vcc
  v_cmp_gt_i32 vcc, 24, v24
  s_nop 1
  v_cndmask_b32_e64 v44, v25, 0, vcc
  v_cmp_gt_i32 vcc, 25, v24
  s_nop 1
  v_cndmask_b32_e64 v45, v25, 0, vcc
  v_cmp_gt_i32 vcc, 26, v24
  s_nop 1
  v_cndmask_b32_e64 v46, v25, 0, vcc
  v_cmp_gt_i32 vcc, 27, v24
  s_nop 1
  v_cndmask_b32_e64 v47, v25, 0, vcc
  s_waitcnt vmcnt(6)
  s_barrier
  s_cmp_lg_u32 s3, 4
  s_cbranch_scc1 Lp12_15
  buffer_load_dword v201, v203, s[64:67], 0 offen sc1
Lp12_15:
  s_cmp_lg_u32 s3, 4
  s_cbranch_scc1 Lw13_16
  s_waitcnt vmcnt(1)
  s_branch Lw13_17
Lw13_16:
  s_waitcnt vmcnt(0)
Lw13_17:
  s_barrier
  s_cmp_lg_u32 s3, 4
  s_cbranch_scc1 Lh1_polled
  s_waitcnt vmcnt(0)
  v_cmp_ne_u32 vcc, 16, v201
  s_nop 4
  s_cbranch_vccz Lh1_polled
  s_mov_b32 s68, 200000
Lpoll_18:
  buffer_load_dword v201, v203, s[64:67], 0 offen sc1
  s_waitcnt vmcnt(0)
  v_cmp_ne_u32 vcc, 16, v201
  s_nop 4
  s_cbranch_vccz Lpdone_19
  s_sleep 1
  s_sub_u32 s68, s68, 1
  s_cmp_lg_u32 s68, 0
  s_cbranch_scc1 Lpoll_18
Lpdone_19:
Lh1_polled:
  s_barrier
  s_add_u32 s47, s44, 0x200000
  s_mov_b32 m0, s51
  s_nop 0
  buffer_load_dwordx4 v2, s[24:27], s47 offen offset:0 lds
  buffer_load_dwordx4 v2, s[24:27], s47 offen offset:1024 lds
  s_add_u32 s54, s55, 0
  s_add_u32 m0, s55, 0
  s_nop 0
  buffer_load_dwordx4 v2, s[32:35], s54 offen offset:0 lds
  buffer_load_dwordx4 v2, s[32:35], s54 offen offset:1024 lds
  buffer_load_dwordx4 v2, s[32:35], s54 offen offset:2048 lds
  buffer_load_dwordx4 v2, s[32:35], s54 offen offset:3072 lds
  s_add_u32 s54, s55, 32768
  s_add_u32 m0, s55, 32768
  s_nop 0
  buffer_load_dwordx4 v2, s[32:35], s54 offen offset:0 lds
  buffer_load_dwordx4 v2, s[32:35], s54 offen offset:1024 lds
  buffer_load_dwordx4 v2, s[32:35], s54 offen offset:2048 lds
  buffer_load_dwordx4 v2, s[32:35], s54 offen offset:3072 lds
  s_waitcnt vmcnt(4)
  s_barrier
  s_branch Lattn_go
Lcompute:
  v_and_b32 v4, 31, v0
  s_lshl_b32 s44, s3, 5
  v_add_u32 v4, s44, v4
  v_lshlrev_b32 v4, 7, v4
  v_bfe_u32 v5, v0, 1, 3
  v_lshrrev_b32 v6, 5, v0
  v_add_u32 v7, 0, v6
  v_xor_b32 v7, v7, v5
  v_lshl_add_u32 v12, v7, 4, v4
  v_add_u32 v7, 2, v6
  v_xor_b32 v7, v7, v5
  v_lshl_add_u32 v13, v7, 4, v4
  v_add_u32 v7, 4, v6
  v_xor_b32 v7, v7, v5
  v_lshl_add_u32 v14, v7, 4, v4
  v_add_u32 v7, 6, v6
  v_xor_b32 v7, v7, v5
  v_lshl_add_u32 v15, v7, 4, v4
  v_bfe_u32 v4, v0, 2, 2
  v_and_b32 v5, 3, v0
  v_bfe_u32 v7, v0, 4, 1
  v_lshlrev_b32 v7, 5, v7
  v_lshl_add_u32 v7, v5, 3, v7
  v_lshlrev_b32 v4, 1, v4
  v_add_u32 v4, v4, v6
  v_mul_u32_u24 v4, 352, v4
  v_add_u32 v4, v4, v7
  v_add_u32 v16, 65536, v4
  v_lshlrev_b32 v2, 4, v0
  s_waitcnt lgkmcnt(0)
  s_mov_b32 s32, s20
  s_mov_b32 s33, s21
  s_mov_b32 s34, 16777216
  s_mov_b32 s35, 0x20000
  s_add_u32 s64, s20, 16777216
  s_addc_u32 s65, s21, 0
  s_mov_b32 s66, 16384
  s_mov_b32 s67, 0x20000
  s_or_b32 s44, s2, s3
  s_cmp_lg_u32 s44, 0
  s_cbranch_scc1 Lnoinit
  v_lshlrev_b32 v20, 8, v0
  v_mov_b32 v21, 0
  buffer_store_dword v21, v20, s[64:67], 0 offen sc1
  s_waitcnt vmcnt(0)
  s_mov_b32 s36, s18
  s_mov_b32 s37, s19
  s_mov_b32 s38, 256
  s_mov_b32 s39, 0x20000
  s_mov_b64 exec, 1
  v_mov_b32 v21, 1
  v_mov_b32 v20, 0
  buffer_store_dword v21, v20, s[36:39], 0 offen sc1
  s_mov_b64 exec, -1
Lnoinit:
  s_mov_b32 s36, s18
  s_mov_b32 s37, s19
  s_mov_b32 s38, 256
  s_mov_b32 s39, 0x20000
  v_mov_b32 v30, 0
  buffer_load_dword v31, v30, s[36:39], 0 offen sc1
  v_and_b32 v18, 31, v0
  v_cmp_eq_u32 vcc, 28, v18
  v_mov_b32 v19, 0x3f803f80
  s_nop 0
  v_cndmask_b32_e64 v18, 0, v19, vcc
  s_mov_b32 s60, 0
  s_mov_b32 s61, -1
  s_mov_b32 s58, 0xf0000000
  s_mov_b32 s59, 0xf0000000
  s_mul_i32 s52, s23, 3
  s_mul_i32 s63, s69, 3
  s_cmp_eq_u32 s23, 9
  s_cbranch_scc1 Lqkv_v1
  s_cmp_eq_u32 s23, 10
  s_cbranch_scc1 Lqkv_v2
  s_cmp_eq_u32 s23, 15
  s_cbranch_scc1 Lqkv_v4
  s_cmp_gt_u32 s23, 10
  s_cbranch_scc1 Lqkv_v3
  s_barrier
  ds_read_b128 v[80:83], v12 offset:0
  ds_read_b64_tr_b16 v[88:89], v16 offset:0
  ds_read_b64_tr_b16 v[90:91], v16 offset:176
  ds_read_b64_tr_b16 v[92:93], v16 offset:56
  ds_read_b64_tr_b16 v[94:95], v16 offset:232
  ds_read_b64_tr_b16 v[96:97], v16 offset:112
  ds_read_b64_tr_b16 v[98:99], v16 offset:288
  s_cmp_ge_u32 s3, 2
  s_cbranch_scc1 Lpf5_20
  s_cmp_eq_u32 s3, 0
  s_cselect_b32 s24, s8, s14
  s_cselect_b32 s25, s9, s15
  s_mov_b32 s26, 401408
  s_mov_b32 s27, 0x20000
  s_mul_i32 s46, s2, 1568
  v_add_u32 v20, s46, v2
  buffer_load_dwordx4 v[168:171], v20, s[24:27], 0 offen offset:0
  buffer_load_dwordx4 v[172:175], v20, s[24:27], 0 offen offset:1024
Lpf5_20:
  s_waitcnt lgkmcnt(4)
  v_mfma_f32_32x32x16_bf16 v[32:47], v[88:91], v[80:83], 0
  ds_read_b128 v[84:87], v13 offset:0
  ds_read_b64_tr_b16 v[100:101], v16 offset:2816
  ds_read_b64_tr_b16 v[102:103], v16 offset:2992
  s_waitcnt lgkmcnt(5)
  v_mfma_f32_32x32x16_bf16 v[48:63], v[92:95], v[80:83], 0
  ds_read_b64_tr_b16 v[104:105], v16 offset:2872
  ds_read_b64_tr_b16 v[106:107], v16 offset:3048
  s_waitcnt lgkmcnt(5)
  v_mfma_f32_32x32x16_bf16 v[64:79], v[96:99], v[80:83], 0
  ds_read_b64_tr_b16 v[108:109], v16 offset:2928
  ds_read_b64_tr_b16 v[110:111], v16 offset:3104
  s_waitcnt lgkmcnt(4)
  v_mfma_f32_32x32x16_bf16 v[32:47], v[100:103], v[84:87], v[32:47]
  ds_read_b128 v[80:83], v14 offset:0
  ds_read_b64_tr_b16 v[88:89], v16 offset:5632
  ds_read_b64_tr_b16 v[90:91], v16 offset:5808
  s_waitcnt lgkmcnt(5)
  v_mfma_f32_32x32x16_bf16 v[48:63], v[104:107], v[84:87], v[48:63]
  ds_read_b64_tr_b16 v[92:93], v16 offset:5688
  ds_read_b64_tr_b16 v[94:95], v16 offset:5864
  s_waitcnt lgkmcnt(5)
  v_mfma_f32_32x32x16_bf16 v[64:79], v[108:111], v[84:87], v[64:79]
  ds_read_b64_tr_b16 v[96:97], v16 offset:5744
  ds_read_b64_tr_b16 v[98:99], v16 offset:5920
  s_waitcnt lgkmcnt(4)
  v_mfma_f32_32x32x16_bf16 v[32:47], v[88:91], v[80:83], v[32:47]
  ds_read_b128 v[84:87], v15 offset:0
  ds_read_b64_tr_b16 v[100:101], v16 offset:8448
  ds_read_b64_tr_b16 v[102:103], v16 offset:8624
  s_waitcnt lgkmcnt(5)
  v_mfma_f32_32x32x16_bf16 v[48:63], v[92:95], v[80:83], v[48:63]
  ds_read_b64_tr_b16 v[104:105], v16 offset:8504
  ds_read_b64_tr_b16 v[106:107], v16 offset:8680
  s_waitcnt lgkmcnt(5)
  v_mfma_f32_32x32x16_bf16 v[64:79], v[96:99], v[80:83], v[64:79]
  ds_read_b64_tr_b16 v[108:109], v16 offset:8560
  ds_read_b64_tr_b16 v[110:111], v16 offset:8736
  s_waitcnt lgkmcnt(0)
  s_barrier
  v_mfma_f32_32x32x16_bf16 v[32:47], v[100:103], v[84:87], v[32:47]
  ds_read_b128 v[80:83], v12 offset:16384
  ds_read_b64_tr_b16 v[88:89], v16 offset:11264
  ds_read_b64_tr_b16 v[90:91], v16 offset:11440
  v_mfma_f32_32x32x16_bf16 v[48:63], v[104:107], v[84:87], v[48:63]
  ds_read_b64_tr_b16 v[92:93], v16 offset:11320
  ds_read_b64_tr_b16 v[94:95], v16 offset:11496
  v_mfma_f32_32x32x16_bf16 v[64:79], v[108:111], v[84:87], v[64:79]
  ds_read_b64_tr_b16 v[96:97], v16 offset:11376
  ds_read_b64_tr_b16 v[98:99], v16 offset:11552
  s_waitcnt lgkmcnt(4)
  v_mfma_f32_32x32x16_bf16 v[32:47], v[88:91], v[80:83], v[32:47]
  ds_read_b128 v[84:87], v13 offset:16384
  ds_read_b64_tr_b16 v[100:101], v16 offset:14080
  ds_read_b64_tr_b16 v[102:103], v16 offset:14256
  s_waitcnt lgkmcnt(5)
  v_mfma_f32_32x32x16_bf16 v[48:63], v[92:95], v[80:83], v[48:63]
  ds_read_b64_tr_b16 v[104:105], v16 offset:14136
  ds_read_b64_tr_b16 v[106:107], v16 offset:14312
  s_waitcnt lgkmcnt(5)
  v_mfma_f32_32x32x16_bf16 v[64:79], v[96:99], v[80:83], v[64:79]
  ds_read_b64_tr_b16 v[108:109], v16 offset:14192
  ds_read_b64_tr_b16 v[110:111], v16 offset:14368
  s_waitcnt lgkmcnt(4)
  v_mfma_f32_32x32x16_bf16 v[32:47], v[100:103], v[84:87], v[32:47]
  ds_read_b128 v[80:83], v14 offset:16384
  ds_read_b64_tr_b16 v[88:89], v16 offset:16896
  ds_read_b64_tr_b16 v[90:91], v16 offset:17072
  s_waitcnt lgkmcnt(5)
  v_mfma_f32_32x32x16_bf16 v[48:63], v[104:107], v[84:87], v[48:63]
  ds_read_b64_tr_b16 v[92:93], v16 offset:16952
  ds_read_b64_tr_b16 v[94:95], v16 offset:17128
  s_waitcnt lgkmcnt(5)
  v_mfma_f32_32x32x16_bf16 v[64:79], v[108:111], v[84:87], v[64:79]
  ds_read_b64_tr_b16 v[96:97], v16 offset:17008
  ds_read_b64_tr_b16 v[98:99], v16 offset:17184
  s_waitcnt lgkmcnt(4)
  v_mfma_f32_32x32x16_bf16 v[32:47], v[88:91], v[80:83], v[32:47]
  ds_read_b128 v[84:87], v15 offset:16384
  ds_read_b64_tr_b16 v[100:101], v16 offset:19712
  ds_read_b64_tr_b16 v[102:103], v16 offset:19888
  s_waitcnt lgkmcnt(5)
  v_mfma_f32_32x32x16_bf16 v[48:63], v[92:95], v[80:83], v[48:63]
  ds_read_b64_tr_b16 v[104:105], v16 offset:19768
  ds_read_b64_tr_b16 v[106:107], v16 offset:19944
  s_waitcnt lgkmcnt(5)
  v_mfma_f32_32x32x16_bf16 v[64:79], v[96:99], v[80:83], v[64:79]
  ds_read_b64_tr_b16 v[108:109], v16 offset:19824
  ds_read_b64_tr_b16 v[110:111], v16 offset:20000
  s_waitcnt lgkmcnt(0)
  s_barrier
  v_mfma_f32_32x32x16_bf16 v[32:47], v[100:103], v[84:87], v[32:47]
  ds_read_b128 v[80:83], v12 offset:32768
  ds_read_b64_tr_b16 v[88:89], v16 offset:22528
  ds_read_b64_tr_b16 v[90:91], v16 offset:22704
  v_mfma_f32_32x32x16_bf16 v[48:63], v[104:107], v[84:87], v[48:63]
  ds_read_b64_tr_b16 v[92:93], v16 offset:22584
  ds_read_b64_tr_b16 v[94:95], v16 offset:22760
  v_mfma_f32_32x32x16_bf16 v[64:79], v[108:111], v[84:87], v[64:79]
  ds_read_b64_tr_b16 v[96:97], v16 offset:22640
  ds_read_b64_tr_b16 v[98:99], v16 offset:22816
  s_waitcnt lgkmcnt(4)
  v_mfma_f32_32x32x16_bf16 v[32:47], v[88:91], v[80:83], v[32:47]
  ds_read_b128 v[84:87], v13 offset:32768
  ds_read_b64_tr_b16 v[100:101], v16 offset:25344
  ds_read_b64_tr_b16 v[102:103], v16 offset:25520
  s_waitcnt lgkmcnt(5)
  v_mfma_f32_32x32x16_bf16 v[48:63], v[92:95], v[80:83], v[48:63]
  ds_read_b64_tr_b16 v[104:105], v16 offset:25400
  ds_read_b64_tr_b16 v[106:107], v16 offset:25576
  s_waitcnt lgkmcnt(5)
  v_mfma_f32_32x32x16_bf16 v[64:79], v[96:99], v[80:83], v[64:79]
  ds_read_b64_tr_b16 v[108:109], v16 offset:25456
  ds_read_b64_tr_b16 v[110:111], v16 offset:25632
  s_waitcnt lgkmcnt(4)
  v_mfma_f32_32x32x16_bf16 v[32:47], v[100:103], v[84:87], v[32:47]
  ds_read_b128 v[80:83], v14 offset:32768
  ds_read_b64_tr_b16 v[88:89], v16 offset:28160
  ds_read_b64_tr_b16 v[90:91], v16 offset:28336
  s_waitcnt lgkmcnt(5)
  v_mfma_f32_32x32x16_bf16 v[48:63], v[104:107], v[84:87], v[48:63]
  ds_read_b64_tr_b16 v[92:93], v16 offset:28216
  ds_read_b64_tr_b16 v[94:95], v16 offset:28392
  s_waitcnt lgkmcnt(5)
  v_mfma_f32_32x32x16_bf16 v[64:79], v[108:111], v[84:87], v[64:79]
  ds_read_b64_tr_b16 v[96:97], v16 offset:28272
  ds_read_b64_tr_b16 v[98:99], v16 offset:28448
  s_waitcnt lgkmcnt(4)
  v_mfma_f32_32x32x16_bf16 v[32:47], v[88:91], v[80:83], v[32:47]
  ds_read_b128 v[84:87], v15 offset:32768
  ds_read_b64_tr_b16 v[100:101], v16 offset:30976
  ds_read_b64_tr_b16 v[102:103], v16 offset:31152
  s_waitcnt lgkmcnt(5)
  v_mfma_f32_32x32x16_bf16 v[48:63], v[92:95], v[80:83], v[48:63]
  ds_read_b64_tr_b16 v[104:105], v16 offset:31032
  ds_read_b64_tr_b16 v[106:107], v16 offset:31208
  s_waitcnt lgkmcnt(5)
  v_mfma_f32_32x32x16_bf16 v[64:79], v[96:99], v[80:83], v[64:79]
  ds_read_b64_tr_b16 v[108:109], v16 offset:31088
  ds_read_b64_tr_b16 v[110:111], v16 offset:31264
  s_waitcnt lgkmcnt(0)
  s_barrier
  v_mfma_f32_32x32x16_bf16 v[32:47], v[100:103], v[84:87], v[32:47]
  ds_read_b128 v[80:83], v12 offset:49152
  ds_read_b64_tr_b16 v[88:89], v16 offset:33792
  ds_read_b64_tr_b16 v[90:91], v16 offset:33968
  v_mfma_f32_32x32x16_bf16 v[48:63], v[104:107], v[84:87], v[48:63]
  ds_read_b64_tr_b16 v[92:93], v16 offset:33848
  ds_read_b64_tr_b16 v[94:95], v16 offset:34024
  v_mfma_f32_32x32x16_bf16 v[64:79], v[108:111], v[84:87], v[64:79]
  ds_read_b64_tr_b16 v[96:97], v16 offset:33904
  ds_read_b64_tr_b16 v[98:99], v16 offset:34080
  s_waitcnt lgkmcnt(4)
  v_mfma_f32_32x32x16_bf16 v[32:47], v[88:91], v[80:83], v[32:47]
  ds_read_b128 v[84:87], v13 offset:49152
  ds_read_b64_tr_b16 v[100:101], v16 offset:36608
  ds_read_b64_tr_b16 v[102:103], v16 offset:36784
  s_waitcnt lgkmcnt(5)
  v_mfma_f32_32x32x16_bf16 v[48:63], v[92:95], v[80:83], v[48:63]
  ds_read_b64_tr_b16 v[104:105], v16 offset:36664
  ds_read_b64_tr_b16 v[106:107], v16 offset:36840
  s_waitcnt lgkmcnt(5)
  v_mfma_f32_32x32x16_bf16 v[64:79], v[96:99], v[80:83], v[64:79]
  ds_read_b64_tr_b16 v[108:109], v16 offset:36720
  ds_read_b64_tr_b16 v[110:111], v16 offset:36896
  s_waitcnt lgkmcnt(4)
  v_mfma_f32_32x32x16_bf16 v[32:47], v[100:103], v[84:87], v[32:47]
  ds_read_b128 v[80:83], v14 offset:49152
  ds_read_b64_tr_b16 v[88:89], v16 offset:39424
  ds_read_b64_tr_b16 v[90:91], v16 offset:39600
  s_waitcnt lgkmcnt(5)
  v_mfma_f32_32x32x16_bf16 v[48:63], v[104:107], v[84:87], v[48:63]
  ds_read_b64_tr_b16 v[92:93], v16 offset:39480
  ds_read_b64_tr_b16 v[94:95], v16 offset:39656
  s_waitcnt lgkmcnt(5)
  v_mfma_f32_32x32x16_bf16 v[64:79], v[108:111], v[84:87], v[64:79]
  ds_read_b64_tr_b16 v[96:97], v16 offset:39536
  ds_read_b64_tr_b16 v[98:99], v16 offset:39712
  s_waitcnt lgkmcnt(4)
  v_mfma_f32_32x32x16_bf16 v[32:47], v[88:91], v[80:83], v[32:47]
  ds_read_b128 v[84:87], v15 offset:49152
  ds_read_b64_tr_b16 v[100:101], v16 offset:42240
  ds_read_b64_tr_b16 v[102:103], v16 offset:42416
  s_waitcnt lgkmcnt(5)
  v_mfma_f32_32x32x16_bf16 v[48:63], v[92:95], v[80:83], v[48:63]
  ds_read_b64_tr_b16 v[104:105], v16 offset:42296
  ds_read_b64_tr_b16 v[106:107], v16 offset:42472
  s_waitcnt lgkmcnt(5)
  v_mfma_f32_32x32x16_bf16 v[64:79], v[96:99], v[80:83], v[64:79]
  ds_read_b64_tr_b16 v[108:109], v16 offset:42352
  ds_read_b64_tr_b16 v[110:111], v16 offset:42528
  s_waitcnt lgkmcnt(0)
  s_barrier
  v_mfma_f32_32x32x16_bf16 v[32:47], v[100:103], v[84:87], v[32:47]
  ds_read_b128 v[80:83], v12 offset:0
  ds_read_b64_tr_b16 v[88:89], v16 offset:0
  ds_read_b64_tr_b16 v[90:91], v16 offset:176
  v_mfma_f32_32x32x16_bf16 v[48:63], v[104:107], v[84:87], v[48:63]
  ds_read_b64_tr_b16 v[92:93], v16 offset:56
  ds_read_b64_tr_b16 v[94:95], v16 offset:232
  v_mfma_f32_32x32x16_bf16 v[64:79], v[108:111], v[84:87], v[64:79]
  ds_read_b64_tr_b16 v[96:97], v16 offset:112
  ds_read_b64_tr_b16 v[98:99], v16 offset:288
  s_waitcnt lgkmcnt(4)
  v_mfma_f32_32x32x16_bf16 v[32:47], v[88:91], v[80:83], v[32:47]
  ds_read_b128 v[84:87], v13 offset:0
  ds_read_b64_tr_b16 v[100:101], v16 offset:2816
  ds_read_b64_tr_b16 v[102:103], v16 offset:2992
  s_waitcnt lgkmcnt(5)
  v_mfma_f32_32x32x16_bf16 v[48:63], v[92:95], v[80:83], v[48:63]
  ds_read_b64_tr_b16 v[104:105], v16 offset:2872
  ds_read_b64_tr_b16 v[106:107], v16 offset:3048
  s_waitcnt lgkmcnt(5)
  v_mfma_f32_32x32x16_bf16 v[64:79], v[96:99], v[80:83], v[64:79]
  ds_read_b64_tr_b16 v[108:109], v16 offset:2928
  ds_read_b64_tr_b16 v[110:111], v16 offset:3104
  s_waitcnt lgkmcnt(4)
  v_mfma_f32_32x32x16_bf16 v[32:47], v[100:103], v[84:87], v[32:47]
  ds_read_b128 v[80:83], v14 offset:0
  ds_read_b64_tr_b16 v[88:89], v16 offset:5632
  ds_read_b64_tr_b16 v[90:91], v16 offset:5808
  s_waitcnt lgkmcnt(5)
  v_mfma_f32_32x32x16_bf16 v[48:63], v[104:107], v[84:87], v[48:63]
  ds_read_b64_tr_b16 v[92:93], v16 offset:5688
  ds_read_b64_tr_b16 v[94:95], v16 offset:5864
  s_waitcnt lgkmcnt(5)
  v_mfma_f32_32x32x16_bf16 v[64:79], v[108:111], v[84:87], v[64:79]
  ds_read_b64_tr_b16 v[96:97], v16 offset:5744
  ds_read_b64_tr_b16 v[98:99], v16 offset:5920
  s_waitcnt lgkmcnt(4)
  v_mfma_f32_32x32x16_bf16 v[32:47], v[88:91], v[80:83], v[32:47]
  ds_read_b128 v[84:87], v15 offset:0
  ds_read_b64_tr_b16 v[100:101], v16 offset:8448
  ds_read_b64_tr_b16 v[102:103], v16 offset:8624
  s_waitcnt lgkmcnt(5)
  v_mfma_f32_32x32x16_bf16 v[48:63], v[92:95], v[80:83], v[48:63]
  ds_read_b64_tr_b16 v[104:105], v16 offset:8504
  ds_read_b64_tr_b16 v[106:107], v16 offset:8680
  s_waitcnt lgkmcnt(5)
  v_mfma_f32_32x32x16_bf16 v[64:79], v[96:99], v[80:83], v[64:79]
  ds_read_b64_tr_b16 v[108:109], v16 offset:8560
  ds_read_b64_tr_b16 v[110:111], v16 offset:8736
  s_waitcnt lgkmcnt(0)
  s_barrier
  v_mfma_f32_32x32x16_bf16 v[32:47], v[100:103], v[84:87], v[32:47]
  ds_read_b128 v[80:83], v12 offset:16384
  ds_read_b64_tr_b16 v[88:89], v16 offset:11264
  ds_read_b64_tr_b16 v[90:91], v16 offset:11440
  v_mfma_f32_32x32x16_bf16 v[48:63], v[104:107], v[84:87], v[48:63]
  ds_read_b64_tr_b16 v[92:93], v16 offset:11320
  ds_read_b64_tr_b16 v[94:95], v16 offset:11496
  v_mfma_f32_32x32x16_bf16 v[64:79], v[108:111], v[84:87], v[64:79]
  ds_read_b64_tr_b16 v[96:97], v16 offset:11376
  ds_read_b64_tr_b16 v[98:99], v16 offset:11552
  s_waitcnt lgkmcnt(4)
  v_mfma_f32_32x32x16_bf16 v[32:47], v[88:91], v[80:83], v[32:47]
  ds_read_b128 v[84:87], v13 offset:16384
  ds_read_b64_tr_b16 v[100:101], v16 offset:14080
  ds_read_b64_tr_b16 v[102:103], v16 offset:14256
  s_waitcnt lgkmcnt(5)
  v_mfma_f32_32x32x16_bf16 v[48:63], v[92:95], v[80:83], v[48:63]
  ds_read_b64_tr_b16 v[104:105], v16 offset:14136
  ds_read_b64_tr_b16 v[106:107], v16 offset:14312
  s_waitcnt lgkmcnt(5)
  v_mfma_f32_32x32x16_bf16 v[64:79], v[96:99], v[80:83], v[64:79]
  ds_read_b64_tr_b16 v[108:109], v16 offset:14192
  ds_read_b64_tr_b16 v[110:111], v16 offset:14368
  s_waitcnt lgkmcnt(4)
  v_mfma_f32_32x32x16_bf16 v[32:47], v[100:103], v[84:87], v[32:47]
  ds_read_b128 v[80:83], v14 offset:16384
  ds_read_b64_tr_b16 v[88:89], v16 offset:16896
  ds_read_b64_tr_b16 v[90:91], v16 offset:17072
  s_waitcnt lgkmcnt(5)
  v_mfma_f32_32x32x16_bf16 v[48:63], v[104:107], v[84:87], v[48:63]
  ds_read_b64_tr_b16 v[92:93], v16 offset:16952
  ds_read_b64_tr_b16 v[94:95], v16 offset:17128
  s_waitcnt lgkmcnt(5)
  v_mfma_f32_32x32x16_bf16 v[64:79], v[108:111], v[84:87], v[64:79]
  ds_read_b64_tr_b16 v[96:97], v16 offset:17008
  ds_read_b64_tr_b16 v[98:99], v16 offset:17184
  s_waitcnt lgkmcnt(4)
  v_mfma_f32_32x32x16_bf16 v[32:47], v[88:91], v[80:83], v[32:47]
  ds_read_b128 v[84:87], v15 offset:16384
  ds_read_b64_tr_b16 v[100:101], v16 offset:19712
  ds_read_b64_tr_b16 v[102:103], v16 offset:19888
  s_waitcnt lgkmcnt(5)
  v_mfma_f32_32x32x16_bf16 v[48:63], v[92:95], v[80:83], v[48:63]
  ds_read_b64_tr_b16 v[104:105], v16 offset:19768
  ds_read_b64_tr_b16 v[106:107], v16 offset:19944
  s_waitcnt lgkmcnt(5)
  v_mfma_f32_32x32x16_bf16 v[64:79], v[96:99], v[80:83], v[64:79]
  ds_read_b64_tr_b16 v[108:109], v16 offset:19824
  ds_read_b64_tr_b16 v[110:111], v16 offset:20000
  s_waitcnt vmcnt(0) lgkmcnt(0)
  s_barrier
  v_mfma_f32_32x32x16_bf16 v[32:47], v[100:103], v[84:87], v[32:47]
  ds_read_b128 v[80:83], v12 offset:32768
  ds_read_b64_tr_b16 v[88:89], v16 offset:22528
  ds_read_b64_tr_b16 v[90:91], v16 offset:22704
  v_mfma_f32_32x32x16_bf16 v[48:63], v[104:107], v[84:87], v[48:63]
  ds_read_b64_tr_b16 v[92:93], v16 offset:22584
  ds_read_b64_tr_b16 v[94:95], v16 offset:22760
  v_mfma_f32_32x32x16_bf16 v[64:79], v[108:111], v[84:87], v[64:79]
  ds_read_b64_tr_b16 v[96:97], v16 offset:22640
  ds_read_b64_tr_b16 v[98:99], v16 offset:22816
  s_waitcnt lgkmcnt(4)
  v_mfma_f32_32x32x16_bf16 v[32:47], v[88:91], v[80:83], v[32:47]
  ds_read_b128 v[84:87], v13 offset:32768
  ds_read_b64_tr_b16 v[100:101], v16 offset:25344
  ds_read_b64_tr_b16 v[102:103], v16 offset:25520
  s_waitcnt lgkmcnt(5)
  v_mfma_f32_32x32x16_bf16 v[48:63], v[92:95], v[80:83], v[48:63]
  ds_read_b64_tr_b16 v[104:105], v16 offset:25400
  ds_read_b64_tr_b16 v[106:107], v16 offset:25576
  s_waitcnt lgkmcnt(5)
  v_mfma_f32_32x32x16_bf16 v[64:79], v[96:99], v[80:83], v[64:79]
  ds_read_b64_tr_b16 v[108:109], v16 offset:25456
  ds_read_b64_tr_b16 v[110:111], v16 offset:25632
  s_waitcnt lgkmcnt(4)
  v_mfma_f32_32x32x16_bf16 v[32:47], v[100:103], v[84:87], v[32:47]
  ds_read_b128 v[80:83], v14 offset:32768
  ds_read_b64_tr_b16 v[88:89], v16 offset:28160
  ds_read_b64_tr_b16 v[90:91], v16 offset:28336
  s_waitcnt lgkmcnt(5)
  v_mfma_f32_32x32x16_bf16 v[48:63], v[104:107], v[84:87], v[48:63]
  ds_read_b64_tr_b16 v[92:93], v16 offset:28216
  ds_read_b64_tr_b16 v[94:95], v16 offset:28392
  s_waitcnt lgkmcnt(5)
  v_mfma_f32_32x32x16_bf16 v[64:79], v[108:111], v[84:87], v[64:79]
  ds_read_b64_tr_b16 v[96:97], v16 offset:28272
  ds_read_b64_tr_b16 v[98:99], v16 offset:28448
  s_waitcnt lgkmcnt(4)
  v_mfma_f32_32x32x16_bf16 v[32:47], v[88:91], v[80:83], v[32:47]
  ds_read_b128 v[84:87], v15 offset:32768
  ds_read_b64_tr_b16 v[100:101], v16 offset:30976
  ds_read_b64_tr_b16 v[102:103], v16 offset:31152
  s_waitcnt lgkmcnt(5)
  v_mfma_f32_32x32x16_bf16 v[48:63], v[92:95], v[80:83], v[48:63]
  ds_read_b64_tr_b16 v[104:105], v16 offset:31032
  ds_read_b64_tr_b16 v[106:107], v16 offset:31208
  s_waitcnt lgkmcnt(5)
  v_mfma_f32_32x32x16_bf16 v[64:79], v[96:99], v[80:83], v[64:79]
  ds_read_b64_tr_b16 v[108:109], v16 offset:31088
  ds_read_b64_tr_b16 v[110:111], v16 offset:31264
  s_waitcnt lgkmcnt(0)
  s_barrier
  v_mfma_f32_32x32x16_bf16 v[32:47], v[100:103], v[84:87], v[32:47]
  ds_read_b128 v[80:83], v12 offset:49152
  ds_read_b64_tr_b16 v[88:89], v16 offset:33792
  ds_read_b64_tr_b16 v[90:91], v16 offset:33968
  v_mfma_f32_32x32x16_bf16 v[48:63], v[104:107], v[84:87], v[48:63]
  ds_read_b64_tr_b16 v[92:93], v16 offset:33848
  ds_read_b64_tr_b16 v[94:95], v16 offset:34024
  v_mfma_f32_32x32x16_bf16 v[64:79], v[108:111], v[84:87], v[64:79]
  ds_read_b64_tr_b16 v[96:97], v16 offset:33904
  ds_read_b64_tr_b16 v[98:99], v16 offset:34080
  s_waitcnt lgkmcnt(4)
  v_mfma_f32_32x32x16_bf16 v[144:159], v[88:91], v[80:83], 0
  ds_read_b128 v[84:87], v13 offset:49152
  ds_read_b64_tr_b16 v[100:101], v16 offset:36608
  ds_read_b64_tr_b16 v[102:103], v16 offset:36784
  s_nop 7
  s_lshl_b32 s54, s22, 2
  s_add_u32 s54, s54, s3
  s_add_u32 s54, s54, 1024
  s_add_u32 s62, s52, 0
  s_and_b32 s56, s62, 15
  s_lshl_b32 s56, s56, 6
  s_add_u32 s56, s56, s54
  s_cmp_lt_u32 s62, 16
  s_cselect_b32 s57, 0x3e8b97f6, 1.0
  s_cselect_b32 s45, 0, 0x3f80
  s_cselect_b32 s46, 11, 12
  s_cselect_b32 s47, 0, 4194304
  s_lshl_b32 s56, s56, s46
  s_add_u32 s48, s56, s47
  v_mov_b32 v19, s45
  v_mul_f32 v32, s57, v32
  v_mul_f32 v33, s57, v33
  v_mul_f32 v34, s57, v34
  v_mul_f32 v35, s57, v35
  v_mul_f32 v36, s57, v36
  v_mul_f32 v37, s57, v37
  v_mul_f32 v38, s57, v38
  s_waitcnt lgkmcnt(5)
  v_mfma_f32_32x32x16_bf16 v[160:175], v[92:95], v[80:83], 0
  ds_read_b64_tr_b16 v[104:105], v16 offset:36664
  ds_read_b64_tr_b16 v[106:107], v16 offset:36840
  v_mul_f32 v39, s57, v39
  v_mul_f32 v40, s57, v40
  v_mul_f32 v41, s57, v41
  v_mul_f32 v42, s57, v42
  v_mul_f32 v43, s57, v43
  v_mul_f32 v44, s57, v44
  v_mul_f32 v45, s57, v45
  v_mul_f32 v46, s57, v46
  v_mul_f32 v47, s57, v47
  v_cvt_pk_bf16_f32 v112, v32, v33
  v_cvt_pk_bf16_f32 v113, v34, v35
  v_cvt_pk_bf16_f32 v114, v36, v37
  v_cvt_pk_bf16_f32 v115, v38, v39
  v_cvt_pk_bf16_f32 v116, v40, v41
  v_cvt_pk_bf16_f32 v117, v42, v43
  v_cvt_pk_bf16_f32 v118, v44, v45
  v_cvt_pk_bf16_f32 v119, v46, v47
  v_cndmask_b32_e64 v118, v118, v19, s[60:61]
  v_cndmask_b32_e64 v119, v119, 0, s[60:61]
  s_waitcnt lgkmcnt(5)
  v_mfma_f32_32x32x16_bf16 v[176:191], v[96:99], v[80:83], 0
  ds_read_b64_tr_b16 v[108:109], v16 offset:36720
  ds_read_b64_tr_b16 v[110:111], v16 offset:36896
  s_nop 1
  buffer_store_dwordx4 v[112:115], v2, s[32:35], s48 offen sc1
  buffer_store_dwordx4 v[116:119], v2, s[32:35], s48 offen offset:1024 sc1
  s_add_u32 s62, s52, 1
  s_and_b32 s56, s62, 15
  s_lshl_b32 s56, s56, 6
  s_add_u32 s56, s56, s54
  s_cmp_lt_u32 s62, 16
  s_cselect_b32 s57, 0x3e8b97f6, 1.0
  s_cselect_b32 s45, 0, 0x3f80
  s_cselect_b32 s46, 11, 12
  s_cselect_b32 s47, 0, 4194304
  s_lshl_b32 s56, s56, s46
  s_add_u32 s49, s56, s47
  v_mov_b32 v19, s45
  v_mul_f32 v48, s57, v48
  v_mul_f32 v49, s57, v49
  v_mul_f32 v50, s57, v50
  v_mul_f32 v51, s57, v51
  v_mul_f32 v52, s57, v52
  v_mul_f32 v53, s57, v53
  v_mul_f32 v54, s57, v54
  v_mul_f32 v55, s57, v55
  v_mul_f32 v56, s57, v56
  s_waitcnt lgkmcnt(4)
  v_mfma_f32_32x32x16_bf16 v[144:159], v[100:103], v[84:87], v[144:159]
  ds_read_b128 v[80:83], v14 offset:49152
  ds_read_b64_tr_b16 v[88:89], v16 offset:39424
  ds_read_b64_tr_b16 v[90:91], v16 offset:39600
  v_mul_f32 v57, s57, v57
  v_mul_f32 v58, s57, v58
  v_mul_f32 v59, s57, v59
  v_mul_f32 v60, s57, v60
  v_mul_f32 v61, s57, v61
  v_mul_f32 v62, s57, v62
  v_mul_f32 v63, s57, v63
  v_cvt_pk_bf16_f32 v120, v48, v49
  v_cvt_pk_bf16_f32 v121, v50, v51
  v_cvt_pk_bf16_f32 v122, v52, v53
  v_cvt_pk_bf16_f32 v123, v54, v55
  v_cvt_pk_bf16_f32 v124, v56, v57
  v_cvt_pk_bf16_f32 v125, v58, v59
  v_cvt_pk_bf16_f32 v126, v60, v61
  v_cvt_pk_bf16_f32 v127, v62, v63
  v_cndmask_b32_e64 v126, v126, v19, s[60:61]
  v_cndmask_b32_e64 v127, v127, 0, s[60:61]
  s_nop 1
  buffer_store_dwordx4 v[120:123], v2, s[32:35], s49 offen sc1
  buffer_store_dwordx4 v[124:127], v2, s[32:35], s49 offen offset:1024 sc1
  s_waitcnt lgkmcnt(5)
  v_mfma_f32_32x32x16_bf16 v[160:175], v[104:107], v[84:87], v[160:175]
  ds_read_b64_tr_b16 v[92:93], v16 offset:39480
  ds_read_b64_tr_b16 v[94:95], v16 offset:39656
  s_add_u32 s62, s52, 2
  s_and_b32 s56, s62, 15
  s_lshl_b32 s56, s56, 6
  s_add_u32 s56, s56, s54
  s_cmp_lt_u32 s62, 16
  s_cselect_b32 s57, 0x3e8b97f6, 1.0
  s_cselect_b32 s45, 0, 0x3f80
  s_cselect_b32 s46, 11, 12
  s_cselect_b32 s47, 0, 4194304
  s_lshl_b32 s56, s56, s46
  s_add_u32 s53, s56, s47
  v_mov_b32 v19, s45
  v_mul_f32 v64, s57, v64
  v_mul_f32 v65, s57, v65
  v_mul_f32 v66, s57, v66
  v_mul_f32 v67, s57, v67
  v_mul_f32 v68, s57, v68
  v_mul_f32 v69, s57, v69
  v_mul_f32 v70, s57, v70
  v_mul_f32 v71, s57, v71
  v_mul_f32 v72, s57, v72
  v_mul_f32 v73, s57, v73
  v_mul_f32 v74, s57, v74
  s_waitcnt lgkmcnt(5)
  v_mfma_f32_32x32x16_bf16 v[176:191], v[108:111], v[84:87], v[176:191]
  ds_read_b64_tr_b16 v[96:97], v16 offset:39536
  ds_read_b64_tr_b16 v[98:99], v16 offset:39712
  v_mul_f32 v75, s57, v75
  v_mul_f32 v76, s57, v76
  v_mul_f32 v77, s57, v77
  v_mul_f32 v78, s57, v78
  v_mul_f32 v79, s57, v79
  v_cvt_pk_bf16_f32 v128, v64, v65
  v_cvt_pk_bf16_f32 v129, v66, v67
  v_cvt_pk_bf16_f32 v130, v68, v69
  v_cvt_pk_bf16_f32 v131, v70, v71
  v_cvt_pk_bf16_f32 v132, v72, v73
  v_cvt_pk_bf16_f32 v133, v74, v75
  v_cvt_pk_bf16_f32 v134, v76, v77
  v_cvt_pk_bf16_f32 v135, v78, v79
  v_cndmask_b32_e64 v134, v134, v19, s[60:61]
  v_cndmask_b32_e64 v135, v135, 0, s[60:61]
  s_nop 1
  buffer_store_dwordx4 v[128:131], v2, s[32:35], s53 offen sc1
  buffer_store_dwordx4 v[132:135], v2, s[32:35], s53 offen offset:1024 sc1
  s_waitcnt lgkmcnt(4)
  v_mfma_f32_32x32x16_bf16 v[144:159], v[88:91], v[80:83], v[144:159]
  ds_read_b128 v[84:87], v15 offset:49152
  ds_read_b64_tr_b16 v[100:101], v16 offset:42240
  ds_read_b64_tr_b16 v[102:103], v16 offset:42416
  s_waitcnt lgkmcnt(5)
  v_mfma_f32_32x32x16_bf16 v[160:175], v[92:95], v[80:83], v[160:175]
  ds_read_b64_tr_b16 v[104:105], v16 offset:42296
  ds_read_b64_tr_b16 v[106:107], v16 offset:42472
  s_waitcnt lgkmcnt(5)
  v_mfma_f32_32x32x16_bf16 v[176:191], v[96:99], v[80:83], v[176:191]
  ds_read_b64_tr_b16 v[108:109], v16 offset:42352
  ds_read_b64_tr_b16 v[110:111], v16 offset:42528
  s_waitcnt lgkmcnt(0)
  s_barrier
  v_mfma_f32_32x32x16_bf16 v[144:159], v[100:103], v[84:87], v[144:159]
  ds_read_b128 v[80:83], v12 offset:0
  ds_read_b64_tr_b16 v[88:89], v16 offset:0
  ds_read_b64_tr_b16 v[90:91], v16 offset:176
  v_mfma_f32_32x32x16_bf16 v[160:175], v[104:107], v[84:87], v[160:175]
  ds_read_b64_tr_b16 v[92:93], v16 offset:56
  ds_read_b64_tr_b16 v[94:95], v16 offset:232
  v_mfma_f32_32x32x16_bf16 v[176:191], v[108:111], v[84:87], v[176:191]
  ds_read_b64_tr_b16 v[96:97], v16 offset:112
  ds_read_b64_tr_b16 v[98:99], v16 offset:288
  s_waitcnt lgkmcnt(4)
  v_mfma_f32_32x32x16_bf16 v[144:159], v[88:91], v[80:83], v[144:159]
  ds_read_b128 v[84:87], v13 offset:0
  ds_read_b64_tr_b16 v[100:101], v16 offset:2816
  ds_read_b64_tr_b16 v[102:103], v16 offset:2992
  s_waitcnt lgkmcnt(5)
  v_mfma_f32_32x32x16_bf16 v[160:175], v[92:95], v[80:83], v[160:175]
  ds_read_b64_tr_b16 v[104:105], v16 offset:2872
  ds_read_b64_tr_b16 v[106:107], v16 offset:3048
  s_waitcnt lgkmcnt(5)
  v_mfma_f32_32x32x16_bf16 v[176:191], v[96:99], v[80:83], v[176:191]
  ds_read_b64_tr_b16 v[108:109], v16 offset:2928
  ds_read_b64_tr_b16 v[110:111], v16 offset:3104
  s_waitcnt lgkmcnt(4)
  v_mfma_f32_32x32x16_bf16 v[144:159], v[100:103], v[84:87], v[144:159]
  ds_read_b128 v[80:83], v14 offset:0
  ds_read_b64_tr_b16 v[88:89], v16 offset:5632
  ds_read_b64_tr_b16 v[90:91], v16 offset:5808
  s_waitcnt lgkmcnt(5)
  v_mfma_f32_32x32x16_bf16 v[160:175], v[104:107], v[84:87], v[160:175]
  ds_read_b64_tr_b16 v[92:93], v16 offset:5688
  ds_read_b64_tr_b16 v[94:95], v16 offset:5864
  s_waitcnt lgkmcnt(5)
  v_mfma_f32_32x32x16_bf16 v[176:191], v[108:111], v[84:87], v[176:191]
  ds_read_b64_tr_b16 v[96:97], v16 offset:5744
  ds_read_b64_tr_b16 v[98:99], v16 offset:5920
  s_waitcnt lgkmcnt(4)
  v_mfma_f32_32x32x16_bf16 v[144:159], v[88:91], v[80:83], v[144:159]
  ds_read_b128 v[84:87], v15 offset:0
  ds_read_b64_tr_b16 v[100:101], v16 offset:8448
  ds_read_b64_tr_b16 v[102:103], v16 offset:8624
  s_waitcnt lgkmcnt(5)
  v_mfma_f32_32x32x16_bf16 v[160:175], v[92:95], v[80:83], v[160:175]
  ds_read_b64_tr_b16 v[104:105], v16 offset:8504
  ds_read_b64_tr_b16 v[106:107], v16 offset:8680
  s_waitcnt lgkmcnt(5)
  v_mfma_f32_32x32x16_bf16 v[176:191], v[96:99], v[80:83], v[176:191]
  ds_read_b64_tr_b16 v[108:109], v16 offset:8560
  ds_read_b64_tr_b16 v[110:111], v16 offset:8736
  s_waitcnt vmcnt(0) lgkmcnt(0)
  s_barrier
  s_cmp_lg_u32 s3, 0
  s_cbranch_scc1 LsigB_21
  v_readfirstlane_b32 s47, v31
  s_cmp_lg_u32 s47, 0
  s_cbranch_scc1 Linited_22
  s_mov_b32 s68, 200000
Linitspin_23:
  buffer_load_dword v31, v30, s[36:39], 0 offen sc1
  s_waitcnt vmcnt(0)
  v_readfirstlane_b32 s47, v31
  s_cmp_lg_u32 s47, 0
  s_cbranch_scc1 Linited_22
  s_sub_u32 s68, s68, 1
  s_cmp_lg_u32 s68, 0
  s_cbranch_scc1 Linitspin_23
Linited_22:
  s_mov_b64 exec, 1
  v_mov_b32 v1, 1
  s_lshl_b32 s47, s23, 8
  s_add_u32 s47, s47, 4096
  v_mov_b32 v29, s47
  buffer_atomic_add v1, v29, s[64:67], 0 offen sc1
  s_mov_b64 exec, -1
LsigB_21:
  v_mfma_f32_32x32x16_bf16 v[144:159], v[100:103], v[84:87], v[144:159]
  ds_read_b128 v[80:83], v12 offset:16384
  ds_read_b64_tr_b16 v[88:89], v16 offset:11264
  ds_read_b64_tr_b16 v[90:91], v16 offset:11440
  v_mfma_f32_32x32x16_bf16 v[160:175], v[104:107], v[84:87], v[160:175]
  ds_read_b64_tr_b16 v[92:93], v16 offset:11320
  ds_read_b64_tr_b16 v[94:95], v16 offset:11496
  v_mfma_f32_32x32x16_bf16 v[176:191], v[108:111], v[84:87], v[176:191]
  ds_read_b64_tr_b16 v[96:97], v16 offset:11376
  ds_read_b64_tr_b16 v[98:99], v16 offset:11552
  s_waitcnt lgkmcnt(4)
  v_mfma_f32_32x32x16_bf16 v[144:159], v[88:91], v[80:83], v[144:159]
  ds_read_b128 v[84:87], v13 offset:16384
  ds_read_b64_tr_b16 v[100:101], v16 offset:14080
  ds_read_b64_tr_b16 v[102:103], v16 offset:14256
  s_waitcnt lgkmcnt(5)
  v_mfma_f32_32x32x16_bf16 v[160:175], v[92:95], v[80:83], v[160:175]
  ds_read_b64_tr_b16 v[104:105], v16 offset:14136
  ds_read_b64_tr_b16 v[106:107], v16 offset:14312
  s_waitcnt lgkmcnt(5)
  v_mfma_f32_32x32x16_bf16 v[176:191], v[96:99], v[80:83], v[176:191]
  ds_read_b64_tr_b16 v[108:109], v16 offset:14192
  ds_read_b64_tr_b16 v[110:111], v16 offset:14368
  s_waitcnt lgkmcnt(4)
  v_mfma_f32_32x32x16_bf16 v[144:159], v[100:103], v[84:87], v[144:159]
  ds_read_b128 v[80:83], v14 offset:16384
  ds_read_b64_tr_b16 v[88:89], v16 offset:16896
  ds_read_b64_tr_b16 v[90:91], v16 offset:17072
  s_waitcnt lgkmcnt(5)
  v_mfma_f32_32x32x16_bf16 v[160:175], v[104:107], v[84:87], v[160:175]
  ds_read_b64_tr_b16 v[92:93], v16 offset:16952
  ds_read_b64_tr_b16 v[94:95], v16 offset:17128
  s_waitcnt lgkmcnt(5)
  v_mfma_f32_32x32x16_bf16 v[176:191], v[108:111], v[84:87], v[176:191]
  ds_read_b64_tr_b16 v[96:97], v16 offset:17008
  ds_read_b64_tr_b16 v[98:99], v16 offset:17184
  s_waitcnt lgkmcnt(4)
  v_mfma_f32_32x32x16_bf16 v[144:159], v[88:91], v[80:83], v[144:159]
  ds_read_b128 v[84:87], v15 offset:16384
  ds_read_b64_tr_b16 v[100:101], v16 offset:19712
  ds_read_b64_tr_b16 v[102:103], v16 offset:19888
  s_waitcnt lgkmcnt(5)
  v_mfma_f32_32x32x16_bf16 v[160:175], v[92:95], v[80:83], v[160:175]
  ds_read_b64_tr_b16 v[104:105], v16 offset:19768
  ds_read_b64_tr_b16 v[106:107], v16 offset:19944
  s_waitcnt lgkmcnt(5)
  v_mfma_f32_32x32x16_bf16 v[176:191], v[96:99], v[80:83], v[176:191]
  ds_read_b64_tr_b16 v[108:109], v16 offset:19824
  ds_read_b64_tr_b16 v[110:111], v16 offset:20000
  s_waitcnt lgkmcnt(0)
  s_barrier
  v_mfma_f32_32x32x16_bf16 v[144:159], v[100:103], v[84:87], v[144:159]
  ds_read_b128 v[80:83], v12 offset:32768
  ds_read_b64_tr_b16 v[88:89], v16 offset:22528
  ds_read_b64_tr_b16 v[90:91], v16 offset:22704
  v_mfma_f32_32x32x16_bf16 v[160:175], v[104:107], v[84:87], v[160:175]
  ds_read_b64_tr_b16 v[92:93], v16 offset:22584
  ds_read_b64_tr_b16 v[94:95], v16 offset:22760
  v_mfma_f32_32x32x16_bf16 v[176:191], v[108:111], v[84:87], v[176:191]
  ds_read_b64_tr_b16 v[96:97], v16 offset:22640
  ds_read_b64_tr_b16 v[98:99], v16 offset:22816
  s_waitcnt lgkmcnt(4)
  v_mfma_f32_32x32x16_bf16 v[144:159], v[88:91], v[80:83], v[144:159]
  ds_read_b128 v[84:87], v13 offset:32768
  ds_read_b64_tr_b16 v[100:101], v16 offset:25344
  ds_read_b64_tr_b16 v[102:103], v16 offset:25520
  s_waitcnt lgkmcnt(5)
  v_mfma_f32_32x32x16_bf16 v[160:175], v[92:95], v[80:83], v[160:175]
  ds_read_b64_tr_b16 v[104:105], v16 offset:25400
  ds_read_b64_tr_b16 v[106:107], v16 offset:25576
  s_waitcnt lgkmcnt(5)
  v_mfma_f32_32x32x16_bf16 v[176:191], v[96:99], v[80:83], v[176:191]
  ds_read_b64_tr_b16 v[108:109], v16 offset:25456
  ds_read_b64_tr_b16 v[110:111], v16 offset:25632
  s_waitcnt lgkmcnt(4)
  v_mfma_f32_32x32x16_bf16 v[144:159], v[100:103], v[84:87], v[144:159]
  ds_read_b128 v[80:83], v14 offset:32768
  ds_read_b64_tr_b16 v[88:89], v16 offset:28160
  ds_read_b64_tr_b16 v[90:91], v16 offset:28336
  s_waitcnt lgkmcnt(5)
  v_mfma_f32_32x32x16_bf16 v[160:175], v[104:107], v[84:87], v[160:175]
  ds_read_b64_tr_b16 v[92:93], v16 offset:28216
  ds_read_b64_tr_b16 v[94:95], v16 offset:28392
  s_waitcnt lgkmcnt(5)
  v_mfma_f32_32x32x16_bf16 v[176:191], v[108:111], v[84:87], v[176:191]
  ds_read_b64_tr_b16 v[96:97], v16 offset:28272
  ds_read_b64_tr_b16 v[98:99], v16 offset:28448
  s_waitcnt lgkmcnt(4)
  v_mfma_f32_32x32x16_bf16 v[144:159], v[88:91], v[80:83], v[144:159]
  ds_read_b128 v[84:87], v15 offset:32768
  ds_read_b64_tr_b16 v[100:101], v16 offset:30976
  ds_read_b64_tr_b16 v[102:103], v16 offset:31152
  s_waitcnt lgkmcnt(5)
  v_mfma_f32_32x32x16_bf16 v[160:175], v[92:95], v[80:83], v[160:175]
  ds_read_b64_tr_b16 v[104:105], v16 offset:31032
  ds_read_b64_tr_b16 v[106:107], v16 offset:31208
  s_waitcnt lgkmcnt(5)
  v_mfma_f32_32x32x16_bf16 v[176:191], v[96:99], v[80:83], v[176:191]
  ds_read_b64_tr_b16 v[108:109], v16 offset:31088
  ds_read_b64_tr_b16 v[110:111], v16 offset:31264
  s_waitcnt lgkmcnt(0)
  s_barrier
  v_mfma_f32_32x32x16_bf16 v[144:159], v[100:103], v[84:87], v[144:159]
  ds_read_b128 v[80:83], v12 offset:49152
  ds_read_b64_tr_b16 v[88:89], v16 offset:33792
  ds_read_b64_tr_b16 v[90:91], v16 offset:33968
  v_mfma_f32_32x32x16_bf16 v[160:175], v[104:107], v[84:87], v[160:175]
  ds_read_b64_tr_b16 v[92:93], v16 offset:33848
  ds_read_b64_tr_b16 v[94:95], v16 offset:34024
  v_mfma_f32_32x32x16_bf16 v[176:191], v[108:111], v[84:87], v[176:191]
  ds_read_b64_tr_b16 v[96:97], v16 offset:33904
  ds_read_b64_tr_b16 v[98:99], v16 offset:34080
  s_waitcnt lgkmcnt(4)
  v_mfma_f32_32x32x16_bf16 v[144:159], v[88:91], v[80:83], v[144:159]
  ds_read_b128 v[84:87], v13 offset:49152
  ds_read_b64_tr_b16 v[100:101], v16 offset:36608
  ds_read_b64_tr_b16 v[102:103], v16 offset:36784
  s_waitcnt lgkmcnt(5)
  v_mfma_f32_32x32x16_bf16 v[160:175], v[92:95], v[80:83], v[160:175]
  ds_read_b64_tr_b16 v[104:105], v16 offset:36664
  ds_read_b64_tr_b16 v[106:107], v16 offset:36840
  s_waitcnt lgkmcnt(5)
  v_mfma_f32_32x32x16_bf16 v[176:191], v[96:99], v[80:83], v[176:191]
  ds_read_b64_tr_b16 v[108:109], v16 offset:36720
  ds_read_b64_tr_b16 v[110:111], v16 offset:36896
  s_waitcnt lgkmcnt(4)
  v_mfma_f32_32x32x16_bf16 v[144:159], v[100:103], v[84:87], v[144:159]
  ds_read_b128 v[80:83], v14 offset:49152
  ds_read_b64_tr_b16 v[88:89], v16 offset:39424
  ds_read_b64_tr_b16 v[90:91], v16 offset:39600
  s_waitcnt lgkmcnt(5)
  v_mfma_f32_32x32x16_bf16 v[160:175], v[104:107], v[84:87], v[160:175]
  ds_read_b64_tr_b16 v[92:93], v16 offset:39480
  ds_read_b64_tr_b16 v[94:95], v16 offset:39656
  s_waitcnt lgkmcnt(5)
  v_mfma_f32_32x32x16_bf16 v[176:191], v[108:111], v[84:87], v[176:191]
  ds_read_b64_tr_b16 v[96:97], v16 offset:39536
  ds_read_b64_tr_b16 v[98:99], v16 offset:39712
  s_waitcnt lgkmcnt(4)
  v_mfma_f32_32x32x16_bf16 v[144:159], v[88:91], v[80:83], v[144:159]
  ds_read_b128 v[84:87], v15 offset:49152
  ds_read_b64_tr_b16 v[100:101], v16 offset:42240
  ds_read_b64_tr_b16 v[102:103], v16 offset:42416
  s_waitcnt lgkmcnt(5)
  v_mfma_f32_32x32x16_bf16 v[160:175], v[92:95], v[80:83], v[160:175]
  ds_read_b64_tr_b16 v[104:105], v16 offset:42296
  ds_read_b64_tr_b16 v[106:107], v16 offset:42472
  s_waitcnt lgkmcnt(5)
  v_mfma_f32_32x32x16_bf16 v[176:191], v[96:99], v[80:83], v[176:191]
  ds_read_b64_tr_b16 v[108:109], v16 offset:42352
  ds_read_b64_tr_b16 v[110:111], v16 offset:42528
  s_waitcnt lgkmcnt(0)
  s_barrier
  v_mfma_f32_32x32x16_bf16 v[144:159], v[100:103], v[84:87], v[144:159]
  ds_read_b128 v[80:83], v12 offset:0
  ds_read_b64_tr_b16 v[88:89], v16 offset:0
  ds_read_b64_tr_b16 v[90:91], v16 offset:176
  v_mfma_f32_32x32x16_bf16 v[160:175], v[104:107], v[84:87], v[160:175]
  ds_read_b64_tr_b16 v[92:93], v16 offset:56
  ds_read_b64_tr_b16 v[94:95], v16 offset:232
  v_mfma_f32_32x32x16_bf16 v[176:191], v[108:111], v[84:87], v[176:191]
  ds_read_b64_tr_b16 v[96:97], v16 offset:112
  ds_read_b64_tr_b16 v[98:99], v16 offset:288
  s_waitcnt lgkmcnt(4)
  v_mfma_f32_32x32x16_bf16 v[144:159], v[88:91], v[80:83], v[144:159]
  ds_read_b128 v[84:87], v13 offset:0
  ds_read_b64_tr_b16 v[100:101], v16 offset:2816
  ds_read_b64_tr_b16 v[102:103], v16 offset:2992
  s_waitcnt lgkmcnt(5)
  v_mfma_f32_32x32x16_bf16 v[160:175], v[92:95], v[80:83], v[160:175]
  ds_read_b64_tr_b16 v[104:105], v16 offset:2872
  ds_read_b64_tr_b16 v[106:107], v16 offset:3048
  s_waitcnt lgkmcnt(5)
  v_mfma_f32_32x32x16_bf16 v[176:191], v[96:99], v[80:83], v[176:191]
  ds_read_b64_tr_b16 v[108:109], v16 offset:2928
  ds_read_b64_tr_b16 v[110:111], v16 offset:3104
  s_waitcnt lgkmcnt(4)
  v_mfma_f32_32x32x16_bf16 v[144:159], v[100:103], v[84:87], v[144:159]
  ds_read_b128 v[80:83], v14 offset:0
  ds_read_b64_tr_b16 v[88:89], v16 offset:5632
  ds_read_b64_tr_b16 v[90:91], v16 offset:5808
  s_waitcnt lgkmcnt(5)
  v_mfma_f32_32x32x16_bf16 v[160:175], v[104:107], v[84:87], v[160:175]
  ds_read_b64_tr_b16 v[92:93], v16 offset:5688
  ds_read_b64_tr_b16 v[94:95], v16 offset:5864
  s_waitcnt lgkmcnt(5)
  v_mfma_f32_32x32x16_bf16 v[176:191], v[108:111], v[84:87], v[176:191]
  ds_read_b64_tr_b16 v[96:97], v16 offset:5744
  ds_read_b64_tr_b16 v[98:99], v16 offset:5920
  s_waitcnt lgkmcnt(4)
  v_mfma_f32_32x32x16_bf16 v[144:159], v[88:91], v[80:83], v[144:159]
  ds_read_b128 v[84:87], v15 offset:0
  ds_read_b64_tr_b16 v[100:101], v16 offset:8448
  ds_read_b64_tr_b16 v[102:103], v16 offset:8624
  s_waitcnt lgkmcnt(5)
  v_mfma_f32_32x32x16_bf16 v[160:175], v[92:95], v[80:83], v[160:175]
  ds_read_b64_tr_b16 v[104:105], v16 offset:8504
  ds_read_b64_tr_b16 v[106:107], v16 offset:8680
  s_waitcnt lgkmcnt(5)
  v_mfma_f32_32x32x16_bf16 v[176:191], v[96:99], v[80:83], v[176:191]
  ds_read_b64_tr_b16 v[108:109], v16 offset:8560
  ds_read_b64_tr_b16 v[110:111], v16 offset:8736
  s_waitcnt lgkmcnt(0)
  s_barrier
  v_mfma_f32_32x32x16_bf16 v[144:159], v[100:103], v[84:87], v[144:159]
  ds_read_b128 v[80:83], v12 offset:16384
  ds_read_b64_tr_b16 v[88:89], v16 offset:11264
  ds_read_b64_tr_b16 v[90:91], v16 offset:11440
  v_mfma_f32_32x32x16_bf16 v[160:175], v[104:107], v[84:87], v[160:175]
  ds_read_b64_tr_b16 v[92:93], v16 offset:11320
  ds_read_b64_tr_b16 v[94:95], v16 offset:11496
  v_mfma_f32_32x32x16_bf16 v[176:191], v[108:111], v[84:87], v[176:191]
  ds_read_b64_tr_b16 v[96:97], v16 offset:11376
  ds_read_b64_tr_b16 v[98:99], v16 offset:11552
  s_waitcnt lgkmcnt(4)
  v_mfma_f32_32x32x16_bf16 v[144:159], v[88:91], v[80:83], v[144:159]
  ds_read_b128 v[84:87], v13 offset:16384
  ds_read_b64_tr_b16 v[100:101], v16 offset:14080
  ds_read_b64_tr_b16 v[102:103], v16 offset:14256
  s_waitcnt lgkmcnt(5)
  v_mfma_f32_32x32x16_bf16 v[160:175], v[92:95], v[80:83], v[160:175]
  ds_read_b64_tr_b16 v[104:105], v16 offset:14136
  ds_read_b64_tr_b16 v[106:107], v16 offset:14312
  s_waitcnt lgkmcnt(5)
  v_mfma_f32_32x32x16_bf16 v[176:191], v[96:99], v[80:83], v[176:191]
  ds_read_b64_tr_b16 v[108:109], v16 offset:14192
  ds_read_b64_tr_b16 v[110:111], v16 offset:14368
  s_waitcnt lgkmcnt(4)
  v_mfma_f32_32x32x16_bf16 v[144:159], v[100:103], v[84:87], v[144:159]
  ds_read_b128 v[80:83], v14 offset:16384
  ds_read_b64_tr_b16 v[88:89], v16 offset:16896
  ds_read_b64_tr_b16 v[90:91], v16 offset:17072
  s_waitcnt lgkmcnt(5)
  v_mfma_f32_32x32x16_bf16 v[160:175], v[104:107], v[84:87], v[160:175]
  ds_read_b64_tr_b16 v[92:93], v16 offset:16952
  ds_read_b64_tr_b16 v[94:95], v16 offset:17128
  s_waitcnt lgkmcnt(5)
  v_mfma_f32_32x32x16_bf16 v[176:191], v[108:111], v[84:87], v[176:191]
  ds_read_b64_tr_b16 v[96:97], v16 offset:17008
  ds_read_b64_tr_b16 v[98:99], v16 offset:17184
  s_waitcnt lgkmcnt(4)
  v_mfma_f32_32x32x16_bf16 v[144:159], v[88:91], v[80:83], v[144:159]
  ds_read_b128 v[84:87], v15 offset:16384
  ds_read_b64_tr_b16 v[100:101], v16 offset:19712
  ds_read_b64_tr_b16 v[102:103], v16 offset:19888
  s_waitcnt lgkmcnt(5)
  v_mfma_f32_32x32x16_bf16 v[160:175], v[92:95], v[80:83], v[160:175]
  ds_read_b64_tr_b16 v[104:105], v16 offset:19768
  ds_read_b64_tr_b16 v[106:107], v16 offset:19944
  s_waitcnt lgkmcnt(5)
  v_mfma_f32_32x32x16_bf16 v[176:191], v[96:99], v[80:83], v[176:191]
  ds_read_b64_tr_b16 v[108:109], v16 offset:19824
  ds_read_b64_tr_b16 v[110:111], v16 offset:20000
  s_waitcnt lgkmcnt(4)
  v_mfma_f32_32x32x16_bf16 v[144:159], v[100:103], v[84:87], v[144:159]
  s_waitcnt lgkmcnt(2)
  v_mfma_f32_32x32x16_bf16 v[160:175], v[104:107], v[84:87], v[160:175]
  s_waitcnt lgkmcnt(0)
  v_mfma_f32_32x32x16_bf16 v[176:191], v[108:111], v[84:87], v[176:191]
  s_barrier
  s_and_b32 s40, s2, 7
  s_bfe_u32 s41, s2, 0x10003
  s_lshl_b32 s40, s40, 1
  s_add_u32 s40, s40, s41
  s_lshl_b32 s47, s40, 18
  s_add_u32 s47, s47, 8388608
  s_add_u32 s32, s20, s47
  s_addc_u32 s33, s21, 0
  s_mov_b32 s34, 0x40000
  s_mov_b32 s35, 0x20000
  s_lshl_b32 s55, s3, 12
  s_add_u32 s54, s55, 0
  s_add_u32 m0, s55, 0
  s_nop 0
  buffer_load_dwordx4 v2, s[32:35], s54 offen offset:0 lds
  buffer_load_dwordx4 v2, s[32:35], s54 offen offset:1024 lds
  buffer_load_dwordx4 v2, s[32:35], s54 offen offset:2048 lds
  buffer_load_dwordx4 v2, s[32:35], s54 offen offset:3072 lds
  s_add_u32 s54, s55, 32768
  s_add_u32 m0, s55, 32768
  s_nop 0
  buffer_load_dwordx4 v2, s[32:35], s54 offen offset:0 lds
  buffer_load_dwordx4 v2, s[32:35], s54 offen offset:1024 lds
  buffer_load_dwordx4 v2, s[32:35], s54 offen offset:2048 lds
  buffer_load_dwordx4 v2, s[32:35], s54 offen offset:3072 lds
  s_lshl_b32 s54, s22, 2
  s_add_u32 s54, s54, s3
  s_add_u32 s62, s63, 0
  s_and_b32 s56, s62, 15
  s_lshl_b32 s56, s56, 6
  s_add_u32 s56, s56, s54
  s_cmp_lt_u32 s62, 16
  s_cselect_b32 s57, 0x3e8b97f6, 1.0
  s_cselect_b32 s45, 0, 0x3f80
  s_cselect_b32 s46, 11, 12
  s_cselect_b32 s47, 0, 4194304
  s_lshl_b32 s56, s56, s46
  s_add_u32 s48, s56, s47
  v_mov_b32 v19, s45
  v_mul_f32 v144, s57, v144
  v_mul_f32 v145, s57, v145
  v_mul_f32 v146, s57, v146
  v_mul_f32 v147, s57, v147
  v_mul_f32 v148, s57, v148
  v_mul_f32 v149, s57, v149
  v_mul_f32 v150, s57, v150
  v_mul_f32 v151, s57, v151
  v_mul_f32 v152, s57, v152
  v_mul_f32 v153, s57, v153
  v_mul_f32 v154, s57, v154
  v_mul_f32 v155, s57, v155
  v_mul_f32 v156, s57, v156
  v_mul_f32 v157, s57, v157
  v_mul_f32 v158, s57, v158
  v_mul_f32 v159, s57, v159
  v_cvt_pk_bf16_f32 v208, v144, v145
  v_cvt_pk_bf16_f32 v209, v146, v147
  v_cvt_pk_bf16_f32 v210, v148, v149
  v_cvt_pk_bf16_f32 v211, v150, v151
  v_cvt_pk_bf16_f32 v212, v152, v153
  v_cvt_pk_bf16_f32 v213, v154, v155
  v_cvt_pk_bf16_f32 v214, v156, v157
  v_cvt_pk_bf16_f32 v215, v158, v159
  v_cndmask_b32_e64 v214, v214, v19, s[60:61]
  v_cndmask_b32_e64 v215, v215, 0, s[60:61]
  s_add_u32 s62, s63, 1
  s_and_b32 s56, s62, 15
  s_lshl_b32 s56, s56, 6
  s_add_u32 s56, s56, s54
  s_cmp_lt_u32 s62, 16
  s_cselect_b32 s57, 0x3e8b97f6, 1.0
  s_cselect_b32 s45, 0, 0x3f80
  s_cselect_b32 s46, 11, 12
  s_cselect_b32 s47, 0, 4194304
  s_lshl_b32 s56, s56, s46
  s_add_u32 s49, s56, s47
  v_mov_b32 v19, s45
  v_mul_f32 v160, s57, v160
  v_mul_f32 v161, s57, v161
  v_mul_f32 v162, s57, v162
  v_mul_f32 v163, s57, v163
  v_mul_f32 v164, s57, v164
  v_mul_f32 v165, s57, v165
  v_mul_f32 v166, s57, v166
  v_mul_f32 v167, s57, v167
  v_mul_f32 v168, s57, v168
  v_mul_f32 v169, s57, v169
  v_mul_f32 v170, s57, v170
  v_mul_f32 v171, s57, v171
  v_mul_f32 v172, s57, v172
  v_mul_f32 v173, s57, v173
  v_mul_f32 v174, s57, v174
  v_mul_f32 v175, s57, v175
  v_cvt_pk_bf16_f32 v216, v160, v161
  v_cvt_pk_bf16_f32 v217, v162, v163
  v_cvt_pk_bf16_f32 v218, v164, v165
  v_cvt_pk_bf16_f32 v219, v166, v167
  v_cvt_pk_bf16_f32 v220, v168, v169
  v_cvt_pk_bf16_f32 v221, v170, v171
  v_cvt_pk_bf16_f32 v222, v172, v173
  v_cvt_pk_bf16_f32 v223, v174, v175
  v_cndmask_b32_e64 v222, v222, v19, s[60:61]
  v_cndmask_b32_e64 v223, v223, 0, s[60:61]
  s_add_u32 s62, s63, 2
  s_and_b32 s56, s62, 15
  s_lshl_b32 s56, s56, 6
  s_add_u32 s56, s56, s54
  s_cmp_lt_u32 s62, 16
  s_cselect_b32 s57, 0x3e8b97f6, 1.0
  s_cselect_b32 s45, 0, 0x3f80
  s_cselect_b32 s46, 11, 12
  s_cselect_b32 s47, 0, 4194304
  s_lshl_b32 s56, s56, s46
  s_add_u32 s53, s56, s47
  v_mov_b32 v19, s45
  v_mul_f32 v176, s57, v176
  v_mul_f32 v177, s57, v177
  v_mul_f32 v178, s57, v178
  v_mul_f32 v179, s57, v179
  v_mul_f32 v180, s57, v180
  v_mul_f32 v181, s57, v181
  v_mul_f32 v182, s57, v182
  v_mul_f32 v183, s57, v183
  v_mul_f32 v184, s57, v184
  v_mul_f32 v185, s57, v185
  v_mul_f32 v186, s57, v186
  v_mul_f32 v187, s57, v187
  v_mul_f32 v188, s57, v188
  v_mul_f32 v189, s57, v189
  v_mul_f32 v190, s57, v190
  v_mul_f32 v191, s57, v191
  v_cvt_pk_bf16_f32 v224, v176, v177
  v_cvt_pk_bf16_f32 v225, v178, v179
  v_cvt_pk_bf16_f32 v226, v180, v181
  v_cvt_pk_bf16_f32 v227, v182, v183
  v_cvt_pk_bf16_f32 v228, v184, v185
  v_cvt_pk_bf16_f32 v229, v186, v187
  v_cvt_pk_bf16_f32 v230, v188, v189
  v_cvt_pk_bf16_f32 v231, v190, v191
  v_cndmask_b32_e64 v230, v230, v19, s[60:61]
  v_cndmask_b32_e64 v231, v231, 0, s[60:61]
  s_branch Lqkv_fin
Lqkv_v1:
  s_barrier
  ds_read_b128 v[80:83], v12 offset:0
  ds_read_b64_tr_b16 v[88:89], v16 offset:0
  ds_read_b64_tr_b16 v[90:91], v16 offset:176
  ds_read_b64_tr_b16 v[92:93], v16 offset:56
  ds_read_b64_tr_b16 v[94:95], v16 offset:232
  ds_read_b64_tr_b16 v[96:97], v16 offset:112
  ds_read_b64_tr_b16 v[98:99], v16 offset:288
  s_cmp_ge_u32 s3, 2
  s_cbranch_scc1 Lpf5_24
  s_cmp_eq_u32 s3, 0
  s_cselect_b32 s24, s8, s14
  s_cselect_b32 s25, s9, s15
  s_mov_b32 s26, 401408
  s_mov_b32 s27, 0x20000
  s_mul_i32 s46, s2, 1568
  v_add_u32 v20, s46, v2
  buffer_load_dwordx4 v[168:171], v20, s[24:27], 0 offen offset:0
  buffer_load_dwordx4 v[172:175], v20, s[24:27], 0 offen offset:1024
Lpf5_24:
  s_waitcnt lgkmcnt(4)
  v_mfma_f32_32x32x16_bf16 v[32:47], v[88:91], v[80:83], 0
  ds_read_b128 v[84:87], v13 offset:0
  ds_read_b64_tr_b16 v[100:101], v16 offset:2816
  ds_read_b64_tr_b16 v[102:103], v16 offset:2992
  s_waitcnt lgkmcnt(5)
  v_mfma_f32_32x32x16_bf16 v[48:63], v[92:95], v[80:83], 0
  ds_read_b64_tr_b16 v[104:105], v16 offset:2872
  ds_read_b64_tr_b16 v[106:107], v16 offset:3048
  s_waitcnt lgkmcnt(5)
  v_mfma_f32_32x32x16_bf16 v[64:79], v[96:99], v[80:83], 0
  ds_read_b64_tr_b16 v[108:109], v16 offset:2928
  ds_read_b64_tr_b16 v[110:111], v16 offset:3104
  s_waitcnt lgkmcnt(4)
  v_mfma_f32_32x32x16_bf16 v[32:47], v[100:103], v[84:87], v[32:47]
  ds_read_b128 v[80:83], v14 offset:0
  ds_read_b64_tr_b16 v[88:89], v16 offset:5632
  ds_read_b64_tr_b16 v[90:91], v16 offset:5808
  s_waitcnt lgkmcnt(5)
  v_mfma_f32_32x32x16_bf16 v[48:63], v[104:107], v[84:87], v[48:63]
  ds_read_b64_tr_b16 v[92:93], v16 offset:5688
  ds_read_b64_tr_b16 v[94:95], v16 offset:5864
  s_waitcnt lgkmcnt(5)
  v_mfma_f32_32x32x16_bf16 v[64:79], v[108:111], v[84:87], v[64:79]
  ds_read_b64_tr_b16 v[96:97], v16 offset:5744
  ds_read_b64_tr_b16 v[98:99], v16 offset:5920
  s_waitcnt lgkmcnt(4)
  v_mfma_f32_32x32x16_bf16 v[32:47], v[88:91], v[80:83], v[32:47]
  ds_read_b128 v[84:87], v15 offset:0
  ds_read_b64_tr_b16 v[100:101], v16 offset:8448
  ds_read_b64_tr_b16 v[102:103], v16 offset:8624
  s_waitcnt lgkmcnt(5)
  v_mfma_f32_32x32x16_bf16 v[48:63], v[92:95], v[80:83], v[48:63]
  ds_read_b64_tr_b16 v[104:105], v16 offset:8504
  ds_read_b64_tr_b16 v[106:107], v16 offset:8680
  s_waitcnt lgkmcnt(5)
  v_mfma_f32_32x32x16_bf16 v[64:79], v[96:99], v[80:83], v[64:79]
  ds_read_b64_tr_b16 v[108:109], v16 offset:8560
  ds_read_b64_tr_b16 v[110:111], v16 offset:8736
  s_waitcnt lgkmcnt(0)
  s_barrier
  v_mfma_f32_32x32x16_bf16 v[32:47], v[100:103], v[84:87], v[32:47]
  ds_read_b128 v[80:83], v12 offset:16384
  ds_read_b64_tr_b16 v[88:89], v16 offset:11264
  ds_read_b64_tr_b16 v[90:91], v16 offset:11440
  v_mfma_f32_32x32x16_bf16 v[48:63], v[104:107], v[84:87], v[48:63]
  ds_read_b64_tr_b16 v[92:93], v16 offset:11320
  ds_read_b64_tr_b16 v[94:95], v16 offset:11496
  v_mfma_f32_32x32x16_bf16 v[64:79], v[108:111], v[84:87], v[64:79]
  ds_read_b64_tr_b16 v[96:97], v16 offset:11376
  ds_read_b64_tr_b16 v[98:99], v16 offset:11552
  s_waitcnt lgkmcnt(4)
  v_mfma_f32_32x32x16_bf16 v[32:47], v[88:91], v[80:83], v[32:47]
  ds_read_b128 v[84:87], v13 offset:16384
  ds_read_b64_tr_b16 v[100:101], v16 offset:14080
  ds_read_b64_tr_b16 v[102:103], v16 offset:14256
  s_waitcnt lgkmcnt(5)
  v_mfma_f32_32x32x16_bf16 v[48:63], v[92:95], v[80:83], v[48:63]
  ds_read_b64_tr_b16 v[104:105], v16 offset:14136
  ds_read_b64_tr_b16 v[106:107], v16 offset:14312
  s_waitcnt lgkmcnt(5)
  v_mfma_f32_32x32x16_bf16 v[64:79], v[96:99], v[80:83], v[64:79]
  ds_read_b64_tr_b16 v[108:109], v16 offset:14192
  ds_read_b64_tr_b16 v[110:111], v16 offset:14368
  s_waitcnt lgkmcnt(4)
  v_mfma_f32_32x32x16_bf16 v[32:47], v[100:103], v[84:87], v[32:47]
  ds_read_b128 v[80:83], v14 offset:16384
  ds_read_b64_tr_b16 v[88:89], v16 offset:16896
  ds_read_b64_tr_b16 v[90:91], v16 offset:17072
  s_waitcnt lgkmcnt(5)
  v_mfma_f32_32x32x16_bf16 v[48:63], v[104:107], v[84:87], v[48:63]
  ds_read_b64_tr_b16 v[92:93], v16 offset:16952
  ds_read_b64_tr_b16 v[94:95], v16 offset:17128
  s_waitcnt lgkmcnt(5)
  v_mfma_f32_32x32x16_bf16 v[64:79], v[108:111], v[84:87], v[64:79]
  ds_read_b64_tr_b16 v[96:97], v16 offset:17008
  ds_read_b64_tr_b16 v[98:99], v16 offset:17184
  s_waitcnt lgkmcnt(4)
  v_mfma_f32_32x32x16_bf16 v[32:47], v[88:91], v[80:83], v[32:47]
  ds_read_b128 v[84:87], v15 offset:16384
  ds_read_b64_tr_b16 v[100:101], v16 offset:19712
  ds_read_b64_tr_b16 v[102:103], v16 offset:19888
  s_waitcnt lgkmcnt(5)
  v_mfma_f32_32x32x16_bf16 v[48:63], v[92:95], v[80:83], v[48:63]
  ds_read_b64_tr_b16 v[104:105], v16 offset:19768
  ds_read_b64_tr_b16 v[106:107], v16 offset:19944
  s_waitcnt lgkmcnt(5)
  v_mfma_f32_32x32x16_bf16 v[64:79], v[96:99], v[80:83], v[64:79]
  ds_read_b64_tr_b16 v[108:109], v16 offset:19824
  ds_read_b64_tr_b16 v[110:111], v16 offset:20000
  s_waitcnt lgkmcnt(0)
  s_barrier
  v_mfma_f32_32x32x16_bf16 v[32:47], v[100:103], v[84:87], v[32:47]
  ds_read_b128 v[80:83], v12 offset:32768
  ds_read_b64_tr_b16 v[88:89], v16 offset:22528
  ds_read_b64_tr_b16 v[90:91], v16 offset:22704
  v_mfma_f32_32x32x16_bf16 v[48:63], v[104:107], v[84:87], v[48:63]
  ds_read_b64_tr_b16 v[92:93], v16 offset:22584
  ds_read_b64_tr_b16 v[94:95], v16 offset:22760
  v_mfma_f32_32x32x16_bf16 v[64:79], v[108:111], v[84:87], v[64:79]
  ds_read_b64_tr_b16 v[96:97], v16 offset:22640
  ds_read_b64_tr_b16 v[98:99], v16 offset:22816
  s_waitcnt lgkmcnt(4)
  v_mfma_f32_32x32x16_bf16 v[32:47], v[88:91], v[80:83], v[32:47]
  ds_read_b128 v[84:87], v13 offset:32768
  ds_read_b64_tr_b16 v[100:101], v16 offset:25344
  ds_read_b64_tr_b16 v[102:103], v16 offset:25520
  s_waitcnt lgkmcnt(5)
  v_mfma_f32_32x32x16_bf16 v[48:63], v[92:95], v[80:83], v[48:63]
  ds_read_b64_tr_b16 v[104:105], v16 offset:25400
  ds_read_b64_tr_b16 v[106:107], v16 offset:25576
  s_waitcnt lgkmcnt(5)
  v_mfma_f32_32x32x16_bf16 v[64:79], v[96:99], v[80:83], v[64:79]
  ds_read_b64_tr_b16 v[108:109], v16 offset:25456
  ds_read_b64_tr_b16 v[110:111], v16 offset:25632
  s_waitcnt lgkmcnt(4)
  v_mfma_f32_32x32x16_bf16 v[32:47], v[100:103], v[84:87], v[32:47]
  ds_read_b128 v[80:83], v14 offset:32768
  ds_read_b64_tr_b16 v[88:89], v16 offset:28160
  ds_read_b64_tr_b16 v[90:91], v16 offset:28336
  s_waitcnt lgkmcnt(5)
  v_mfma_f32_32x32x16_bf16 v[48:63], v[104:107], v[84:87], v[48:63]
  ds_read_b64_tr_b16 v[92:93], v16 offset:28216
  ds_read_b64_tr_b16 v[94:95], v16 offset:28392
  s_waitcnt lgkmcnt(5)
  v_mfma_f32_32x32x16_bf16 v[64:79], v[108:111], v[84:87], v[64:79]
  ds_read_b64_tr_b16 v[96:97], v16 offset:28272
  ds_read_b64_tr_b16 v[98:99], v16 offset:28448
  s_waitcnt lgkmcnt(4)
  v_mfma_f32_32x32x16_bf16 v[32:47], v[88:91], v[80:83], v[32:47]
  ds_read_b128 v[84:87], v15 offset:32768
  ds_read_b64_tr_b16 v[100:101], v16 offset:30976
  ds_read_b64_tr_b16 v[102:103], v16 offset:31152
  s_waitcnt lgkmcnt(5)
  v_mfma_f32_32x32x16_bf16 v[48:63], v[92:95], v[80:83], v[48:63]
  ds_read_b64_tr_b16 v[104:105], v16 offset:31032
  ds_read_b64_tr_b16 v[106:107], v16 offset:31208
  s_waitcnt lgkmcnt(5)
  v_mfma_f32_32x32x16_bf16 v[64:79], v[96:99], v[80:83], v[64:79]
  ds_read_b64_tr_b16 v[108:109], v16 offset:31088
  ds_read_b64_tr_b16 v[110:111], v16 offset:31264
  s_waitcnt lgkmcnt(0)
  s_barrier
  v_mfma_f32_32x32x16_bf16 v[32:47], v[100:103], v[84:87], v[32:47]
  ds_read_b128 v[80:83], v12 offset:49152
  ds_read_b64_tr_b16 v[88:89], v16 offset:33792
  ds_read_b64_tr_b16 v[90:91], v16 offset:33968
  v_mfma_f32_32x32x16_bf16 v[48:63], v[104:107], v[84:87], v[48:63]
  ds_read_b64_tr_b16 v[92:93], v16 offset:33848
  ds_read_b64_tr_b16 v[94:95], v16 offset:34024
  v_mfma_f32_32x32x16_bf16 v[64:79], v[108:111], v[84:87], v[64:79]
  ds_read_b64_tr_b16 v[96:97], v16 offset:33904
  ds_read_b64_tr_b16 v[98:99], v16 offset:34080
  s_waitcnt lgkmcnt(4)
  v_mfma_f32_32x32x16_bf16 v[32:47], v[88:91], v[80:83], v[32:47]
  ds_read_b128 v[84:87], v13 offset:49152
  ds_read_b64_tr_b16 v[100:101], v16 offset:36608
  ds_read_b64_tr_b16 v[102:103], v16 offset:36784
  s_waitcnt lgkmcnt(5)
  v_mfma_f32_32x32x16_bf16 v[48:63], v[92:95], v[80:83], v[48:63]
  ds_read_b64_tr_b16 v[104:105], v16 offset:36664
  ds_read_b64_tr_b16 v[106:107], v16 offset:36840
  s_waitcnt lgkmcnt(5)
  v_mfma_f32_32x32x16_bf16 v[64:79], v[96:99], v[80:83], v[64:79]
  ds_read_b64_tr_b16 v[108:109], v16 offset:36720
  ds_read_b64_tr_b16 v[110:111], v16 offset:36896
  s_waitcnt lgkmcnt(4)
  v_mfma_f32_32x32x16_bf16 v[32:47], v[100:103], v[84:87], v[32:47]
  ds_read_b128 v[80:83], v14 offset:49152
  ds_read_b64_tr_b16 v[88:89], v16 offset:39424
  ds_read_b64_tr_b16 v[90:91], v16 offset:39600
  s_waitcnt lgkmcnt(5)
  v_mfma_f32_32x32x16_bf16 v[48:63], v[104:107], v[84:87], v[48:63]
  ds_read_b64_tr_b16 v[92:93], v16 offset:39480
  ds_read_b64_tr_b16 v[94:95], v16 offset:39656
  s_waitcnt lgkmcnt(5)
  v_mfma_f32_32x32x16_bf16 v[64:79], v[108:111], v[84:87], v[64:79]
  ds_read_b64_tr_b16 v[96:97], v16 offset:39536
  ds_read_b64_tr_b16 v[98:99], v16 offset:39712
  s_waitcnt lgkmcnt(4)
  v_mfma_f32_32x32x16_bf16 v[32:47], v[88:91], v[80:83], v[32:47]
  ds_read_b128 v[84:87], v15 offset:49152
  ds_read_b64_tr_b16 v[100:101], v16 offset:42240
  ds_read_b64_tr_b16 v[102:103], v16 offset:42416
  s_waitcnt lgkmcnt(5)
  v_mfma_f32_32x32x16_bf16 v[48:63], v[92:95], v[80:83], v[48:63]
  ds_read_b64_tr_b16 v[104:105], v16 offset:42296
  ds_read_b64_tr_b16 v[106:107], v16 offset:42472
  s_waitcnt lgkmcnt(5)
  v_mfma_f32_32x32x16_bf16 v[64:79], v[96:99], v[80:83], v[64:79]
  ds_read_b64_tr_b16 v[108:109], v16 offset:42352
  ds_read_b64_tr_b16 v[110:111], v16 offset:42528
  s_waitcnt lgkmcnt(0)
  s_barrier
  v_mfma_f32_32x32x16_bf16 v[32:47], v[100:103], v[84:87], v[32:47]
  ds_read_b128 v[80:83], v12 offset:0
  ds_read_b64_tr_b16 v[88:89], v16 offset:0
  ds_read_b64_tr_b16 v[90:91], v16 offset:176
  v_mfma_f32_32x32x16_bf16 v[48:63], v[104:107], v[84:87], v[48:63]
  ds_read_b64_tr_b16 v[92:93], v16 offset:56
  ds_read_b64_tr_b16 v[94:95], v16 offset:232
  v_mfma_f32_32x32x16_bf16 v[64:79], v[108:111], v[84:87], v[64:79]
  ds_read_b64_tr_b16 v[96:97], v16 offset:112
  ds_read_b64_tr_b16 v[98:99], v16 offset:288
  s_waitcnt lgkmcnt(4)
  v_mfma_f32_32x32x16_bf16 v[32:47], v[88:91], v[80:83], v[32:47]
  ds_read_b128 v[84:87], v13 offset:0
  ds_read_b64_tr_b16 v[100:101], v16 offset:2816
  ds_read_b64_tr_b16 v[102:103], v16 offset:2992
  s_waitcnt lgkmcnt(5)
  v_mfma_f32_32x32x16_bf16 v[48:63], v[92:95], v[80:83], v[48:63]
  ds_read_b64_tr_b16 v[104:105], v16 offset:2872
  ds_read_b64_tr_b16 v[106:107], v16 offset:3048
  s_waitcnt lgkmcnt(5)
  v_mfma_f32_32x32x16_bf16 v[64:79], v[96:99], v[80:83], v[64:79]
  ds_read_b64_tr_b16 v[108:109], v16 offset:2928
  ds_read_b64_tr_b16 v[110:111], v16 offset:3104
  s_waitcnt lgkmcnt(4)
  v_mfma_f32_32x32x16_bf16 v[32:47], v[100:103], v[84:87], v[32:47]
  ds_read_b128 v[80:83], v14 offset:0
  ds_read_b64_tr_b16 v[88:89], v16 offset:5632
  ds_read_b64_tr_b16 v[90:91], v16 offset:5808
  s_waitcnt lgkmcnt(5)
  v_mfma_f32_32x32x16_bf16 v[48:63], v[104:107], v[84:87], v[48:63]
  ds_read_b64_tr_b16 v[92:93], v16 offset:5688
  ds_read_b64_tr_b16 v[94:95], v16 offset:5864
  s_waitcnt lgkmcnt(5)
  v_mfma_f32_32x32x16_bf16 v[64:79], v[108:111], v[84:87], v[64:79]
  ds_read_b64_tr_b16 v[96:97], v16 offset:5744
  ds_read_b64_tr_b16 v[98:99], v16 offset:5920
  s_waitcnt lgkmcnt(4)
  v_mfma_f32_32x32x16_bf16 v[32:47], v[88:91], v[80:83], v[32:47]
  ds_read_b128 v[84:87], v15 offset:0
  ds_read_b64_tr_b16 v[100:101], v16 offset:8448
  ds_read_b64_tr_b16 v[102:103], v16 offset:8624
  s_waitcnt lgkmcnt(5)
  v_mfma_f32_32x32x16_bf16 v[48:63], v[92:95], v[80:83], v[48:63]
  ds_read_b64_tr_b16 v[104:105], v16 offset:8504
  ds_read_b64_tr_b16 v[106:107], v16 offset:8680
  s_waitcnt lgkmcnt(5)
  v_mfma_f32_32x32x16_bf16 v[64:79], v[96:99], v[80:83], v[64:79]
  ds_read_b64_tr_b16 v[108:109], v16 offset:8560
  ds_read_b64_tr_b16 v[110:111], v16 offset:8736
  s_waitcnt lgkmcnt(0)
  s_barrier
  v_mfma_f32_32x32x16_bf16 v[32:47], v[100:103], v[84:87], v[32:47]
  ds_read_b128 v[80:83], v12 offset:16384
  ds_read_b64_tr_b16 v[88:89], v16 offset:11264
  ds_read_b64_tr_b16 v[90:91], v16 offset:11440
  v_mfma_f32_32x32x16_bf16 v[48:63], v[104:107], v[84:87], v[48:63]
  ds_read_b64_tr_b16 v[92:93], v16 offset:11320
  ds_read_b64_tr_b16 v[94:95], v16 offset:11496
  v_mfma_f32_32x32x16_bf16 v[64:79], v[108:111], v[84:87], v[64:79]
  ds_read_b64_tr_b16 v[96:97], v16 offset:11376
  ds_read_b64_tr_b16 v[98:99], v16 offset:11552
  s_waitcnt lgkmcnt(4)
  v_mfma_f32_32x32x16_bf16 v[32:47], v[88:91], v[80:83], v[32:47]
  ds_read_b128 v[84:87], v13 offset:16384
  ds_read_b64_tr_b16 v[100:101], v16 offset:14080
  ds_read_b64_tr_b16 v[102:103], v16 offset:14256
  s_waitcnt lgkmcnt(5)
  v_mfma_f32_32x32x16_bf16 v[48:63], v[92:95], v[80:83], v[48:63]
  ds_read_b64_tr_b16 v[104:105], v16 offset:14136
  ds_read_b64_tr_b16 v[106:107], v16 offset:14312
  s_waitcnt lgkmcnt(5)
  v_mfma_f32_32x32x16_bf16 v[64:79], v[96:99], v[80:83], v[64:79]
  ds_read_b64_tr_b16 v[108:109], v16 offset:14192
  ds_read_b64_tr_b16 v[110:111], v16 offset:14368
  s_waitcnt lgkmcnt(4)
  v_mfma_f32_32x32x16_bf16 v[32:47], v[100:103], v[84:87], v[32:47]
  ds_read_b128 v[80:83], v14 offset:16384
  ds_read_b64_tr_b16 v[88:89], v16 offset:16896
  ds_read_b64_tr_b16 v[90:91], v16 offset:17072
  s_waitcnt lgkmcnt(5)
  v_mfma_f32_32x32x16_bf16 v[48:63], v[104:107], v[84:87], v[48:63]
  ds_read_b64_tr_b16 v[92:93], v16 offset:16952
  ds_read_b64_tr_b16 v[94:95], v16 offset:17128
  s_waitcnt lgkmcnt(5)
  v_mfma_f32_32x32x16_bf16 v[64:79], v[108:111], v[84:87], v[64:79]
  ds_read_b64_tr_b16 v[96:97], v16 offset:17008
  ds_read_b64_tr_b16 v[98:99], v16 offset:17184
  s_waitcnt lgkmcnt(4)
  v_mfma_f32_32x32x16_bf16 v[32:47], v[88:91], v[80:83], v[32:47]
  ds_read_b128 v[84:87], v15 offset:16384
  ds_read_b64_tr_b16 v[100:101], v16 offset:19712
  ds_read_b64_tr_b16 v[102:103], v16 offset:19888
  s_waitcnt lgkmcnt(5)
  v_mfma_f32_32x32x16_bf16 v[48:63], v[92:95], v[80:83], v[48:63]
  ds_read_b64_tr_b16 v[104:105], v16 offset:19768
  ds_read_b64_tr_b16 v[106:107], v16 offset:19944
  s_waitcnt lgkmcnt(5)
  v_mfma_f32_32x32x16_bf16 v[64:79], v[96:99], v[80:83], v[64:79]
  ds_read_b64_tr_b16 v[108:109], v16 offset:19824
  ds_read_b64_tr_b16 v[110:111], v16 offset:20000
  s_waitcnt vmcnt(0) lgkmcnt(0)
  s_barrier
  v_mfma_f32_32x32x16_bf16 v[32:47], v[100:103], v[84:87], v[32:47]
  ds_read_b128 v[80:83], v12 offset:32768
  ds_read_b64_tr_b16 v[88:89], v16 offset:22528
  ds_read_b64_tr_b16 v[90:91], v16 offset:22704
  v_mfma_f32_32x32x16_bf16 v[48:63], v[104:107], v[84:87], v[48:63]
  ds_read_b64_tr_b16 v[92:93], v16 offset:22584
  ds_read_b64_tr_b16 v[94:95], v16 offset:22760
  v_mfma_f32_32x32x16_bf16 v[64:79], v[108:111], v[84:87], v[64:79]
  ds_read_b64_tr_b16 v[96:97], v16 offset:22640
  ds_read_b64_tr_b16 v[98:99], v16 offset:22816
  s_waitcnt lgkmcnt(4)
  v_mfma_f32_32x32x16_bf16 v[32:47], v[88:91], v[80:83], v[32:47]
  ds_read_b128 v[84:87], v13 offset:32768
  ds_read_b64_tr_b16 v[100:101], v16 offset:25344
  ds_read_b64_tr_b16 v[102:103], v16 offset:25520
  s_waitcnt lgkmcnt(5)
  v_mfma_f32_32x32x16_bf16 v[48:63], v[92:95], v[80:83], v[48:63]
  ds_read_b64_tr_b16 v[104:105], v16 offset:25400
  ds_read_b64_tr_b16 v[106:107], v16 offset:25576
  s_waitcnt lgkmcnt(5)
  v_mfma_f32_32x32x16_bf16 v[64:79], v[96:99], v[80:83], v[64:79]
  ds_read_b64_tr_b16 v[108:109], v16 offset:25456
  ds_read_b64_tr_b16 v[110:111], v16 offset:25632
  s_waitcnt lgkmcnt(4)
  v_mfma_f32_32x32x16_bf16 v[32:47], v[100:103], v[84:87], v[32:47]
  ds_read_b128 v[80:83], v14 offset:32768
  ds_read_b64_tr_b16 v[88:89], v16 offset:28160
  ds_read_b64_tr_b16 v[90:91], v16 offset:28336
  s_waitcnt lgkmcnt(5)
  v_mfma_f32_32x32x16_bf16 v[48:63], v[104:107], v[84:87], v[48:63]
  ds_read_b64_tr_b16 v[92:93], v16 offset:28216
  ds_read_b64_tr_b16 v[94:95], v16 offset:28392
  s_waitcnt lgkmcnt(5)
  v_mfma_f32_32x32x16_bf16 v[64:79], v[108:111], v[84:87], v[64:79]
  ds_read_b64_tr_b16 v[96:97], v16 offset:28272
  ds_read_b64_tr_b16 v[98:99], v16 offset:28448
  s_waitcnt lgkmcnt(4)
  v_mfma_f32_32x32x16_bf16 v[32:47], v[88:91], v[80:83], v[32:47]
  ds_read_b128 v[84:87], v15 offset:32768
  ds_read_b64_tr_b16 v[100:101], v16 offset:30976
  ds_read_b64_tr_b16 v[102:103], v16 offset:31152
  s_waitcnt lgkmcnt(5)
  v_mfma_f32_32x32x16_bf16 v[48:63], v[92:95], v[80:83], v[48:63]
  ds_read_b64_tr_b16 v[104:105], v16 offset:31032
  ds_read_b64_tr_b16 v[106:107], v16 offset:31208
  s_waitcnt lgkmcnt(5)
  v_mfma_f32_32x32x16_bf16 v[64:79], v[96:99], v[80:83], v[64:79]
  ds_read_b64_tr_b16 v[108:109], v16 offset:31088
  ds_read_b64_tr_b16 v[110:111], v16 offset:31264
  s_waitcnt lgkmcnt(0)
  s_barrier
  v_mfma_f32_32x32x16_bf16 v[32:47], v[100:103], v[84:87], v[32:47]
  ds_read_b128 v[80:83], v12 offset:49152
  ds_read_b64_tr_b16 v[88:89], v16 offset:33792
  ds_read_b64_tr_b16 v[90:91], v16 offset:33968
  v_mfma_f32_32x32x16_bf16 v[48:63], v[104:107], v[84:87], v[48:63]
  ds_read_b64_tr_b16 v[92:93], v16 offset:33848
  ds_read_b64_tr_b16 v[94:95], v16 offset:34024
  v_mfma_f32_32x32x16_bf16 v[64:79], v[108:111], v[84:87], v[64:79]
  ds_read_b64_tr_b16 v[96:97], v16 offset:33904
  ds_read_b64_tr_b16 v[98:99], v16 offset:34080
  s_waitcnt lgkmcnt(4)
  v_mfma_f32_32x32x16_bf16 v[144:159], v[88:91], v[80:83], 0
  ds_read_b128 v[84:87], v13 offset:49152
  ds_read_b64_tr_b16 v[100:101], v16 offset:36608
  ds_read_b64_tr_b16 v[102:103], v16 offset:36784
  s_nop 7
  s_lshl_b32 s54, s22, 2
  s_add_u32 s54, s54, s3
  s_add_u32 s54, s54, 1024
  s_add_u32 s62, s52, 0
  s_and_b32 s56, s62, 15
  s_lshl_b32 s56, s56, 6
  s_add_u32 s56, s56, s54
  s_cmp_lt_u32 s62, 16
  s_cselect_b32 s57, 0x3e8b97f6, 1.0
  s_cselect_b32 s45, 0, 0x3f80
  s_cselect_b32 s46, 11, 12
  s_cselect_b32 s47, 0, 4194304
  s_lshl_b32 s56, s56, s46
  s_add_u32 s48, s56, s47
  v_mov_b32 v19, s45
  v_mul_f32 v32, s57, v32
  v_mul_f32 v33, s57, v33
  v_mul_f32 v34, s57, v34
  v_mul_f32 v35, s57, v35
  v_mul_f32 v36, s57, v36
  v_mul_f32 v37, s57, v37
  v_mul_f32 v38, s57, v38
  s_waitcnt lgkmcnt(5)
  v_mfma_f32_32x32x16_bf16 v[160:175], v[92:95], v[80:83], 0
  ds_read_b64_tr_b16 v[104:105], v16 offset:36664
  ds_read_b64_tr_b16 v[106:107], v16 offset:36840
  v_mul_f32 v39, s57, v39
  v_mul_f32 v40, s57, v40
  v_mul_f32 v41, s57, v41
  v_mul_f32 v42, s57, v42
  v_mul_f32 v43, s57, v43
  v_mul_f32 v44, s57, v44
  v_mul_f32 v45, s57, v45
  v_mul_f32 v46, s57, v46
  v_mul_f32 v47, s57, v47
  v_cvt_pk_bf16_f32 v112, v32, v33
  v_cvt_pk_bf16_f32 v113, v34, v35
  v_cvt_pk_bf16_f32 v114, v36, v37
  v_cvt_pk_bf16_f32 v115, v38, v39
  v_cvt_pk_bf16_f32 v116, v40, v41
  v_cvt_pk_bf16_f32 v117, v42, v43
  v_cvt_pk_bf16_f32 v118, v44, v45
  v_cvt_pk_bf16_f32 v119, v46, v47
  v_cndmask_b32_e64 v118, v118, v19, s[60:61]
  v_cndmask_b32_e64 v119, v119, 0, s[60:61]
  s_waitcnt lgkmcnt(5)
  v_mfma_f32_32x32x16_bf16 v[176:191], v[80:83], v[96:99], 0
  ds_read_b64_tr_b16 v[108:109], v16 offset:36720
  ds_read_b64_tr_b16 v[110:111], v16 offset:36896
  s_nop 1
  buffer_store_dwordx4 v[112:115], v2, s[32:35], s48 offen sc1
  buffer_store_dwordx4 v[116:119], v2, s[32:35], s48 offen offset:1024 sc1
  s_add_u32 s62, s52, 1
  s_and_b32 s56, s62, 15
  s_lshl_b32 s56, s56, 6
  s_add_u32 s56, s56, s54
  s_cmp_lt_u32 s62, 16
  s_cselect_b32 s57, 0x3e8b97f6, 1.0
  s_cselect_b32 s45, 0, 0x3f80
  s_cselect_b32 s46, 11, 12
  s_cselect_b32 s47, 0, 4194304
  s_lshl_b32 s56, s56, s46
  s_add_u32 s49, s56, s47
  v_mov_b32 v19, s45
  v_mul_f32 v48, s57, v48
  v_mul_f32 v49, s57, v49
  v_mul_f32 v50, s57, v50
  v_mul_f32 v51, s57, v51
  v_mul_f32 v52, s57, v52
  v_mul_f32 v53, s57, v53
  v_mul_f32 v54, s57, v54
  v_mul_f32 v55, s57, v55
  v_mul_f32 v56, s57, v56
  s_waitcnt lgkmcnt(4)
  v_mfma_f32_32x32x16_bf16 v[144:159], v[100:103], v[84:87], v[144:159]
  ds_read_b128 v[80:83], v14 offset:49152
  ds_read_b64_tr_b16 v[88:89], v16 offset:39424
  ds_read_b64_tr_b16 v[90:91], v16 offset:39600
  v_mul_f32 v57, s57, v57
  v_mul_f32 v58, s57, v58
  v_mul_f32 v59, s57, v59
  v_mul_f32 v60, s57, v60
  v_mul_f32 v61, s57, v61
  v_mul_f32 v62, s57, v62
  v_mul_f32 v63, s57, v63
  v_cvt_pk_bf16_f32 v120, v48, v49
  v_cvt_pk_bf16_f32 v121, v50, v51
  v_cvt_pk_bf16_f32 v122, v52, v53
  v_cvt_pk_bf16_f32 v123, v54, v55
  v_cvt_pk_bf16_f32 v124, v56, v57
  v_cvt_pk_bf16_f32 v125, v58, v59
  v_cvt_pk_bf16_f32 v126, v60, v61
  v_cvt_pk_bf16_f32 v127, v62, v63
  v_cndmask_b32_e64 v126, v126, v19, s[60:61]
  v_cndmask_b32_e64 v127, v127, 0, s[60:61]
  s_nop 1
  buffer_store_dwordx4 v[120:123], v2, s[32:35], s49 offen sc1
  buffer_store_dwordx4 v[124:127], v2, s[32:35], s49 offen offset:1024 sc1
  s_waitcnt lgkmcnt(5)
  v_mfma_f32_32x32x16_bf16 v[160:175], v[104:107], v[84:87], v[160:175]
  ds_read_b64_tr_b16 v[92:93], v16 offset:39480
  ds_read_b64_tr_b16 v[94:95], v16 offset:39656
  s_add_u32 s62, s52, 2
  s_and_b32 s56, s62, 15
  s_lshl_b32 s56, s56, 6
  s_add_u32 s56, s56, s54
  s_cmp_lt_u32 s62, 16
  s_cselect_b32 s57, 0x3e8b97f6, 1.0
  s_cselect_b32 s45, 0, 0x3f80
  s_cselect_b32 s46, 11, 12
  s_cselect_b32 s47, 0, 4194304
  s_lshl_b32 s56, s56, s46
  s_add_u32 s53, s56, s47
  v_mov_b32 v19, s45
  v_mul_f32 v64, s57, v64
  v_mul_f32 v65, s57, v65
  v_mul_f32 v66, s57, v66
  v_mul_f32 v67, s57, v67
  v_mul_f32 v68, s57, v68
  v_mul_f32 v69, s57, v69
  v_mul_f32 v70, s57, v70
  v_mul_f32 v71, s57, v71
  v_mul_f32 v72, s57, v72
  v_mul_f32 v73, s57, v73
  v_mul_f32 v74, s57, v74
  s_waitcnt lgkmcnt(5)
  v_mfma_f32_32x32x16_bf16 v[176:191], v[84:87], v[108:111], v[176:191]
  ds_read_b64_tr_b16 v[96:97], v16 offset:39536
  ds_read_b64_tr_b16 v[98:99], v16 offset:39712
  v_mul_f32 v75, s57, v75
  v_mul_f32 v76, s57, v76
  v_mul_f32 v77, s57, v77
  v_mul_f32 v78, s57, v78
  v_mul_f32 v79, s57, v79
  v_cvt_pk_bf16_f32 v128, v64, v65
  v_cvt_pk_bf16_f32 v129, v66, v67
  v_cvt_pk_bf16_f32 v130, v68, v69
  v_cvt_pk_bf16_f32 v131, v70, v71
  v_cvt_pk_bf16_f32 v132, v72, v73
  v_cvt_pk_bf16_f32 v133, v74, v75
  v_cvt_pk_bf16_f32 v134, v76, v77
  v_cvt_pk_bf16_f32 v135, v78, v79
  v_cndmask_b32_e64 v134, v134, v19, s[60:61]
  v_cndmask_b32_e64 v135, v135, 0, s[60:61]
  s_nop 1
  buffer_store_dwordx4 v[128:131], v2, s[32:35], s53 offen sc1
  buffer_store_dwordx4 v[132:135], v2, s[32:35], s53 offen offset:1024 sc1
  s_waitcnt lgkmcnt(4)
  v_mfma_f32_32x32x16_bf16 v[144:159], v[88:91], v[80:83], v[144:159]
  ds_read_b128 v[84:87], v15 offset:49152
  ds_read_b64_tr_b16 v[100:101], v16 offset:42240
  ds_read_b64_tr_b16 v[102:103], v16 offset:42416
  s_waitcnt lgkmcnt(5)
  v_mfma_f32_32x32x16_bf16 v[160:175], v[92:95], v[80:83], v[160:175]
  ds_read_b64_tr_b16 v[104:105], v16 offset:42296
  ds_read_b64_tr_b16 v[106:107], v16 offset:42472
  s_waitcnt lgkmcnt(5)
  v_mfma_f32_32x32x16_bf16 v[176:191], v[80:83], v[96:99], v[176:191]
  ds_read_b64_tr_b16 v[108:109], v16 offset:42352
  ds_read_b64_tr_b16 v[110:111], v16 offset:42528
  s_waitcnt lgkmcnt(0)
  s_barrier
  v_mfma_f32_32x32x16_bf16 v[144:159], v[100:103], v[84:87], v[144:159]
  ds_read_b128 v[80:83], v12 offset:0
  ds_read_b64_tr_b16 v[88:89], v16 offset:0
  ds_read_b64_tr_b16 v[90:91], v16 offset:176
  v_mfma_f32_32x32x16_bf16 v[160:175], v[104:107], v[84:87], v[160:175]
  ds_read_b64_tr_b16 v[92:93], v16 offset:56
  ds_read_b64_tr_b16 v[94:95], v16 offset:232
  v_mfma_f32_32x32x16_bf16 v[176:191], v[84:87], v[108:111], v[176:191]
  ds_read_b64_tr_b16 v[96:97], v16 offset:112
  ds_read_b64_tr_b16 v[98:99], v16 offset:288
  s_waitcnt lgkmcnt(4)
  v_mfma_f32_32x32x16_bf16 v[144:159], v[88:91], v[80:83], v[144:159]
  ds_read_b128 v[84:87], v13 offset:0
  ds_read_b64_tr_b16 v[100:101], v16 offset:2816
  ds_read_b64_tr_b16 v[102:103], v16 offset:2992
  s_waitcnt lgkmcnt(5)
  v_mfma_f32_32x32x16_bf16 v[160:175], v[92:95], v[80:83], v[160:175]
  ds_read_b64_tr_b16 v[104:105], v16 offset:2872
  ds_read_b64_tr_b16 v[106:107], v16 offset:3048
  s_waitcnt lgkmcnt(5)
  v_mfma_f32_32x32x16_bf16 v[176:191], v[80:83], v[96:99], v[176:191]
  ds_read_b64_tr_b16 v[108:109], v16 offset:2928
  ds_read_b64_tr_b16 v[110:111], v16 offset:3104
  s_waitcnt lgkmcnt(4)
  v_mfma_f32_32x32x16_bf16 v[144:159], v[100:103], v[84:87], v[144:159]
  ds_read_b128 v[80:83], v14 offset:0
  ds_read_b64_tr_b16 v[88:89], v16 offset:5632
  ds_read_b64_tr_b16 v[90:91], v16 offset:5808
  s_waitcnt lgkmcnt(5)
  v_mfma_f32_32x32x16_bf16 v[160:175], v[104:107], v[84:87], v[160:175]
  ds_read_b64_tr_b16 v[92:93], v16 offset:5688
  ds_read_b64_tr_b16 v[94:95], v16 offset:5864
  s_waitcnt lgkmcnt(5)
  v_mfma_f32_32x32x16_bf16 v[176:191], v[84:87], v[108:111], v[176:191]
  ds_read_b64_tr_b16 v[96:97], v16 offset:5744
  ds_read_b64_tr_b16 v[98:99], v16 offset:5920
  s_waitcnt lgkmcnt(4)
  v_mfma_f32_32x32x16_bf16 v[144:159], v[88:91], v[80:83], v[144:159]
  ds_read_b128 v[84:87], v15 offset:0
  ds_read_b64_tr_b16 v[100:101], v16 offset:8448
  ds_read_b64_tr_b16 v[102:103], v16 offset:8624
  s_waitcnt lgkmcnt(5)
  v_mfma_f32_32x32x16_bf16 v[160:175], v[92:95], v[80:83], v[160:175]
  ds_read_b64_tr_b16 v[104:105], v16 offset:8504
  ds_read_b64_tr_b16 v[106:107], v16 offset:8680
  s_waitcnt lgkmcnt(5)
  v_mfma_f32_32x32x16_bf16 v[176:191], v[80:83], v[96:99], v[176:191]
  ds_read_b64_tr_b16 v[108:109], v16 offset:8560
  ds_read_b64_tr_b16 v[110:111], v16 offset:8736
  s_waitcnt vmcnt(0) lgkmcnt(0)
  s_barrier
  s_cmp_lg_u32 s3, 0
  s_cbranch_scc1 LsigB_25
  v_readfirstlane_b32 s47, v31
  s_cmp_lg_u32 s47, 0
  s_cbranch_scc1 Linited_26
  s_mov_b32 s68, 200000
Linitspin_27:
  buffer_load_dword v31, v30, s[36:39], 0 offen sc1
  s_waitcnt vmcnt(0)
  v_readfirstlane_b32 s47, v31
  s_cmp_lg_u32 s47, 0
  s_cbranch_scc1 Linited_26
  s_sub_u32 s68, s68, 1
  s_cmp_lg_u32 s68, 0
  s_cbranch_scc1 Linitspin_27
Linited_26:
  s_mov_b64 exec, 1
  v_mov_b32 v1, 1
  s_lshl_b32 s47, s23, 8
  s_add_u32 s47, s47, 4096
  v_mov_b32 v29, s47
  buffer_atomic_add v1, v29, s[64:67], 0 offen sc1
  s_mov_b64 exec, -1
LsigB_25:
  v_mfma_f32_32x32x16_bf16 v[144:159], v[100:103], v[84:87], v[144:159]
  ds_read_b128 v[80:83], v12 offset:16384
  ds_read_b64_tr_b16 v[88:89], v16 offset:11264
  ds_read_b64_tr_b16 v[90:91], v16 offset:11440
  v_mfma_f32_32x32x16_bf16 v[160:175], v[104:107], v[84:87], v[160:175]
  ds_read_b64_tr_b16 v[92:93], v16 offset:11320
  ds_read_b64_tr_b16 v[94:95], v16 offset:11496
  v_mfma_f32_32x32x16_bf16 v[176:191], v[84:87], v[108:111], v[176:191]
  ds_read_b64_tr_b16 v[96:97], v16 offset:11376
  ds_read_b64_tr_b16 v[98:99], v16 offset:11552
  s_waitcnt lgkmcnt(4)
  v_mfma_f32_32x32x16_bf16 v[144:159], v[88:91], v[80:83], v[144:159]
  ds_read_b128 v[84:87], v13 offset:16384
  ds_read_b64_tr_b16 v[100:101], v16 offset:14080
  ds_read_b64_tr_b16 v[102:103], v16 offset:14256
  s_waitcnt lgkmcnt(5)
  v_mfma_f32_32x32x16_bf16 v[160:175], v[92:95], v[80:83], v[160:175]
  ds_read_b64_tr_b16 v[104:105], v16 offset:14136
  ds_read_b64_tr_b16 v[106:107], v16 offset:14312
  s_waitcnt lgkmcnt(5)
  v_mfma_f32_32x32x16_bf16 v[176:191], v[80:83], v[96:99], v[176:191]
  ds_read_b64_tr_b16 v[108:109], v16 offset:14192
  ds_read_b64_tr_b16 v[110:111], v16 offset:14368
  s_waitcnt lgkmcnt(4)
  v_mfma_f32_32x32x16_bf16 v[144:159], v[100:103], v[84:87], v[144:159]
  ds_read_b128 v[80:83], v14 offset:16384
  ds_read_b64_tr_b16 v[88:89], v16 offset:16896
  ds_read_b64_tr_b16 v[90:91], v16 offset:17072
  s_waitcnt lgkmcnt(5)
  v_mfma_f32_32x32x16_bf16 v[160:175], v[104:107], v[84:87], v[160:175]
  ds_read_b64_tr_b16 v[92:93], v16 offset:16952
  ds_read_b64_tr_b16 v[94:95], v16 offset:17128
  s_waitcnt lgkmcnt(5)
  v_mfma_f32_32x32x16_bf16 v[176:191], v[84:87], v[108:111], v[176:191]
  ds_read_b64_tr_b16 v[96:97], v16 offset:17008
  ds_read_b64_tr_b16 v[98:99], v16 offset:17184
  s_waitcnt lgkmcnt(4)
  v_mfma_f32_32x32x16_bf16 v[144:159], v[88:91], v[80:83], v[144:159]
  ds_read_b128 v[84:87], v15 offset:16384
  ds_read_b64_tr_b16 v[100:101], v16 offset:19712
  ds_read_b64_tr_b16 v[102:103], v16 offset:19888
  s_waitcnt lgkmcnt(5)
  v_mfma_f32_32x32x16_bf16 v[160:175], v[92:95], v[80:83], v[160:175]
  ds_read_b64_tr_b16 v[104:105], v16 offset:19768
  ds_read_b64_tr_b16 v[106:107], v16 offset:19944
  s_waitcnt lgkmcnt(5)
  v_mfma_f32_32x32x16_bf16 v[176:191], v[80:83], v[96:99], v[176:191]
  ds_read_b64_tr_b16 v[108:109], v16 offset:19824
  ds_read_b64_tr_b16 v[110:111], v16 offset:20000
  s_waitcnt lgkmcnt(0)
  s_barrier
  v_mfma_f32_32x32x16_bf16 v[144:159], v[100:103], v[84:87], v[144:159]
  ds_read_b128 v[80:83], v12 offset:32768
  ds_read_b64_tr_b16 v[88:89], v16 offset:22528
  ds_read_b64_tr_b16 v[90:91], v16 offset:22704
  v_mfma_f32_32x32x16_bf16 v[160:175], v[104:107], v[84:87], v[160:175]
  ds_read_b64_tr_b16 v[92:93], v16 offset:22584
  ds_read_b64_tr_b16 v[94:95], v16 offset:22760
  v_mfma_f32_32x32x16_bf16 v[176:191], v[84:87], v[108:111], v[176:191]
  ds_read_b64_tr_b16 v[96:97], v16 offset:22640
  ds_read_b64_tr_b16 v[98:99], v16 offset:22816
  s_waitcnt lgkmcnt(4)
  v_mfma_f32_32x32x16_bf16 v[144:159], v[88:91], v[80:83], v[144:159]
  ds_read_b128 v[84:87], v13 offset:32768
  ds_read_b64_tr_b16 v[100:101], v16 offset:25344
  ds_read_b64_tr_b16 v[102:103], v16 offset:25520
  s_waitcnt lgkmcnt(5)
  v_mfma_f32_32x32x16_bf16 v[160:175], v[92:95], v[80:83], v[160:175]
  ds_read_b64_tr_b16 v[104:105], v16 offset:25400
  ds_read_b64_tr_b16 v[106:107], v16 offset:25576
  s_waitcnt lgkmcnt(5)
  v_mfma_f32_32x32x16_bf16 v[176:191], v[80:83], v[96:99], v[176:191]
  ds_read_b64_tr_b16 v[108:109], v16 offset:25456
  ds_read_b64_tr_b16 v[110:111], v16 offset:25632
  s_waitcnt lgkmcnt(4)
  v_mfma_f32_32x32x16_bf16 v[144:159], v[100:103], v[84:87], v[144:159]
  ds_read_b128 v[80:83], v14 offset:32768
  ds_read_b64_tr_b16 v[88:89], v16 offset:28160
  ds_read_b64_tr_b16 v[90:91], v16 offset:28336
  s_waitcnt lgkmcnt(5)
  v_mfma_f32_32x32x16_bf16 v[160:175], v[104:107], v[84:87], v[160:175]
  ds_read_b64_tr_b16 v[92:93], v16 offset:28216
  ds_read_b64_tr_b16 v[94:95], v16 offset:28392
  s_waitcnt lgkmcnt(5)
  v_mfma_f32_32x32x16_bf16 v[176:191], v[84:87], v[108:111], v[176:191]
  ds_read_b64_tr_b16 v[96:97], v16 offset:28272
  ds_read_b64_tr_b16 v[98:99], v16 offset:28448
  s_waitcnt lgkmcnt(4)
  v_mfma_f32_32x32x16_bf16 v[144:159], v[88:91], v[80:83], v[144:159]
  ds_read_b128 v[84:87], v15 offset:32768
  ds_read_b64_tr_b16 v[100:101], v16 offset:30976
  ds_read_b64_tr_b16 v[102:103], v16 offset:31152
  s_waitcnt lgkmcnt(5)
  v_mfma_f32_32x32x16_bf16 v[160:175], v[92:95], v[80:83], v[160:175]
  ds_read_b64_tr_b16 v[104:105], v16 offset:31032
  ds_read_b64_tr_b16 v[106:107], v16 offset:31208
  s_waitcnt lgkmcnt(5)
  v_mfma_f32_32x32x16_bf16 v[176:191], v[80:83], v[96:99], v[176:191]
  ds_read_b64_tr_b16 v[108:109], v16 offset:31088
  ds_read_b64_tr_b16 v[110:111], v16 offset:31264
  s_waitcnt lgkmcnt(0)
  s_barrier
  v_mfma_f32_32x32x16_bf16 v[144:159], v[100:103], v[84:87], v[144:159]
  ds_read_b128 v[80:83], v12 offset:49152
  ds_read_b64_tr_b16 v[88:89], v16 offset:33792
  ds_read_b64_tr_b16 v[90:91], v16 offset:33968
  v_mfma_f32_32x32x16_bf16 v[160:175], v[104:107], v[84:87], v[160:175]
  ds_read_b64_tr_b16 v[92:93], v16 offset:33848
  ds_read_b64_tr_b16 v[94:95], v16 offset:34024
  v_mfma_f32_32x32x16_bf16 v[176:191], v[84:87], v[108:111], v[176:191]
  ds_read_b64_tr_b16 v[96:97], v16 offset:33904
  ds_read_b64_tr_b16 v[98:99], v16 offset:34080
  s_waitcnt lgkmcnt(4)
  v_mfma_f32_32x32x16_bf16 v[144:159], v[88:91], v[80:83], v[144:159]
  ds_read_b128 v[84:87], v13 offset:49152
  ds_read_b64_tr_b16 v[100:101], v16 offset:36608
  ds_read_b64_tr_b16 v[102:103], v16 offset:36784
  s_waitcnt lgkmcnt(5)
  v_mfma_f32_32x32x16_bf16 v[160:175], v[92:95], v[80:83], v[160:175]
  ds_read_b64_tr_b16 v[104:105], v16 offset:36664
  ds_read_b64_tr_b16 v[106:107], v16 offset:36840
  s_waitcnt lgkmcnt(5)
  v_mfma_f32_32x32x16_bf16 v[176:191], v[80:83], v[96:99], v[176:191]
  ds_read_b64_tr_b16 v[108:109], v16 offset:36720
  ds_read_b64_tr_b16 v[110:111], v16 offset:36896
  s_waitcnt lgkmcnt(4)
  v_mfma_f32_32x32x16_bf16 v[144:159], v[100:103], v[84:87], v[144:159]
  ds_read_b128 v[80:83], v14 offset:49152
  ds_read_b64_tr_b16 v[88:89], v16 offset:39424
  ds_read_b64_tr_b16 v[90:91], v16 offset:39600
  s_waitcnt lgkmcnt(5)
  v_mfma_f32_32x32x16_bf16 v[160:175], v[104:107], v[84:87], v[160:175]
  ds_read_b64_tr_b16 v[92:93], v16 offset:39480
  ds_read_b64_tr_b16 v[94:95], v16 offset:39656
  s_waitcnt lgkmcnt(5)
  v_mfma_f32_32x32x16_bf16 v[176:191], v[84:87], v[108:111], v[176:191]
  ds_read_b64_tr_b16 v[96:97], v16 offset:39536
  ds_read_b64_tr_b16 v[98:99], v16 offset:39712
  s_waitcnt lgkmcnt(4)
  v_mfma_f32_32x32x16_bf16 v[144:159], v[88:91], v[80:83], v[144:159]
  ds_read_b128 v[84:87], v15 offset:49152
  ds_read_b64_tr_b16 v[100:101], v16 offset:42240
  ds_read_b64_tr_b16 v[102:103], v16 offset:42416
  s_waitcnt lgkmcnt(5)
  v_mfma_f32_32x32x16_bf16 v[160:175], v[92:95], v[80:83], v[160:175]
  ds_read_b64_tr_b16 v[104:105], v16 offset:42296
  ds_read_b64_tr_b16 v[106:107], v16 offset:42472
  s_waitcnt lgkmcnt(5)
  v_mfma_f32_32x32x16_bf16 v[176:191], v[80:83], v[96:99], v[176:191]
  ds_read_b64_tr_b16 v[108:109], v16 offset:42352
  ds_read_b64_tr_b16 v[110:111], v16 offset:42528
  s_waitcnt lgkmcnt(0)
  s_barrier
  v_mfma_f32_32x32x16_bf16 v[144:159], v[100:103], v[84:87], v[144:159]
  ds_read_b128 v[80:83], v12 offset:0
  ds_read_b64_tr_b16 v[88:89], v16 offset:0
  ds_read_b64_tr_b16 v[90:91], v16 offset:176
  v_mfma_f32_32x32x16_bf16 v[160:175], v[104:107], v[84:87], v[160:175]
  ds_read_b64_tr_b16 v[92:93], v16 offset:56
  ds_read_b64_tr_b16 v[94:95], v16 offset:232
  v_mfma_f32_32x32x16_bf16 v[176:191], v[84:87], v[108:111], v[176:191]
  ds_read_b64_tr_b16 v[96:97], v16 offset:112
  ds_read_b64_tr_b16 v[98:99], v16 offset:288
  s_waitcnt lgkmcnt(4)
  v_mfma_f32_32x32x16_bf16 v[144:159], v[88:91], v[80:83], v[144:159]
  ds_read_b128 v[84:87], v13 offset:0
  ds_read_b64_tr_b16 v[100:101], v16 offset:2816
  ds_read_b64_tr_b16 v[102:103], v16 offset:2992
  s_waitcnt lgkmcnt(5)
  v_mfma_f32_32x32x16_bf16 v[160:175], v[92:95], v[80:83], v[160:175]
  ds_read_b64_tr_b16 v[104:105], v16 offset:2872
  ds_read_b64_tr_b16 v[106:107], v16 offset:3048
  s_waitcnt lgkmcnt(5)
  v_mfma_f32_32x32x16_bf16 v[176:191], v[80:83], v[96:99], v[176:191]
  ds_read_b64_tr_b16 v[108:109], v16 offset:2928
  ds_read_b64_tr_b16 v[110:111], v16 offset:3104
  s_waitcnt lgkmcnt(4)
  v_mfma_f32_32x32x16_bf16 v[144:159], v[100:103], v[84:87], v[144:159]
  ds_read_b128 v[80:83], v14 offset:0
  ds_read_b64_tr_b16 v[88:89], v16 offset:5632
  ds_read_b64_tr_b16 v[90:91], v16 offset:5808
  s_waitcnt lgkmcnt(5)
  v_mfma_f32_32x32x16_bf16 v[160:175], v[104:107], v[84:87], v[160:175]
  ds_read_b64_tr_b16 v[92:93], v16 offset:5688
  ds_read_b64_tr_b16 v[94:95], v16 offset:5864
  s_waitcnt lgkmcnt(5)
  v_mfma_f32_32x32x16_bf16 v[176:191], v[84:87], v[108:111], v[176:191]
  ds_read_b64_tr_b16 v[96:97], v16 offset:5744
  ds_read_b64_tr_b16 v[98:99], v16 offset:5920
  s_waitcnt lgkmcnt(4)
  v_mfma_f32_32x32x16_bf16 v[144:159], v[88:91], v[80:83], v[144:159]
  ds_read_b128 v[84:87], v15 offset:0
  ds_read_b64_tr_b16 v[100:101], v16 offset:8448
  ds_read_b64_tr_b16 v[102:103], v16 offset:8624
  s_waitcnt lgkmcnt(5)
  v_mfma_f32_32x32x16_bf16 v[160:175], v[92:95], v[80:83], v[160:175]
  ds_read_b64_tr_b16 v[104:105], v16 offset:8504
  ds_read_b64_tr_b16 v[106:107], v16 offset:8680
  s_waitcnt lgkmcnt(5)
  v_mfma_f32_32x32x16_bf16 v[176:191], v[80:83], v[96:99], v[176:191]
  ds_read_b64_tr_b16 v[108:109], v16 offset:8560
  ds_read_b64_tr_b16 v[110:111], v16 offset:8736
  s_waitcnt lgkmcnt(0)
  s_barrier
  v_mfma_f32_32x32x16_bf16 v[144:159], v[100:103], v[84:87], v[144:159]
  ds_read_b128 v[80:83], v12 offset:16384
  ds_read_b64_tr_b16 v[88:89], v16 offset:11264
  ds_read_b64_tr_b16 v[90:91], v16 offset:11440
  v_mfma_f32_32x32x16_bf16 v[160:175], v[104:107], v[84:87], v[160:175]
  ds_read_b64_tr_b16 v[92:93], v16 offset:11320
  ds_read_b64_tr_b16 v[94:95], v16 offset:11496
  v_mfma_f32_32x32x16_bf16 v[176:191], v[84:87], v[108:111], v[176:191]
  ds_read_b64_tr_b16 v[96:97], v16 offset:11376
  ds_read_b64_tr_b16 v[98:99], v16 offset:11552
  s_waitcnt lgkmcnt(4)
  v_mfma_f32_32x32x16_bf16 v[144:159], v[88:91], v[80:83], v[144:159]
  ds_read_b128 v[84:87], v13 offset:16384
  ds_read_b64_tr_b16 v[100:101], v16 offset:14080
  ds_read_b64_tr_b16 v[102:103], v16 offset:14256
  s_waitcnt lgkmcnt(5)
  v_mfma_f32_32x32x16_bf16 v[160:175], v[92:95], v[80:83], v[160:175]
  ds_read_b64_tr_b16 v[104:105], v16 offset:14136
  ds_read_b64_tr_b16 v[106:107], v16 offset:14312
  s_waitcnt lgkmcnt(5)
  v_mfma_f32_32x32x16_bf16 v[176:191], v[80:83], v[96:99], v[176:191]
  ds_read_b64_tr_b16 v[108:109], v16 offset:14192
  ds_read_b64_tr_b16 v[110:111], v16 offset:14368
  s_waitcnt lgkmcnt(4)
  v_mfma_f32_32x32x16_bf16 v[144:159], v[100:103], v[84:87], v[144:159]
  ds_read_b128 v[80:83], v14 offset:16384
  ds_read_b64_tr_b16 v[88:89], v16 offset:16896
  ds_read_b64_tr_b16 v[90:91], v16 offset:17072
  s_waitcnt lgkmcnt(5)
  v_mfma_f32_32x32x16_bf16 v[160:175], v[104:107], v[84:87], v[160:175]
  ds_read_b64_tr_b16 v[92:93], v16 offset:16952
  ds_read_b64_tr_b16 v[94:95], v16 offset:17128
  s_waitcnt lgkmcnt(5)
  v_mfma_f32_32x32x16_bf16 v[176:191], v[84:87], v[108:111], v[176:191]
  ds_read_b64_tr_b16 v[96:97], v16 offset:17008
  ds_read_b64_tr_b16 v[98:99], v16 offset:17184
  s_waitcnt lgkmcnt(4)
  v_mfma_f32_32x32x16_bf16 v[144:159], v[88:91], v[80:83], v[144:159]
  ds_read_b128 v[84:87], v15 offset:16384
  ds_read_b64_tr_b16 v[100:101], v16 offset:19712
  ds_read_b64_tr_b16 v[102:103], v16 offset:19888
  s_waitcnt lgkmcnt(5)
  v_mfma_f32_32x32x16_bf16 v[160:175], v[92:95], v[80:83], v[160:175]
  ds_read_b64_tr_b16 v[104:105], v16 offset:19768
  ds_read_b64_tr_b16 v[106:107], v16 offset:19944
  s_waitcnt lgkmcnt(5)
  v_mfma_f32_32x32x16_bf16 v[176:191], v[80:83], v[96:99], v[176:191]
  ds_read_b64_tr_b16 v[108:109], v16 offset:19824
  ds_read_b64_tr_b16 v[110:111], v16 offset:20000
  s_waitcnt lgkmcnt(4)
  v_mfma_f32_32x32x16_bf16 v[144:159], v[100:103], v[84:87], v[144:159]
  s_waitcnt lgkmcnt(2)
  v_mfma_f32_32x32x16_bf16 v[160:175], v[104:107], v[84:87], v[160:175]
  s_waitcnt lgkmcnt(0)
  v_mfma_f32_32x32x16_bf16 v[176:191], v[84:87], v[108:111], v[176:191]
  s_barrier
  s_and_b32 s40, s2, 7
  s_bfe_u32 s41, s2, 0x10003
  s_lshl_b32 s40, s40, 1
  s_add_u32 s40, s40, s41
  s_lshl_b32 s47, s40, 18
  s_add_u32 s47, s47, 8388608
  s_add_u32 s32, s20, s47
  s_addc_u32 s33, s21, 0
  s_mov_b32 s34, 0x40000
  s_mov_b32 s35, 0x20000
  s_lshl_b32 s55, s3, 12
  s_add_u32 s54, s55, 0
  s_add_u32 m0, s55, 0
  s_nop 0
  buffer_load_dwordx4 v2, s[32:35], s54 offen offset:0 lds
  buffer_load_dwordx4 v2, s[32:35], s54 offen offset:1024 lds
  buffer_load_dwordx4 v2, s[32:35], s54 offen offset:2048 lds
  buffer_load_dwordx4 v2, s[32:35], s54 offen offset:3072 lds
  s_add_u32 s54, s55, 32768
  s_add_u32 m0, s55, 32768
  s_nop 0
  buffer_load_dwordx4 v2, s[32:35], s54 offen offset:0 lds
  buffer_load_dwordx4 v2, s[32:35], s54 offen offset:1024 lds
  buffer_load_dwordx4 v2, s[32:35], s54 offen offset:2048 lds
  buffer_load_dwordx4 v2, s[32:35], s54 offen offset:3072 lds
  s_lshl_b32 s54, s22, 2
  s_add_u32 s54, s54, s3
  s_add_u32 s62, s63, 0
  s_and_b32 s56, s62, 15
  s_lshl_b32 s56, s56, 6
  s_add_u32 s56, s56, s54
  s_cmp_lt_u32 s62, 16
  s_cselect_b32 s57, 0x3e8b97f6, 1.0
  s_cselect_b32 s45, 0, 0x3f80
  s_cselect_b32 s46, 11, 12
  s_cselect_b32 s47, 0, 4194304
  s_lshl_b32 s56, s56, s46
  s_add_u32 s48, s56, s47
  v_mov_b32 v19, s45
  v_mul_f32 v144, s57, v144
  v_mul_f32 v145, s57, v145
  v_mul_f32 v146, s57, v146
  v_mul_f32 v147, s57, v147
  v_mul_f32 v148, s57, v148
  v_mul_f32 v149, s57, v149
  v_mul_f32 v150, s57, v150
  v_mul_f32 v151, s57, v151
  v_mul_f32 v152, s57, v152
  v_mul_f32 v153, s57, v153
  v_mul_f32 v154, s57, v154
  v_mul_f32 v155, s57, v155
  v_mul_f32 v156, s57, v156
  v_mul_f32 v157, s57, v157
  v_mul_f32 v158, s57, v158
  v_mul_f32 v159, s57, v159
  v_cvt_pk_bf16_f32 v208, v144, v145
  v_cvt_pk_bf16_f32 v209, v146, v147
  v_cvt_pk_bf16_f32 v210, v148, v149
  v_cvt_pk_bf16_f32 v211, v150, v151
  v_cvt_pk_bf16_f32 v212, v152, v153
  v_cvt_pk_bf16_f32 v213, v154, v155
  v_cvt_pk_bf16_f32 v214, v156, v157
  v_cvt_pk_bf16_f32 v215, v158, v159
  v_cndmask_b32_e64 v214, v214, v19, s[60:61]
  v_cndmask_b32_e64 v215, v215, 0, s[60:61]
  s_add_u32 s62, s63, 1
  s_and_b32 s56, s62, 15
  s_lshl_b32 s56, s56, 6
  s_add_u32 s56, s56, s54
  s_cmp_lt_u32 s62, 16
  s_cselect_b32 s57, 0x3e8b97f6, 1.0
  s_cselect_b32 s45, 0, 0x3f80
  s_cselect_b32 s46, 11, 12
  s_cselect_b32 s47, 0, 4194304
  s_lshl_b32 s56, s56, s46
  s_add_u32 s49, s56, s47
  v_mov_b32 v19, s45
  v_mul_f32 v160, s57, v160
  v_mul_f32 v161, s57, v161
  v_mul_f32 v162, s57, v162
  v_mul_f32 v163, s57, v163
  v_mul_f32 v164, s57, v164
  v_mul_f32 v165, s57, v165
  v_mul_f32 v166, s57, v166
  v_mul_f32 v167, s57, v167
  v_mul_f32 v168, s57, v168
  v_mul_f32 v169, s57, v169
  v_mul_f32 v170, s57, v170
  v_mul_f32 v171, s57, v171
  v_mul_f32 v172, s57, v172
  v_mul_f32 v173, s57, v173
  v_mul_f32 v174, s57, v174
  v_mul_f32 v175, s57, v175
  v_cvt_pk_bf16_f32 v216, v160, v161
  v_cvt_pk_bf16_f32 v217, v162, v163
  v_cvt_pk_bf16_f32 v218, v164, v165
  v_cvt_pk_bf16_f32 v219, v166, v167
  v_cvt_pk_bf16_f32 v220, v168, v169
  v_cvt_pk_bf16_f32 v221, v170, v171
  v_cvt_pk_bf16_f32 v222, v172, v173
  v_cvt_pk_bf16_f32 v223, v174, v175
  v_cndmask_b32_e64 v222, v222, v19, s[60:61]
  v_cndmask_b32_e64 v223, v223, 0, s[60:61]
  s_add_u32 s62, s63, 2
  s_and_b32 s56, s62, 15
  s_lshl_b32 s56, s56, 6
  s_add_u32 s56, s56, s54
  s_lshl_b32 s56, s56, 12
  s_add_u32 s53, s56, 4196352
  v_cvt_pk_bf16_f32 v224, v176, v177
  v_cvt_pk_bf16_f32 v225, v178, v179
  v_cvt_pk_bf16_f32 v226, v180, v181
  v_cvt_pk_bf16_f32 v227, v182, v183
  v_cvt_pk_bf16_f32 v228, v184, v185
  v_cvt_pk_bf16_f32 v229, v186, v187
  v_cvt_pk_bf16_f32 v230, v188, v189
  v_cvt_pk_bf16_f32 v231, v190, v191
  v_cndmask_b32_e64 v224, v224, v18, s[58:59]
  v_cndmask_b32_e64 v225, v225, v18, s[58:59]
  v_cndmask_b32_e64 v226, v226, v18, s[58:59]
  v_cndmask_b32_e64 v227, v227, v18, s[58:59]
  v_cndmask_b32_e64 v228, v228, v18, s[58:59]
  v_cndmask_b32_e64 v229, v229, v18, s[58:59]
  v_cndmask_b32_e64 v230, v230, v18, s[58:59]
  v_cndmask_b32_e64 v231, v231, v18, s[58:59]
  s_branch Lqkv_fin
Lqkv_v2:
  s_barrier
  ds_read_b128 v[80:83], v12 offset:0
  ds_read_b64_tr_b16 v[88:89], v16 offset:0
  ds_read_b64_tr_b16 v[90:91], v16 offset:176
  ds_read_b64_tr_b16 v[92:93], v16 offset:56
  ds_read_b64_tr_b16 v[94:95], v16 offset:232
  ds_read_b64_tr_b16 v[96:97], v16 offset:112
  ds_read_b64_tr_b16 v[98:99], v16 offset:288
  s_cmp_ge_u32 s3, 2
  s_cbranch_scc1 Lpf5_28
  s_cmp_eq_u32 s3, 0
  s_cselect_b32 s24, s8, s14
  s_cselect_b32 s25, s9, s15
  s_mov_b32 s26, 401408
  s_mov_b32 s27, 0x20000
  s_mul_i32 s46, s2, 1568
  v_add_u32 v20, s46, v2
  buffer_load_dwordx4 v[168:171], v20, s[24:27], 0 offen offset:0
  buffer_load_dwordx4 v[172:175], v20, s[24:27], 0 offen offset:1024
Lpf5_28:
  s_waitcnt lgkmcnt(4)
  v_mfma_f32_32x32x16_bf16 v[32:47], v[88:91], v[80:83], 0
  ds_read_b128 v[84:87], v13 offset:0
  ds_read_b64_tr_b16 v[100:101], v16 offset:2816
  ds_read_b64_tr_b16 v[102:103], v16 offset:2992
  s_waitcnt lgkmcnt(5)
  v_mfma_f32_32x32x16_bf16 v[48:63], v[92:95], v[80:83], 0
  ds_read_b64_tr_b16 v[104:105], v16 offset:2872
  ds_read_b64_tr_b16 v[106:107], v16 offset:3048
  s_waitcnt lgkmcnt(5)
  v_mfma_f32_32x32x16_bf16 v[64:79], v[80:83], v[96:99], 0
  ds_read_b64_tr_b16 v[108:109], v16 offset:2928
  ds_read_b64_tr_b16 v[110:111], v16 offset:3104
  s_waitcnt lgkmcnt(4)
  v_mfma_f32_32x32x16_bf16 v[32:47], v[100:103], v[84:87], v[32:47]
  ds_read_b128 v[80:83], v14 offset:0
  ds_read_b64_tr_b16 v[88:89], v16 offset:5632
  ds_read_b64_tr_b16 v[90:91], v16 offset:5808
  s_waitcnt lgkmcnt(5)
  v_mfma_f32_32x32x16_bf16 v[48:63], v[104:107], v[84:87], v[48:63]
  ds_read_b64_tr_b16 v[92:93], v16 offset:5688
  ds_read_b64_tr_b16 v[94:95], v16 offset:5864
  s_waitcnt lgkmcnt(5)
  v_mfma_f32_32x32x16_bf16 v[64:79], v[84:87], v[108:111], v[64:79]
  ds_read_b64_tr_b16 v[96:97], v16 offset:5744
  ds_read_b64_tr_b16 v[98:99], v16 offset:5920
  s_waitcnt lgkmcnt(4)
  v_mfma_f32_32x32x16_bf16 v[32:47], v[88:91], v[80:83], v[32:47]
  ds_read_b128 v[84:87], v15 offset:0
  ds_read_b64_tr_b16 v[100:101], v16 offset:8448
  ds_read_b64_tr_b16 v[102:103], v16 offset:8624
  s_waitcnt lgkmcnt(5)
  v_mfma_f32_32x32x16_bf16 v[48:63], v[92:95], v[80:83], v[48:63]
  ds_read_b64_tr_b16 v[104:105], v16 offset:8504
  ds_read_b64_tr_b16 v[106:107], v16 offset:8680
  s_waitcnt lgkmcnt(5)
  v_mfma_f32_32x32x16_bf16 v[64:79], v[80:83], v[96:99], v[64:79]
  ds_read_b64_tr_b16 v[108:109], v16 offset:8560
  ds_read_b64_tr_b16 v[110:111], v16 offset:8736
  s_waitcnt lgkmcnt(0)
  s_barrier
  v_mfma_f32_32x32x16_bf16 v[32:47], v[100:103], v[84:87], v[32:47]
  ds_read_b128 v[80:83], v12 offset:16384
  ds_read_b64_tr_b16 v[88:89], v16 offset:11264
  ds_read_b64_tr_b16 v[90:91], v16 offset:11440
  v_mfma_f32_32x32x16_bf16 v[48:63], v[104:107], v[84:87], v[48:63]
  ds_read_b64_tr_b16 v[92:93], v16 offset:11320
  ds_read_b64_tr_b16 v[94:95], v16 offset:11496
  v_mfma_f32_32x32x16_bf16 v[64:79], v[84:87], v[108:111], v[64:79]
  ds_read_b64_tr_b16 v[96:97], v16 offset:11376
  ds_read_b64_tr_b16 v[98:99], v16 offset:11552
  s_waitcnt lgkmcnt(4)
  v_mfma_f32_32x32x16_bf16 v[32:47], v[88:91], v[80:83], v[32:47]
  ds_read_b128 v[84:87], v13 offset:16384
  ds_read_b64_tr_b16 v[100:101], v16 offset:14080
  ds_read_b64_tr_b16 v[102:103], v16 offset:14256
  s_waitcnt lgkmcnt(5)
  v_mfma_f32_32x32x16_bf16 v[48:63], v[92:95], v[80:83], v[48:63]
  ds_read_b64_tr_b16 v[104:105], v16 offset:14136
  ds_read_b64_tr_b16 v[106:107], v16 offset:14312
  s_waitcnt lgkmcnt(5)
  v_mfma_f32_32x32x16_bf16 v[64:79], v[80:83], v[96:99], v[64:79]
  ds_read_b64_tr_b16 v[108:109], v16 offset:14192
  ds_read_b64_tr_b16 v[110:111], v16 offset:14368
  s_waitcnt lgkmcnt(4)
  v_mfma_f32_32x32x16_bf16 v[32:47], v[100:103], v[84:87], v[32:47]
  ds_read_b128 v[80:83], v14 offset:16384
  ds_read_b64_tr_b16 v[88:89], v16 offset:16896
  ds_read_b64_tr_b16 v[90:91], v16 offset:17072
  s_waitcnt lgkmcnt(5)
  v_mfma_f32_32x32x16_bf16 v[48:63], v[104:107], v[84:87], v[48:63]
  ds_read_b64_tr_b16 v[92:93], v16 offset:16952
  ds_read_b64_tr_b16 v[94:95], v16 offset:17128
  s_waitcnt lgkmcnt(5)
  v_mfma_f32_32x32x16_bf16 v[64:79], v[84:87], v[108:111], v[64:79]
  ds_read_b64_tr_b16 v[96:97], v16 offset:17008
  ds_read_b64_tr_b16 v[98:99], v16 offset:17184
  s_waitcnt lgkmcnt(4)
  v_mfma_f32_32x32x16_bf16 v[32:47], v[88:91], v[80:83], v[32:47]
  ds_read_b128 v[84:87], v15 offset:16384
  ds_read_b64_tr_b16 v[100:101], v16 offset:19712
  ds_read_b64_tr_b16 v[102:103], v16 offset:19888
  s_waitcnt lgkmcnt(5)
  v_mfma_f32_32x32x16_bf16 v[48:63], v[92:95], v[80:83], v[48:63]
  ds_read_b64_tr_b16 v[104:105], v16 offset:19768
  ds_read_b64_tr_b16 v[106:107], v16 offset:19944
  s_waitcnt lgkmcnt(5)
  v_mfma_f32_32x32x16_bf16 v[64:79], v[80:83], v[96:99], v[64:79]
  ds_read_b64_tr_b16 v[108:109], v16 offset:19824
  ds_read_b64_tr_b16 v[110:111], v16 offset:20000
  s_waitcnt lgkmcnt(0)
  s_barrier
  v_mfma_f32_32x32x16_bf16 v[32:47], v[100:103], v[84:87], v[32:47]
  ds_read_b128 v[80:83], v12 offset:32768
  ds_read_b64_tr_b16 v[88:89], v16 offset:22528
  ds_read_b64_tr_b16 v[90:91], v16 offset:22704
  v_mfma_f32_32x32x16_bf16 v[48:63], v[104:107], v[84:87], v[48:63]
  ds_read_b64_tr_b16 v[92:93], v16 offset:22584
  ds_read_b64_tr_b16 v[94:95], v16 offset:22760
  v_mfma_f32_32x32x16_bf16 v[64:79], v[84:87], v[108:111], v[64:79]
  ds_read_b64_tr_b16 v[96:97], v16 offset:22640
  ds_read_b64_tr_b16 v[98:99], v16 offset:22816
  s_waitcnt lgkmcnt(4)
  v_mfma_f32_32x32x16_bf16 v[32:47], v[88:91], v[80:83], v[32:47]
  ds_read_b128 v[84:87], v13 offset:32768
  ds_read_b64_tr_b16 v[100:101], v16 offset:25344
  ds_read_b64_tr_b16 v[102:103], v16 offset:25520
  s_waitcnt lgkmcnt(5)
  v_mfma_f32_32x32x16_bf16 v[48:63], v[92:95], v[80:83], v[48:63]
  ds_read_b64_tr_b16 v[104:105], v16 offset:25400
  ds_read_b64_tr_b16 v[106:107], v16 offset:25576
  s_waitcnt lgkmcnt(5)
  v_mfma_f32_32x32x16_bf16 v[64:79], v[80:83], v[96:99], v[64:79]
  ds_read_b64_tr_b16 v[108:109], v16 offset:25456
  ds_read_b64_tr_b16 v[110:111], v16 offset:25632
  s_waitcnt lgkmcnt(4)
  v_mfma_f32_32x32x16_bf16 v[32:47], v[100:103], v[84:87], v[32:47]
  ds_read_b128 v[80:83], v14 offset:32768
  ds_read_b64_tr_b16 v[88:89], v16 offset:28160
  ds_read_b64_tr_b16 v[90:91], v16 offset:28336
  s_waitcnt lgkmcnt(5)
  v_mfma_f32_32x32x16_bf16 v[48:63], v[104:107], v[84:87], v[48:63]
  ds_read_b64_tr_b16 v[92:93], v16 offset:28216
  ds_read_b64_tr_b16 v[94:95], v16 offset:28392
  s_waitcnt lgkmcnt(5)
  v_mfma_f32_32x32x16_bf16 v[64:79], v[84:87], v[108:111], v[64:79]
  ds_read_b64_tr_b16 v[96:97], v16 offset:28272
  ds_read_b64_tr_b16 v[98:99], v16 offset:28448
  s_waitcnt lgkmcnt(4)
  v_mfma_f32_32x32x16_bf16 v[32:47], v[88:91], v[80:83], v[32:47]
  ds_read_b128 v[84:87], v15 offset:32768
  ds_read_b64_tr_b16 v[100:101], v16 offset:30976
  ds_read_b64_tr_b16 v[102:103], v16 offset:31152
  s_waitcnt lgkmcnt(5)
  v_mfma_f32_32x32x16_bf16 v[48:63], v[92:95], v[80:83], v[48:63]
  ds_read_b64_tr_b16 v[104:105], v16 offset:31032
  ds_read_b64_tr_b16 v[106:107], v16 offset:31208
  s_waitcnt lgkmcnt(5)
  v_mfma_f32_32x32x16_bf16 v[64:79], v[80:83], v[96:99], v[64:79]
  ds_read_b64_tr_b16 v[108:109], v16 offset:31088
  ds_read_b64_tr_b16 v[110:111], v16 offset:31264
  s_waitcnt lgkmcnt(0)
  s_barrier
  v_mfma_f32_32x32x16_bf16 v[32:47], v[100:103], v[84:87], v[32:47]
  ds_read_b128 v[80:83], v12 offset:49152
  ds_read_b64_tr_b16 v[88:89], v16 offset:33792
  ds_read_b64_tr_b16 v[90:91], v16 offset:33968
  v_mfma_f32_32x32x16_bf16 v[48:63], v[104:107], v[84:87], v[48:63]
  ds_read_b64_tr_b16 v[92:93], v16 offset:33848
  ds_read_b64_tr_b16 v[94:95], v16 offset:34024
  v_mfma_f32_32x32x16_bf16 v[64:79], v[84:87], v[108:111], v[64:79]
  ds_read_b64_tr_b16 v[96:97], v16 offset:33904
  ds_read_b64_tr_b16 v[98:99], v16 offset:34080
  s_waitcnt lgkmcnt(4)
  v_mfma_f32_32x32x16_bf16 v[32:47], v[88:91], v[80:83], v[32:47]
  ds_read_b128 v[84:87], v13 offset:49152
  ds_read_b64_tr_b16 v[100:101], v16 offset:36608
  ds_read_b64_tr_b16 v[102:103], v16 offset:36784
  s_waitcnt lgkmcnt(5)
  v_mfma_f32_32x32x16_bf16 v[48:63], v[92:95], v[80:83], v[48:63]
  ds_read_b64_tr_b16 v[104:105], v16 offset:36664
  ds_read_b64_tr_b16 v[106:107], v16 offset:36840
  s_waitcnt lgkmcnt(5)
  v_mfma_f32_32x32x16_bf16 v[64:79], v[80:83], v[96:99], v[64:79]
  ds_read_b64_tr_b16 v[108:109], v16 offset:36720
  ds_read_b64_tr_b16 v[110:111], v16 offset:36896
  s_waitcnt lgkmcnt(4)
  v_mfma_f32_32x32x16_bf16 v[32:47], v[100:103], v[84:87], v[32:47]
  ds_read_b128 v[80:83], v14 offset:49152
  ds_read_b64_tr_b16 v[88:89], v16 offset:39424
  ds_read_b64_tr_b16 v[90:91], v16 offset:39600
  s_waitcnt lgkmcnt(5)
  v_mfma_f32_32x32x16_bf16 v[48:63], v[104:107], v[84:87], v[48:63]
  ds_read_b64_tr_b16 v[92:93], v16 offset:39480
  ds_read_b64_tr_b16 v[94:95], v16 offset:39656
  s_waitcnt lgkmcnt(5)
  v_mfma_f32_32x32x16_bf16 v[64:79], v[84:87], v[108:111], v[64:79]
  ds_read_b64_tr_b16 v[96:97], v16 offset:39536
  ds_read_b64_tr_b16 v[98:99], v16 offset:39712
  s_waitcnt lgkmcnt(4)
  v_mfma_f32_32x32x16_bf16 v[32:47], v[88:91], v[80:83], v[32:47]
  ds_read_b128 v[84:87], v15 offset:49152
  ds_read_b64_tr_b16 v[100:101], v16 offset:42240
  ds_read_b64_tr_b16 v[102:103], v16 offset:42416
  s_waitcnt lgkmcnt(5)
  v_mfma_f32_32x32x16_bf16 v[48:63], v[92:95], v[80:83], v[48:63]
  ds_read_b64_tr_b16 v[104:105], v16 offset:42296
  ds_read_b64_tr_b16 v[106:107], v16 offset:42472
  s_waitcnt lgkmcnt(5)
  v_mfma_f32_32x32x16_bf16 v[64:79], v[80:83], v[96:99], v[64:79]
  ds_read_b64_tr_b16 v[108:109], v16 offset:42352
  ds_read_b64_tr_b16 v[110:111], v16 offset:42528
  s_waitcnt lgkmcnt(0)
  s_barrier
  v_mfma_f32_32x32x16_bf16 v[32:47], v[100:103], v[84:87], v[32:47]
  ds_read_b128 v[80:83], v12 offset:0
  ds_read_b64_tr_b16 v[88:89], v16 offset:0
  ds_read_b64_tr_b16 v[90:91], v16 offset:176
  v_mfma_f32_32x32x16_bf16 v[48:63], v[104:107], v[84:87], v[48:63]
  ds_read_b64_tr_b16 v[92:93], v16 offset:56
  ds_read_b64_tr_b16 v[94:95], v16 offset:232
  v_mfma_f32_32x32x16_bf16 v[64:79], v[84:87], v[108:111], v[64:79]
  ds_read_b64_tr_b16 v[96:97], v16 offset:112
  ds_read_b64_tr_b16 v[98:99], v16 offset:288
  s_waitcnt lgkmcnt(4)
  v_mfma_f32_32x32x16_bf16 v[32:47], v[88:91], v[80:83], v[32:47]
  ds_read_b128 v[84:87], v13 offset:0
  ds_read_b64_tr_b16 v[100:101], v16 offset:2816
  ds_read_b64_tr_b16 v[102:103], v16 offset:2992
  s_waitcnt lgkmcnt(5)
  v_mfma_f32_32x32x16_bf16 v[48:63], v[92:95], v[80:83], v[48:63]
  ds_read_b64_tr_b16 v[104:105], v16 offset:2872
  ds_read_b64_tr_b16 v[106:107], v16 offset:3048
  s_waitcnt lgkmcnt(5)
  v_mfma_f32_32x32x16_bf16 v[64:79], v[80:83], v[96:99], v[64:79]
  ds_read_b64_tr_b16 v[108:109], v16 offset:2928
  ds_read_b64_tr_b16 v[110:111], v16 offset:3104
  s_waitcnt lgkmcnt(4)
  v_mfma_f32_32x32x16_bf16 v[32:47], v[100:103], v[84:87], v[32:47]
  ds_read_b128 v[80:83], v14 offset:0
  ds_read_b64_tr_b16 v[88:89], v16 offset:5632
  ds_read_b64_tr_b16 v[90:91], v16 offset:5808
  s_waitcnt lgkmcnt(5)
  v_mfma_f32_32x32x16_bf16 v[48:63], v[104:107], v[84:87], v[48:63]
  ds_read_b64_tr_b16 v[92:93], v16 offset:5688
  ds_read_b64_tr_b16 v[94:95], v16 offset:5864
  s_waitcnt lgkmcnt(5)
  v_mfma_f32_32x32x16_bf16 v[64:79], v[84:87], v[108:111], v[64:79]
  ds_read_b64_tr_b16 v[96:97], v16 offset:5744
  ds_read_b64_tr_b16 v[98:99], v16 offset:5920
  s_waitcnt lgkmcnt(4)
  v_mfma_f32_32x32x16_bf16 v[32:47], v[88:91], v[80:83], v[32:47]
  ds_read_b128 v[84:87], v15 offset:0
  ds_read_b64_tr_b16 v[100:101], v16 offset:8448
  ds_read_b64_tr_b16 v[102:103], v16 offset:8624
  s_waitcnt lgkmcnt(5)
  v_mfma_f32_32x32x16_bf16 v[48:63], v[92:95], v[80:83], v[48:63]
  ds_read_b64_tr_b16 v[104:105], v16 offset:8504
  ds_read_b64_tr_b16 v[106:107], v16 offset:8680
  s_waitcnt lgkmcnt(5)
  v_mfma_f32_32x32x16_bf16 v[64:79], v[80:83], v[96:99], v[64:79]
  ds_read_b64_tr_b16 v[108:109], v16 offset:8560
  ds_read_b64_tr_b16 v[110:111], v16 offset:8736
  s_waitcnt lgkmcnt(0)
  s_barrier
  v_mfma_f32_32x32x16_bf16 v[32:47], v[100:103], v[84:87], v[32:47]
  ds_read_b128 v[80:83], v12 offset:16384
  ds_read_b64_tr_b16 v[88:89], v16 offset:11264
  ds_read_b64_tr_b16 v[90:91], v16 offset:11440
  v_mfma_f32_32x32x16_bf16 v[48:63], v[104:107], v[84:87], v[48:63]
  ds_read_b64_tr_b16 v[92:93], v16 offset:11320
  ds_read_b64_tr_b16 v[94:95], v16 offset:11496
  v_mfma_f32_32x32x16_bf16 v[64:79], v[84:87], v[108:111], v[64:79]
  ds_read_b64_tr_b16 v[96:97], v16 offset:11376
  ds_read_b64_tr_b16 v[98:99], v16 offset:11552
  s_waitcnt lgkmcnt(4)
  v_mfma_f32_32x32x16_bf16 v[32:47], v[88:91], v[80:83], v[32:47]
  ds_read_b128 v[84:87], v13 offset:16384
  ds_read_b64_tr_b16 v[100:101], v16 offset:14080
  ds_read_b64_tr_b16 v[102:103], v16 offset:14256
  s_waitcnt lgkmcnt(5)
  v_mfma_f32_32x32x16_bf16 v[48:63], v[92:95], v[80:83], v[48:63]
  ds_read_b64_tr_b16 v[104:105], v16 offset:14136
  ds_read_b64_tr_b16 v[106:107], v16 offset:14312
  s_waitcnt lgkmcnt(5)
  v_mfma_f32_32x32x16_bf16 v[64:79], v[80:83], v[96:99], v[64:79]
  ds_read_b64_tr_b16 v[108:109], v16 offset:14192
  ds_read_b64_tr_b16 v[110:111], v16 offset:14368
  s_waitcnt lgkmcnt(4)
  v_mfma_f32_32x32x16_bf16 v[32:47], v[100:103], v[84:87], v[32:47]
  ds_read_b128 v[80:83], v14 offset:16384
  ds_read_b64_tr_b16 v[88:89], v16 offset:16896
  ds_read_b64_tr_b16 v[90:91], v16 offset:17072
  s_waitcnt lgkmcnt(5)
  v_mfma_f32_32x32x16_bf16 v[48:63], v[104:107], v[84:87], v[48:63]
  ds_read_b64_tr_b16 v[92:93], v16 offset:16952
  ds_read_b64_tr_b16 v[94:95], v16 offset:17128
  s_waitcnt lgkmcnt(5)
  v_mfma_f32_32x32x16_bf16 v[64:79], v[84:87], v[108:111], v[64:79]
  ds_read_b64_tr_b16 v[96:97], v16 offset:17008
  ds_read_b64_tr_b16 v[98:99], v16 offset:17184
  s_waitcnt lgkmcnt(4)
  v_mfma_f32_32x32x16_bf16 v[32:47], v[88:91], v[80:83], v[32:47]
  ds_read_b128 v[84:87], v15 offset:16384
  ds_read_b64_tr_b16 v[100:101], v16 offset:19712
  ds_read_b64_tr_b16 v[102:103], v16 offset:19888
  s_waitcnt lgkmcnt(5)
  v_mfma_f32_32x32x16_bf16 v[48:63], v[92:95], v[80:83], v[48:63]
  ds_read_b64_tr_b16 v[104:105], v16 offset:19768
  ds_read_b64_tr_b16 v[106:107], v16 offset:19944
  s_waitcnt lgkmcnt(5)
  v_mfma_f32_32x32x16_bf16 v[64:79], v[80:83], v[96:99], v[64:79]
  ds_read_b64_tr_b16 v[108:109], v16 offset:19824
  ds_read_b64_tr_b16 v[110:111], v16 offset:20000
  s_waitcnt vmcnt(0) lgkmcnt(0)
  s_barrier
  v_mfma_f32_32x32x16_bf16 v[32:47], v[100:103], v[84:87], v[32:47]
  ds_read_b128 v[80:83], v12 offset:32768
  ds_read_b64_tr_b16 v[88:89], v16 offset:22528
  ds_read_b64_tr_b16 v[90:91], v16 offset:22704
  v_mfma_f32_32x32x16_bf16 v[48:63], v[104:107], v[84:87], v[48:63]
  ds_read_b64_tr_b16 v[92:93], v16 offset:22584
  ds_read_b64_tr_b16 v[94:95], v16 offset:22760
  v_mfma_f32_32x32x16_bf16 v[64:79], v[84:87], v[108:111], v[64:79]
  ds_read_b64_tr_b16 v[96:97], v16 offset:22640
  ds_read_b64_tr_b16 v[98:99], v16 offset:22816
  s_waitcnt lgkmcnt(4)
  v_mfma_f32_32x32x16_bf16 v[32:47], v[88:91], v[80:83], v[32:47]
  ds_read_b128 v[84:87], v13 offset:32768
  ds_read_b64_tr_b16 v[100:101], v16 offset:25344
  ds_read_b64_tr_b16 v[102:103], v16 offset:25520
  s_waitcnt lgkmcnt(5)
  v_mfma_f32_32x32x16_bf16 v[48:63], v[92:95], v[80:83], v[48:63]
  ds_read_b64_tr_b16 v[104:105], v16 offset:25400
  ds_read_b64_tr_b16 v[106:107], v16 offset:25576
  s_waitcnt lgkmcnt(5)
  v_mfma_f32_32x32x16_bf16 v[64:79], v[80:83], v[96:99], v[64:79]
  ds_read_b64_tr_b16 v[108:109], v16 offset:25456
  ds_read_b64_tr_b16 v[110:111], v16 offset:25632
  s_waitcnt lgkmcnt(4)
  v_mfma_f32_32x32x16_bf16 v[32:47], v[100:103], v[84:87], v[32:47]
  ds_read_b128 v[80:83], v14 offset:32768
  ds_read_b64_tr_b16 v[88:89], v16 offset:28160
  ds_read_b64_tr_b16 v[90:91], v16 offset:28336
  s_waitcnt lgkmcnt(5)
  v_mfma_f32_32x32x16_bf16 v[48:63], v[104:107], v[84:87], v[48:63]
  ds_read_b64_tr_b16 v[92:93], v16 offset:28216
  ds_read_b64_tr_b16 v[94:95], v16 offset:28392
  s_waitcnt lgkmcnt(5)
  v_mfma_f32_32x32x16_bf16 v[64:79], v[84:87], v[108:111], v[64:79]
  ds_read_b64_tr_b16 v[96:97], v16 offset:28272
  ds_read_b64_tr_b16 v[98:99], v16 offset:28448
  s_waitcnt lgkmcnt(4)
  v_mfma_f32_32x32x16_bf16 v[32:47], v[88:91], v[80:83], v[32:47]
  ds_read_b128 v[84:87], v15 offset:32768
  ds_read_b64_tr_b16 v[100:101], v16 offset:30976
  ds_read_b64_tr_b16 v[102:103], v16 offset:31152
  s_waitcnt lgkmcnt(5)
  v_mfma_f32_32x32x16_bf16 v[48:63], v[92:95], v[80:83], v[48:63]
  ds_read_b64_tr_b16 v[104:105], v16 offset:31032
  ds_read_b64_tr_b16 v[106:107], v16 offset:31208
  s_waitcnt lgkmcnt(5)
  v_mfma_f32_32x32x16_bf16 v[64:79], v[80:83], v[96:99], v[64:79]
  ds_read_b64_tr_b16 v[108:109], v16 offset:31088
  ds_read_b64_tr_b16 v[110:111], v16 offset:31264
  s_waitcnt lgkmcnt(0)
  s_barrier
  v_mfma_f32_32x32x16_bf16 v[32:47], v[100:103], v[84:87], v[32:47]
  ds_read_b128 v[80:83], v12 offset:49152
  ds_read_b64_tr_b16 v[88:89], v16 offset:33792
  ds_read_b64_tr_b16 v[90:91], v16 offset:33968
  v_mfma_f32_32x32x16_bf16 v[48:63], v[104:107], v[84:87], v[48:63]
  ds_read_b64_tr_b16 v[92:93], v16 offset:33848
  ds_read_b64_tr_b16 v[94:95], v16 offset:34024
  v_mfma_f32_32x32x16_bf16 v[64:79], v[84:87], v[108:111], v[64:79]
  ds_read_b64_tr_b16 v[96:97], v16 offset:33904
  ds_read_b64_tr_b16 v[98:99], v16 offset:34080
  s_waitcnt lgkmcnt(4)
  v_mfma_f32_32x32x16_bf16 v[144:159], v[80:83], v[88:91], 0
  ds_read_b128 v[84:87], v13 offset:49152
  ds_read_b64_tr_b16 v[100:101], v16 offset:36608
  ds_read_b64_tr_b16 v[102:103], v16 offset:36784
  s_nop 7
  s_lshl_b32 s54, s22, 2
  s_add_u32 s54, s54, s3
  s_add_u32 s54, s54, 1024
  s_add_u32 s62, s52, 0
  s_and_b32 s56, s62, 15
  s_lshl_b32 s56, s56, 6
  s_add_u32 s56, s56, s54
  s_cmp_lt_u32 s62, 16
  s_cselect_b32 s57, 0x3e8b97f6, 1.0
  s_cselect_b32 s45, 0, 0x3f80
  s_cselect_b32 s46, 11, 12
  s_cselect_b32 s47, 0, 4194304
  s_lshl_b32 s56, s56, s46
  s_add_u32 s48, s56, s47
  v_mov_b32 v19, s45
  v_mul_f32 v32, s57, v32
  v_mul_f32 v33, s57, v33
  v_mul_f32 v34, s57, v34
  v_mul_f32 v35, s57, v35
  v_mul_f32 v36, s57, v36
  s_waitcnt lgkmcnt(5)
  v_mfma_f32_32x32x16_bf16 v[160:175], v[80:83], v[92:95], 0
  ds_read_b64_tr_b16 v[104:105], v16 offset:36664
  ds_read_b64_tr_b16 v[106:107], v16 offset:36840
  v_mul_f32 v37, s57, v37
  v_mul_f32 v38, s57, v38
  v_mul_f32 v39, s57, v39
  v_mul_f32 v40, s57, v40
  v_mul_f32 v41, s57, v41
  v_mul_f32 v42, s57, v42
  v_mul_f32 v43, s57, v43
  v_mul_f32 v44, s57, v44
  v_mul_f32 v45, s57, v45
  v_mul_f32 v46, s57, v46
  v_mul_f32 v47, s57, v47
  v_cvt_pk_bf16_f32 v112, v32, v33
  v_cvt_pk_bf16_f32 v113, v34, v35
  v_cvt_pk_bf16_f32 v114, v36, v37
  v_cvt_pk_bf16_f32 v115, v38, v39
  v_cvt_pk_bf16_f32 v116, v40, v41
  v_cvt_pk_bf16_f32 v117, v42, v43
  s_waitcnt lgkmcnt(5)
  v_mfma_f32_32x32x16_bf16 v[176:191], v[80:83], v[96:99], 0
  ds_read_b64_tr_b16 v[108:109], v16 offset:36720
  ds_read_b64_tr_b16 v[110:111], v16 offset:36896
  v_cvt_pk_bf16_f32 v118, v44, v45
  v_cvt_pk_bf16_f32 v119, v46, v47
  v_cndmask_b32_e64 v118, v118, v19, s[60:61]
  v_cndmask_b32_e64 v119, v119, 0, s[60:61]
  s_nop 1
  buffer_store_dwordx4 v[112:115], v2, s[32:35], s48 offen sc1
  buffer_store_dwordx4 v[116:119], v2, s[32:35], s48 offen offset:1024 sc1
  s_add_u32 s62, s52, 1
  s_and_b32 s56, s62, 15
  s_lshl_b32 s56, s56, 6
  s_add_u32 s56, s56, s54
  s_cmp_lt_u32 s62, 16
  s_cselect_b32 s57, 0x3e8b97f6, 1.0
  s_cselect_b32 s45, 0, 0x3f80
  s_cselect_b32 s46, 11, 12
  s_cselect_b32 s47, 0, 4194304
  s_lshl_b32 s56, s56, s46
  s_add_u32 s49, s56, s47
  v_mov_b32 v19, s45
  v_mul_f32 v48, s57, v48
  v_mul_f32 v49, s57, v49
  v_mul_f32 v50, s57, v50
  s_waitcnt lgkmcnt(4)
  v_mfma_f32_32x32x16_bf16 v[144:159], v[84:87], v[100:103], v[144:159]
  ds_read_b128 v[80:83], v14 offset:49152
  ds_read_b64_tr_b16 v[88:89], v16 offset:39424
  ds_read_b64_tr_b16 v[90:91], v16 offset:39600
  v_mul_f32 v51, s57, v51
  v_mul_f32 v52, s57, v52
  v_mul_f32 v53, s57, v53
  v_mul_f32 v54, s57, v54
  v_mul_f32 v55, s57, v55
  v_mul_f32 v56, s57, v56
  v_mul_f32 v57, s57, v57
  v_mul_f32 v58, s57, v58
  v_mul_f32 v59, s57, v59
  v_mul_f32 v60, s57, v60
  v_mul_f32 v61, s57, v61
  v_mul_f32 v62, s57, v62
  v_mul_f32 v63, s57, v63
  v_cvt_pk_bf16_f32 v120, v48, v49
  v_cvt_pk_bf16_f32 v121, v50, v51
  v_cvt_pk_bf16_f32 v122, v52, v53
  v_cvt_pk_bf16_f32 v123, v54, v55
  s_waitcnt lgkmcnt(5)
  v_mfma_f32_32x32x16_bf16 v[160:175], v[84:87], v[104:107], v[160:175]
  ds_read_b64_tr_b16 v[92:93], v16 offset:39480
  ds_read_b64_tr_b16 v[94:95], v16 offset:39656
  v_cvt_pk_bf16_f32 v124, v56, v57
  v_cvt_pk_bf16_f32 v125, v58, v59
  v_cvt_pk_bf16_f32 v126, v60, v61
  v_cvt_pk_bf16_f32 v127, v62, v63
  v_cndmask_b32_e64 v126, v126, v19, s[60:61]
  v_cndmask_b32_e64 v127, v127, 0, s[60:61]
  s_nop 1
  buffer_store_dwordx4 v[120:123], v2, s[32:35], s49 offen sc1
  buffer_store_dwordx4 v[124:127], v2, s[32:35], s49 offen offset:1024 sc1
  s_add_u32 s62, s52, 2
  s_and_b32 s56, s62, 15
  s_lshl_b32 s56, s56, 6
  s_add_u32 s56, s56, s54
  s_lshl_b32 s56, s56, 12
  s_add_u32 s53, s56, 4196352
  v_cvt_pk_bf16_f32 v128, v64, v65
  v_cvt_pk_bf16_f32 v129, v66, v67
  v_cvt_pk_bf16_f32 v130, v68, v69
  s_waitcnt lgkmcnt(5)
  v_mfma_f32_32x32x16_bf16 v[176:191], v[84:87], v[108:111], v[176:191]
  ds_read_b64_tr_b16 v[96:97], v16 offset:39536
  ds_read_b64_tr_b16 v[98:99], v16 offset:39712
  v_cvt_pk_bf16_f32 v131, v70, v71
  v_cvt_pk_bf16_f32 v132, v72, v73
  v_cvt_pk_bf16_f32 v133, v74, v75
  v_cvt_pk_bf16_f32 v134, v76, v77
  v_cvt_pk_bf16_f32 v135, v78, v79
  v_cndmask_b32_e64 v128, v128, v18, s[58:59]
  v_cndmask_b32_e64 v129, v129, v18, s[58:59]
  v_cndmask_b32_e64 v130, v130, v18, s[58:59]
  v_cndmask_b32_e64 v131, v131, v18, s[58:59]
  v_cndmask_b32_e64 v132, v132, v18, s[58:59]
  v_cndmask_b32_e64 v133, v133, v18, s[58:59]
  v_cndmask_b32_e64 v134, v134, v18, s[58:59]
  v_cndmask_b32_e64 v135, v135, v18, s[58:59]
  s_nop 1
  buffer_store_dwordx4 v[128:131], v2, s[32:35], s53 offen sc1
  buffer_store_dwordx4 v[132:135], v2, s[32:35], s53 offen offset:1024 sc1
  s_waitcnt lgkmcnt(4)
  v_mfma_f32_32x32x16_bf16 v[144:159], v[80:83], v[88:91], v[144:159]
  ds_read_b128 v[84:87], v15 offset:49152
  ds_read_b64_tr_b16 v[100:101], v16 offset:42240
  ds_read_b64_tr_b16 v[102:103], v16 offset:42416
  s_waitcnt lgkmcnt(5)
  v_mfma_f32_32x32x16_bf16 v[160:175], v[80:83], v[92:95], v[160:175]
  ds_read_b64_tr_b16 v[104:105], v16 offset:42296
  ds_read_b64_tr_b16 v[106:107], v16 offset:42472
  s_waitcnt lgkmcnt(5)
  v_mfma_f32_32x32x16_bf16 v[176:191], v[80:83], v[96:99], v[176:191]
  ds_read_b64_tr_b16 v[108:109], v16 offset:42352
  ds_read_b64_tr_b16 v[110:111], v16 offset:42528
  s_waitcnt lgkmcnt(0)
  s_barrier
  v_mfma_f32_32x32x16_bf16 v[144:159], v[84:87], v[100:103], v[144:159]
  ds_read_b128 v[80:83], v12 offset:0
  ds_read_b64_tr_b16 v[88:89], v16 offset:0
  ds_read_b64_tr_b16 v[90:91], v16 offset:176
  v_mfma_f32_32x32x16_bf16 v[160:175], v[84:87], v[104:107], v[160:175]
  ds_read_b64_tr_b16 v[92:93], v16 offset:56
  ds_read_b64_tr_b16 v[94:95], v16 offset:232
  v_mfma_f32_32x32x16_bf16 v[176:191], v[84:87], v[108:111], v[176:191]
  ds_read_b64_tr_b16 v[96:97], v16 offset:112
  ds_read_b64_tr_b16 v[98:99], v16 offset:288
  s_waitcnt lgkmcnt(4)
  v_mfma_f32_32x32x16_bf16 v[144:159], v[80:83], v[88:91], v[144:159]
  ds_read_b128 v[84:87], v13 offset:0
  ds_read_b64_tr_b16 v[100:101], v16 offset:2816
  ds_read_b64_tr_b16 v[102:103], v16 offset:2992
  s_waitcnt lgkmcnt(5)
  v_mfma_f32_32x32x16_bf16 v[160:175], v[80:83], v[92:95], v[160:175]
  ds_read_b64_tr_b16 v[104:105], v16 offset:2872
  ds_read_b64_tr_b16 v[106:107], v16 offset:3048
  s_waitcnt lgkmcnt(5)
  v_mfma_f32_32x32x16_bf16 v[176:191], v[80:83], v[96:99], v[176:191]
  ds_read_b64_tr_b16 v[108:109], v16 offset:2928
  ds_read_b64_tr_b16 v[110:111], v16 offset:3104
  s_waitcnt lgkmcnt(4)
  v_mfma_f32_32x32x16_bf16 v[144:159], v[84:87], v[100:103], v[144:159]
  ds_read_b128 v[80:83], v14 offset:0
  ds_read_b64_tr_b16 v[88:89], v16 offset:5632
  ds_read_b64_tr_b16 v[90:91], v16 offset:5808
  s_waitcnt lgkmcnt(5)
  v_mfma_f32_32x32x16_bf16 v[160:175], v[84:87], v[104:107], v[160:175]
  ds_read_b64_tr_b16 v[92:93], v16 offset:5688
  ds_read_b64_tr_b16 v[94:95], v16 offset:5864
  s_waitcnt lgkmcnt(5)
  v_mfma_f32_32x32x16_bf16 v[176:191], v[84:87], v[108:111], v[176:191]
  ds_read_b64_tr_b16 v[96:97], v16 offset:5744
  ds_read_b64_tr_b16 v[98:99], v16 offset:5920
  s_waitcnt lgkmcnt(4)
  v_mfma_f32_32x32x16_bf16 v[144:159], v[80:83], v[88:91], v[144:159]
  ds_read_b128 v[84:87], v15 offset:0
  ds_read_b64_tr_b16 v[100:101], v16 offset:8448
  ds_read_b64_tr_b16 v[102:103], v16 offset:8624
  s_waitcnt lgkmcnt(5)
  v_mfma_f32_32x32x16_bf16 v[160:175], v[80:83], v[92:95], v[160:175]
  ds_read_b64_tr_b16 v[104:105], v16 offset:8504
  ds_read_b64_tr_b16 v[106:107], v16 offset:8680
  s_waitcnt lgkmcnt(5)
  v_mfma_f32_32x32x16_bf16 v[176:191], v[80:83], v[96:99], v[176:191]
  ds_read_b64_tr_b16 v[108:109], v16 offset:8560
  ds_read_b64_tr_b16 v[110:111], v16 offset:8736
  s_waitcnt vmcnt(0) lgkmcnt(0)
  s_barrier
  s_cmp_lg_u32 s3, 0
  s_cbranch_scc1 LsigB_29
  v_readfirstlane_b32 s47, v31
  s_cmp_lg_u32 s47, 0
  s_cbranch_scc1 Linited_30
  s_mov_b32 s68, 200000
Linitspin_31:
  buffer_load_dword v31, v30, s[36:39], 0 offen sc1
  s_waitcnt vmcnt(0)
  v_readfirstlane_b32 s47, v31
  s_cmp_lg_u32 s47, 0
  s_cbranch_scc1 Linited_30
  s_sub_u32 s68, s68, 1
  s_cmp_lg_u32 s68, 0
  s_cbranch_scc1 Linitspin_31
Linited_30:
  s_mov_b64 exec, 1
  v_mov_b32 v1, 1
  s_lshl_b32 s47, s23, 8
  s_add_u32 s47, s47, 4096
  v_mov_b32 v29, s47
  buffer_atomic_add v1, v29, s[64:67], 0 offen sc1
  s_mov_b64 exec, -1
LsigB_29:
  v_mfma_f32_32x32x16_bf16 v[144:159], v[84:87], v[100:103], v[144:159]
  ds_read_b128 v[80:83], v12 offset:16384
  ds_read_b64_tr_b16 v[88:89], v16 offset:11264
  ds_read_b64_tr_b16 v[90:91], v16 offset:11440
  v_mfma_f32_32x32x16_bf16 v[160:175], v[84:87], v[104:107], v[160:175]
  ds_read_b64_tr_b16 v[92:93], v16 offset:11320
  ds_read_b64_tr_b16 v[94:95], v16 offset:11496
  v_mfma_f32_32x32x16_bf16 v[176:191], v[84:87], v[108:111], v[176:191]
  ds_read_b64_tr_b16 v[96:97], v16 offset:11376
  ds_read_b64_tr_b16 v[98:99], v16 offset:11552
  s_waitcnt lgkmcnt(4)
  v_mfma_f32_32x32x16_bf16 v[144:159], v[80:83], v[88:91], v[144:159]
  ds_read_b128 v[84:87], v13 offset:16384
  ds_read_b64_tr_b16 v[100:101], v16 offset:14080
  ds_read_b64_tr_b16 v[102:103], v16 offset:14256
  s_waitcnt lgkmcnt(5)
  v_mfma_f32_32x32x16_bf16 v[160:175], v[80:83], v[92:95], v[160:175]
  ds_read_b64_tr_b16 v[104:105], v16 offset:14136
  ds_read_b64_tr_b16 v[106:107], v16 offset:14312
  s_waitcnt lgkmcnt(5)
  v_mfma_f32_32x32x16_bf16 v[176:191], v[80:83], v[96:99], v[176:191]
  ds_read_b64_tr_b16 v[108:109], v16 offset:14192
  ds_read_b64_tr_b16 v[110:111], v16 offset:14368
  s_waitcnt lgkmcnt(4)
  v_mfma_f32_32x32x16_bf16 v[144:159], v[84:87], v[100:103], v[144:159]
  ds_read_b128 v[80:83], v14 offset:16384
  ds_read_b64_tr_b16 v[88:89], v16 offset:16896
  ds_read_b64_tr_b16 v[90:91], v16 offset:17072
  s_waitcnt lgkmcnt(5)
  v_mfma_f32_32x32x16_bf16 v[160:175], v[84:87], v[104:107], v[160:175]
  ds_read_b64_tr_b16 v[92:93], v16 offset:16952
  ds_read_b64_tr_b16 v[94:95], v16 offset:17128
  s_waitcnt lgkmcnt(5)
  v_mfma_f32_32x32x16_bf16 v[176:191], v[84:87], v[108:111], v[176:191]
  ds_read_b64_tr_b16 v[96:97], v16 offset:17008
  ds_read_b64_tr_b16 v[98:99], v16 offset:17184
  s_waitcnt lgkmcnt(4)
  v_mfma_f32_32x32x16_bf16 v[144:159], v[80:83], v[88:91], v[144:159]
  ds_read_b128 v[84:87], v15 offset:16384
  ds_read_b64_tr_b16 v[100:101], v16 offset:19712
  ds_read_b64_tr_b16 v[102:103], v16 offset:19888
  s_waitcnt lgkmcnt(5)
  v_mfma_f32_32x32x16_bf16 v[160:175], v[80:83], v[92:95], v[160:175]
  ds_read_b64_tr_b16 v[104:105], v16 offset:19768
  ds_read_b64_tr_b16 v[106:107], v16 offset:19944
  s_waitcnt lgkmcnt(5)
  v_mfma_f32_32x32x16_bf16 v[176:191], v[80:83], v[96:99], v[176:191]
  ds_read_b64_tr_b16 v[108:109], v16 offset:19824
  ds_read_b64_tr_b16 v[110:111], v16 offset:20000
  s_waitcnt lgkmcnt(0)
  s_barrier
  v_mfma_f32_32x32x16_bf16 v[144:159], v[84:87], v[100:103], v[144:159]
  ds_read_b128 v[80:83], v12 offset:32768
  ds_read_b64_tr_b16 v[88:89], v16 offset:22528
  ds_read_b64_tr_b16 v[90:91], v16 offset:22704
  v_mfma_f32_32x32x16_bf16 v[160:175], v[84:87], v[104:107], v[160:175]
  ds_read_b64_tr_b16 v[92:93], v16 offset:22584
  ds_read_b64_tr_b16 v[94:95], v16 offset:22760
  v_mfma_f32_32x32x16_bf16 v[176:191], v[84:87], v[108:111], v[176:191]
  ds_read_b64_tr_b16 v[96:97], v16 offset:22640
  ds_read_b64_tr_b16 v[98:99], v16 offset:22816
  s_waitcnt lgkmcnt(4)
  v_mfma_f32_32x32x16_bf16 v[144:159], v[80:83], v[88:91], v[144:159]
  ds_read_b128 v[84:87], v13 offset:32768
  ds_read_b64_tr_b16 v[100:101], v16 offset:25344
  ds_read_b64_tr_b16 v[102:103], v16 offset:25520
  s_waitcnt lgkmcnt(5)
  v_mfma_f32_32x32x16_bf16 v[160:175], v[80:83], v[92:95], v[160:175]
  ds_read_b64_tr_b16 v[104:105], v16 offset:25400
  ds_read_b64_tr_b16 v[106:107], v16 offset:25576
  s_waitcnt lgkmcnt(5)
  v_mfma_f32_32x32x16_bf16 v[176:191], v[80:83], v[96:99], v[176:191]
  ds_read_b64_tr_b16 v[108:109], v16 offset:25456
  ds_read_b64_tr_b16 v[110:111], v16 offset:25632
  s_waitcnt lgkmcnt(4)
  v_mfma_f32_32x32x16_bf16 v[144:159], v[84:87], v[100:103], v[144:159]
  ds_read_b128 v[80:83], v14 offset:32768
  ds_read_b64_tr_b16 v[88:89], v16 offset:28160
  ds_read_b64_tr_b16 v[90:91], v16 offset:28336
  s_waitcnt lgkmcnt(5)
  v_mfma_f32_32x32x16_bf16 v[160:175], v[84:87], v[104:107], v[160:175]
  ds_read_b64_tr_b16 v[92:93], v16 offset:28216
  ds_read_b64_tr_b16 v[94:95], v16 offset:28392
  s_waitcnt lgkmcnt(5)
  v_mfma_f32_32x32x16_bf16 v[176:191], v[84:87], v[108:111], v[176:191]
  ds_read_b64_tr_b16 v[96:97], v16 offset:28272
  ds_read_b64_tr_b16 v[98:99], v16 offset:28448
  s_waitcnt lgkmcnt(4)
  v_mfma_f32_32x32x16_bf16 v[144:159], v[80:83], v[88:91], v[144:159]
  ds_read_b128 v[84:87], v15 offset:32768
  ds_read_b64_tr_b16 v[100:101], v16 offset:30976
  ds_read_b64_tr_b16 v[102:103], v16 offset:31152
  s_waitcnt lgkmcnt(5)
  v_mfma_f32_32x32x16_bf16 v[160:175], v[80:83], v[92:95], v[160:175]
  ds_read_b64_tr_b16 v[104:105], v16 offset:31032
  ds_read_b64_tr_b16 v[106:107], v16 offset:31208
  s_waitcnt lgkmcnt(5)
  v_mfma_f32_32x32x16_bf16 v[176:191], v[80:83], v[96:99], v[176:191]
  ds_read_b64_tr_b16 v[108:109], v16 offset:31088
  ds_read_b64_tr_b16 v[110:111], v16 offset:31264
  s_waitcnt lgkmcnt(0)
  s_barrier
  v_mfma_f32_32x32x16_bf16 v[144:159], v[84:87], v[100:103], v[144:159]
  ds_read_b128 v[80:83], v12 offset:49152
  ds_read_b64_tr_b16 v[88:89], v16 offset:33792
  ds_read_b64_tr_b16 v[90:91], v16 offset:33968
  v_mfma_f32_32x32x16_bf16 v[160:175], v[84:87], v[104:107], v[160:175]
  ds_read_b64_tr_b16 v[92:93], v16 offset:33848
  ds_read_b64_tr_b16 v[94:95], v16 offset:34024
  v_mfma_f32_32x32x16_bf16 v[176:191], v[84:87], v[108:111], v[176:191]
  ds_read_b64_tr_b16 v[96:97], v16 offset:33904
  ds_read_b64_tr_b16 v[98:99], v16 offset:34080
  s_waitcnt lgkmcnt(4)
  v_mfma_f32_32x32x16_bf16 v[144:159], v[80:83], v[88:91], v[144:159]
  ds_read_b128 v[84:87], v13 offset:49152
  ds_read_b64_tr_b16 v[100:101], v16 offset:36608
  ds_read_b64_tr_b16 v[102:103], v16 offset:36784
  s_waitcnt lgkmcnt(5)
  v_mfma_f32_32x32x16_bf16 v[160:175], v[80:83], v[92:95], v[160:175]
  ds_read_b64_tr_b16 v[104:105], v16 offset:36664
  ds_read_b64_tr_b16 v[106:107], v16 offset:36840
  s_waitcnt lgkmcnt(5)
  v_mfma_f32_32x32x16_bf16 v[176:191], v[80:83], v[96:99], v[176:191]
  ds_read_b64_tr_b16 v[108:109], v16 offset:36720
  ds_read_b64_tr_b16 v[110:111], v16 offset:36896
  s_waitcnt lgkmcnt(4)
  v_mfma_f32_32x32x16_bf16 v[144:159], v[84:87], v[100:103], v[144:159]
  ds_read_b128 v[80:83], v14 offset:49152
  ds_read_b64_tr_b16 v[88:89], v16 offset:39424
  ds_read_b64_tr_b16 v[90:91], v16 offset:39600
  s_waitcnt lgkmcnt(5)
  v_mfma_f32_32x32x16_bf16 v[160:175], v[84:87], v[104:107], v[160:175]
  ds_read_b64_tr_b16 v[92:93], v16 offset:39480
  ds_read_b64_tr_b16 v[94:95], v16 offset:39656
  s_waitcnt lgkmcnt(5)
  v_mfma_f32_32x32x16_bf16 v[176:191], v[84:87], v[108:111], v[176:191]
  ds_read_b64_tr_b16 v[96:97], v16 offset:39536
  ds_read_b64_tr_b16 v[98:99], v16 offset:39712
  s_waitcnt lgkmcnt(4)
  v_mfma_f32_32x32x16_bf16 v[144:159], v[80:83], v[88:91], v[144:159]
  ds_read_b128 v[84:87], v15 offset:49152
  ds_read_b64_tr_b16 v[100:101], v16 offset:42240
  ds_read_b64_tr_b16 v[102:103], v16 offset:42416
  s_waitcnt lgkmcnt(5)
  v_mfma_f32_32x32x16_bf16 v[160:175], v[80:83], v[92:95], v[160:175]
  ds_read_b64_tr_b16 v[104:105], v16 offset:42296
  ds_read_b64_tr_b16 v[106:107], v16 offset:42472
  s_waitcnt lgkmcnt(5)
  v_mfma_f32_32x32x16_bf16 v[176:191], v[80:83], v[96:99], v[176:191]
  ds_read_b64_tr_b16 v[108:109], v16 offset:42352
  ds_read_b64_tr_b16 v[110:111], v16 offset:42528
  s_waitcnt lgkmcnt(0)
  s_barrier
  v_mfma_f32_32x32x16_bf16 v[144:159], v[84:87], v[100:103], v[144:159]
  ds_read_b128 v[80:83], v12 offset:0
  ds_read_b64_tr_b16 v[88:89], v16 offset:0
  ds_read_b64_tr_b16 v[90:91], v16 offset:176
  v_mfma_f32_32x32x16_bf16 v[160:175], v[84:87], v[104:107], v[160:175]
  ds_read_b64_tr_b16 v[92:93], v16 offset:56
  ds_read_b64_tr_b16 v[94:95], v16 offset:232
  v_mfma_f32_32x32x16_bf16 v[176:191], v[84:87], v[108:111], v[176:191]
  ds_read_b64_tr_b16 v[96:97], v16 offset:112
  ds_read_b64_tr_b16 v[98:99], v16 offset:288
  s_waitcnt lgkmcnt(4)
  v_mfma_f32_32x32x16_bf16 v[144:159], v[80:83], v[88:91], v[144:159]
  ds_read_b128 v[84:87], v13 offset:0
  ds_read_b64_tr_b16 v[100:101], v16 offset:2816
  ds_read_b64_tr_b16 v[102:103], v16 offset:2992
  s_waitcnt lgkmcnt(5)
  v_mfma_f32_32x32x16_bf16 v[160:175], v[80:83], v[92:95], v[160:175]
  ds_read_b64_tr_b16 v[104:105], v16 offset:2872
  ds_read_b64_tr_b16 v[106:107], v16 offset:3048
  s_waitcnt lgkmcnt(5)
  v_mfma_f32_32x32x16_bf16 v[176:191], v[80:83], v[96:99], v[176:191]
  ds_read_b64_tr_b16 v[108:109], v16 offset:2928
  ds_read_b64_tr_b16 v[110:111], v16 offset:3104
  s_waitcnt lgkmcnt(4)
  v_mfma_f32_32x32x16_bf16 v[144:159], v[84:87], v[100:103], v[144:159]
  ds_read_b128 v[80:83], v14 offset:0
  ds_read_b64_tr_b16 v[88:89], v16 offset:5632
  ds_read_b64_tr_b16 v[90:91], v16 offset:5808
  s_waitcnt lgkmcnt(5)
  v_mfma_f32_32x32x16_bf16 v[160:175], v[84:87], v[104:107], v[160:175]
  ds_read_b64_tr_b16 v[92:93], v16 offset:5688
  ds_read_b64_tr_b16 v[94:95], v16 offset:5864
  s_waitcnt lgkmcnt(5)
  v_mfma_f32_32x32x16_bf16 v[176:191], v[84:87], v[108:111], v[176:191]
  ds_read_b64_tr_b16 v[96:97], v16 offset:5744
  ds_read_b64_tr_b16 v[98:99], v16 offset:5920
  s_waitcnt lgkmcnt(4)
  v_mfma_f32_32x32x16_bf16 v[144:159], v[80:83], v[88:91], v[144:159]
  ds_read_b128 v[84:87], v15 offset:0
  ds_read_b64_tr_b16 v[100:101], v16 offset:8448
  ds_read_b64_tr_b16 v[102:103], v16 offset:8624
  s_waitcnt lgkmcnt(5)
  v_mfma_f32_32x32x16_bf16 v[160:175], v[80:83], v[92:95], v[160:175]
  ds_read_b64_tr_b16 v[104:105], v16 offset:8504
  ds_read_b64_tr_b16 v[106:107], v16 offset:8680
  s_waitcnt lgkmcnt(5)
  v_mfma_f32_32x32x16_bf16 v[176:191], v[80:83], v[96:99], v[176:191]
  ds_read_b64_tr_b16 v[108:109], v16 offset:8560
  ds_read_b64_tr_b16 v[110:111], v16 offset:8736
  s_waitcnt lgkmcnt(0)
  s_barrier
  v_mfma_f32_32x32x16_bf16 v[144:159], v[84:87], v[100:103], v[144:159]
  ds_read_b128 v[80:83], v12 offset:16384
  ds_read_b64_tr_b16 v[88:89], v16 offset:11264
  ds_read_b64_tr_b16 v[90:91], v16 offset:11440
  v_mfma_f32_32x32x16_bf16 v[160:175], v[84:87], v[104:107], v[160:175]
  ds_read_b64_tr_b16 v[92:93], v16 offset:11320
  ds_read_b64_tr_b16 v[94:95], v16 offset:11496
  v_mfma_f32_32x32x16_bf16 v[176:191], v[84:87], v[108:111], v[176:191]
  ds_read_b64_tr_b16 v[96:97], v16 offset:11376
  ds_read_b64_tr_b16 v[98:99], v16 offset:11552
  s_waitcnt lgkmcnt(4)
  v_mfma_f32_32x32x16_bf16 v[144:159], v[80:83], v[88:91], v[144:159]
  ds_read_b128 v[84:87], v13 offset:16384
  ds_read_b64_tr_b16 v[100:101], v16 offset:14080
  ds_read_b64_tr_b16 v[102:103], v16 offset:14256
  s_waitcnt lgkmcnt(5)
  v_mfma_f32_32x32x16_bf16 v[160:175], v[80:83], v[92:95], v[160:175]
  ds_read_b64_tr_b16 v[104:105], v16 offset:14136
  ds_read_b64_tr_b16 v[106:107], v16 offset:14312
  s_waitcnt lgkmcnt(5)
  v_mfma_f32_32x32x16_bf16 v[176:191], v[80:83], v[96:99], v[176:191]
  ds_read_b64_tr_b16 v[108:109], v16 offset:14192
  ds_read_b64_tr_b16 v[110:111], v16 offset:14368
  s_waitcnt lgkmcnt(4)
  v_mfma_f32_32x32x16_bf16 v[144:159], v[84:87], v[100:103], v[144:159]
  ds_read_b128 v[80:83], v14 offset:16384
  ds_read_b64_tr_b16 v[88:89], v16 offset:16896
  ds_read_b64_tr_b16 v[90:91], v16 offset:17072
  s_waitcnt lgkmcnt(5)
  v_mfma_f32_32x32x16_bf16 v[160:175], v[84:87], v[104:107], v[160:175]
  ds_read_b64_tr_b16 v[92:93], v16 offset:16952
  ds_read_b64_tr_b16 v[94:95], v16 offset:17128
  s_waitcnt lgkmcnt(5)
  v_mfma_f32_32x32x16_bf16 v[176:191], v[84:87], v[108:111], v[176:191]
  ds_read_b64_tr_b16 v[96:97], v16 offset:17008
  ds_read_b64_tr_b16 v[98:99], v16 offset:17184
  s_waitcnt lgkmcnt(4)
  v_mfma_f32_32x32x16_bf16 v[144:159], v[80:83], v[88:91], v[144:159]
  ds_read_b128 v[84:87], v15 offset:16384
  ds_read_b64_tr_b16 v[100:101], v16 offset:19712
  ds_read_b64_tr_b16 v[102:103], v16 offset:19888
  s_waitcnt lgkmcnt(5)
  v_mfma_f32_32x32x16_bf16 v[160:175], v[80:83], v[92:95], v[160:175]
  ds_read_b64_tr_b16 v[104:105], v16 offset:19768
  ds_read_b64_tr_b16 v[106:107], v16 offset:19944
  s_waitcnt lgkmcnt(5)
  v_mfma_f32_32x32x16_bf16 v[176:191], v[80:83], v[96:99], v[176:191]
  ds_read_b64_tr_b16 v[108:109], v16 offset:19824
  ds_read_b64_tr_b16 v[110:111], v16 offset:20000
  s_waitcnt lgkmcnt(4)
  v_mfma_f32_32x32x16_bf16 v[144:159], v[84:87], v[100:103], v[144:159]
  s_waitcnt lgkmcnt(2)
  v_mfma_f32_32x32x16_bf16 v[160:175], v[84:87], v[104:107], v[160:175]
  s_waitcnt lgkmcnt(0)
  v_mfma_f32_32x32x16_bf16 v[176:191], v[84:87], v[108:111], v[176:191]
  s_barrier
  s_and_b32 s40, s2, 7
  s_bfe_u32 s41, s2, 0x10003
  s_lshl_b32 s40, s40, 1
  s_add_u32 s40, s40, s41
  s_lshl_b32 s47, s40, 18
  s_add_u32 s47, s47, 8388608
  s_add_u32 s32, s20, s47
  s_addc_u32 s33, s21, 0
  s_mov_b32 s34, 0x40000
  s_mov_b32 s35, 0x20000
  s_lshl_b32 s55, s3, 12
  s_add_u32 s54, s55, 0
  s_add_u32 m0, s55, 0
  s_nop 0
  buffer_load_dwordx4 v2, s[32:35], s54 offen offset:0 lds
  buffer_load_dwordx4 v2, s[32:35], s54 offen offset:1024 lds
  buffer_load_dwordx4 v2, s[32:35], s54 offen offset:2048 lds
  buffer_load_dwordx4 v2, s[32:35], s54 offen offset:3072 lds
  s_add_u32 s54, s55, 32768
  s_add_u32 m0, s55, 32768
  s_nop 0
  buffer_load_dwordx4 v2, s[32:35], s54 offen offset:0 lds
  buffer_load_dwordx4 v2, s[32:35], s54 offen offset:1024 lds
  buffer_load_dwordx4 v2, s[32:35], s54 offen offset:2048 lds
  buffer_load_dwordx4 v2, s[32:35], s54 offen offset:3072 lds
  s_lshl_b32 s54, s22, 2
  s_add_u32 s54, s54, s3
  s_add_u32 s62, s63, 0
  s_and_b32 s56, s62, 15
  s_lshl_b32 s56, s56, 6
  s_add_u32 s56, s56, s54
  s_lshl_b32 s56, s56, 12
  s_add_u32 s48, s56, 4196352
  v_cvt_pk_bf16_f32 v208, v144, v145
  v_cvt_pk_bf16_f32 v209, v146, v147
  v_cvt_pk_bf16_f32 v210, v148, v149
  v_cvt_pk_bf16_f32 v211, v150, v151
  v_cvt_pk_bf16_f32 v212, v152, v153
  v_cvt_pk_bf16_f32 v213, v154, v155
  v_cvt_pk_bf16_f32 v214, v156, v157
  v_cvt_pk_bf16_f32 v215, v158, v159
  v_cndmask_b32_e64 v208, v208, v18, s[58:59]
  v_cndmask_b32_e64 v209, v209, v18, s[58:59]
  v_cndmask_b32_e64 v210, v210, v18, s[58:59]
  v_cndmask_b32_e64 v211, v211, v18, s[58:59]
  v_cndmask_b32_e64 v212, v212, v18, s[58:59]
  v_cndmask_b32_e64 v213, v213, v18, s[58:59]
  v_cndmask_b32_e64 v214, v214, v18, s[58:59]
  v_cndmask_b32_e64 v215, v215, v18, s[58:59]
  s_add_u32 s62, s63, 1
  s_and_b32 s56, s62, 15
  s_lshl_b32 s56, s56, 6
  s_add_u32 s56, s56, s54
  s_lshl_b32 s56, s56, 12
  s_add_u32 s49, s56, 4196352
  v_cvt_pk_bf16_f32 v216, v160, v161
  v_cvt_pk_bf16_f32 v217, v162, v163
  v_cvt_pk_bf16_f32 v218, v164, v165
  v_cvt_pk_bf16_f32 v219, v166, v167
  v_cvt_pk_bf16_f32 v220, v168, v169
  v_cvt_pk_bf16_f32 v221, v170, v171
  v_cvt_pk_bf16_f32 v222, v172, v173
  v_cvt_pk_bf16_f32 v223, v174, v175
  v_cndmask_b32_e64 v216, v216, v18, s[58:59]
  v_cndmask_b32_e64 v217, v217, v18, s[58:59]
  v_cndmask_b32_e64 v218, v218, v18, s[58:59]
  v_cndmask_b32_e64 v219, v219, v18, s[58:59]
  v_cndmask_b32_e64 v220, v220, v18, s[58:59]
  v_cndmask_b32_e64 v221, v221, v18, s[58:59]
  v_cndmask_b32_e64 v222, v222, v18, s[58:59]
  v_cndmask_b32_e64 v223, v223, v18, s[58:59]
  s_add_u32 s62, s63, 2
  s_and_b32 s56, s62, 15
  s_lshl_b32 s56, s56, 6
  s_add_u32 s56, s56, s54
  s_lshl_b32 s56, s56, 12
  s_add_u32 s53, s56, 4196352
  v_cvt_pk_bf16_f32 v224, v176, v177
  v_cvt_pk_bf16_f32 v225, v178, v179
  v_cvt_pk_bf16_f32 v226, v180, v181
  v_cvt_pk_bf16_f32 v227, v182, v183
  v_cvt_pk_bf16_f32 v228, v184, v185
  v_cvt_pk_bf16_f32 v229, v186, v187
  v_cvt_pk_bf16_f32 v230, v188, v189
  v_cvt_pk_bf16_f32 v231, v190, v191
  v_cndmask_b32_e64 v224, v224, v18, s[58:59]
  v_cndmask_b32_e64 v225, v225, v18, s[58:59]
  v_cndmask_b32_e64 v226, v226, v18, s[58:59]
  v_cndmask_b32_e64 v227, v227, v18, s[58:59]
  v_cndmask_b32_e64 v228, v228, v18, s[58:59]
  v_cndmask_b32_e64 v229, v229, v18, s[58:59]
  v_cndmask_b32_e64 v230, v230, v18, s[58:59]
  v_cndmask_b32_e64 v231, v231, v18, s[58:59]
  s_branch Lqkv_fin
Lqkv_v3:
  s_barrier
  ds_read_b128 v[80:83], v12 offset:0
  ds_read_b64_tr_b16 v[88:89], v16 offset:0
  ds_read_b64_tr_b16 v[90:91], v16 offset:176
  ds_read_b64_tr_b16 v[92:93], v16 offset:56
  ds_read_b64_tr_b16 v[94:95], v16 offset:232
  ds_read_b64_tr_b16 v[96:97], v16 offset:112
  ds_read_b64_tr_b16 v[98:99], v16 offset:288
  s_cmp_ge_u32 s3, 2
  s_cbranch_scc1 Lpf5_32
  s_cmp_eq_u32 s3, 0
  s_cselect_b32 s24, s8, s14
  s_cselect_b32 s25, s9, s15
  s_mov_b32 s26, 401408
  s_mov_b32 s27, 0x20000
  s_mul_i32 s46, s2, 1568
  v_add_u32 v20, s46, v2
  buffer_load_dwordx4 v[168:171], v20, s[24:27], 0 offen offset:0
  buffer_load_dwordx4 v[172:175], v20, s[24:27], 0 offen offset:1024
Lpf5_32:
  s_waitcnt lgkmcnt(4)
  v_mfma_f32_32x32x16_bf16 v[32:47], v[80:83], v[88:91], 0
  ds_read_b128 v[84:87], v13 offset:0
  ds_read_b64_tr_b16 v[100:101], v16 offset:2816
  ds_read_b64_tr_b16 v[102:103], v16 offset:2992
  s_waitcnt lgkmcnt(5)
  v_mfma_f32_32x32x16_bf16 v[48:63], v[80:83], v[92:95], 0
  ds_read_b64_tr_b16 v[104:105], v16 offset:2872
  ds_read_b64_tr_b16 v[106:107], v16 offset:3048
  s_waitcnt lgkmcnt(5)
  v_mfma_f32_32x32x16_bf16 v[64:79], v[80:83], v[96:99], 0
  ds_read_b64_tr_b16 v[108:109], v16 offset:2928
  ds_read_b64_tr_b16 v[110:111], v16 offset:3104
  s_waitcnt lgkmcnt(4)
  v_mfma_f32_32x32x16_bf16 v[32:47], v[84:87], v[100:103], v[32:47]
  ds_read_b128 v[80:83], v14 offset:0
  ds_read_b64_tr_b16 v[88:89], v16 offset:5632
  ds_read_b64_tr_b16 v[90:91], v16 offset:5808
  s_waitcnt lgkmcnt(5)
  v_mfma_f32_32x32x16_bf16 v[48:63], v[84:87], v[104:107], v[48:63]
  ds_read_b64_tr_b16 v[92:93], v16 offset:5688
  ds_read_b64_tr_b16 v[94:95], v16 offset:5864
  s_waitcnt lgkmcnt(5)
  v_mfma_f32_32x32x16_bf16 v[64:79], v[84:87], v[108:111], v[64:79]
  ds_read_b64_tr_b16 v[96:97], v16 offset:5744
  ds_read_b64_tr_b16 v[98:99], v16 offset:5920
  s_waitcnt lgkmcnt(4)
  v_mfma_f32_32x32x16_bf16 v[32:47], v[80:83], v[88:91], v[32:47]
  ds_read_b128 v[84:87], v15 offset:0
  ds_read_b64_tr_b16 v[100:101], v16 offset:8448
  ds_read_b64_tr_b16 v[102:103], v16 offset:8624
  s_waitcnt lgkmcnt(5)
  v_mfma_f32_32x32x16_bf16 v[48:63], v[80:83], v[92:95], v[48:63]
  ds_read_b64_tr_b16 v[104:105], v16 offset:8504
  ds_read_b64_tr_b16 v[106:107], v16 offset:8680
  s_waitcnt lgkmcnt(5)
  v_mfma_f32_32x32x16_bf16 v[64:79], v[80:83], v[96:99], v[64:79]
  ds_read_b64_tr_b16 v[108:109], v16 offset:8560
  ds_read_b64_tr_b16 v[110:111], v16 offset:8736
  s_waitcnt lgkmcnt(0)
  s_barrier
  v_mfma_f32_32x32x16_bf16 v[32:47], v[84:87], v[100:103], v[32:47]
  ds_read_b128 v[80:83], v12 offset:16384
  ds_read_b64_tr_b16 v[88:89], v16 offset:11264
  ds_read_b64_tr_b16 v[90:91], v16 offset:11440
  v_mfma_f32_32x32x16_bf16 v[48:63], v[84:87], v[104:107], v[48:63]
  ds_read_b64_tr_b16 v[92:93], v16 offset:11320
  ds_read_b64_tr_b16 v[94:95], v16 offset:11496
  v_mfma_f32_32x32x16_bf16 v[64:79], v[84:87], v[108:111], v[64:79]
  ds_read_b64_tr_b16 v[96:97], v16 offset:11376
  ds_read_b64_tr_b16 v[98:99], v16 offset:11552
  s_waitcnt lgkmcnt(4)
  v_mfma_f32_32x32x16_bf16 v[32:47], v[80:83], v[88:91], v[32:47]
  ds_read_b128 v[84:87], v13 offset:16384
  ds_read_b64_tr_b16 v[100:101], v16 offset:14080
  ds_read_b64_tr_b16 v[102:103], v16 offset:14256
  s_waitcnt lgkmcnt(5)
  v_mfma_f32_32x32x16_bf16 v[48:63], v[80:83], v[92:95], v[48:63]
  ds_read_b64_tr_b16 v[104:105], v16 offset:14136
  ds_read_b64_tr_b16 v[106:107], v16 offset:14312
  s_waitcnt lgkmcnt(5)
  v_mfma_f32_32x32x16_bf16 v[64:79], v[80:83], v[96:99], v[64:79]
  ds_read_b64_tr_b16 v[108:109], v16 offset:14192
  ds_read_b64_tr_b16 v[110:111], v16 offset:14368
  s_waitcnt lgkmcnt(4)
  v_mfma_f32_32x32x16_bf16 v[32:47], v[84:87], v[100:103], v[32:47]
  ds_read_b128 v[80:83], v14 offset:16384
  ds_read_b64_tr_b16 v[88:89], v16 offset:16896
  ds_read_b64_tr_b16 v[90:91], v16 offset:17072
  s_waitcnt lgkmcnt(5)
  v_mfma_f32_32x32x16_bf16 v[48:63], v[84:87], v[104:107], v[48:63]
  ds_read_b64_tr_b16 v[92:93], v16 offset:16952
  ds_read_b64_tr_b16 v[94:95], v16 offset:17128
  s_waitcnt lgkmcnt(5)
  v_mfma_f32_32x32x16_bf16 v[64:79], v[84:87], v[108:111], v[64:79]
  ds_read_b64_tr_b16 v[96:97], v16 offset:17008
  ds_read_b64_tr_b16 v[98:99], v16 offset:17184
  s_waitcnt lgkmcnt(4)
  v_mfma_f32_32x32x16_bf16 v[32:47], v[80:83], v[88:91], v[32:47]
  ds_read_b128 v[84:87], v15 offset:16384
  ds_read_b64_tr_b16 v[100:101], v16 offset:19712
  ds_read_b64_tr_b16 v[102:103], v16 offset:19888
  s_waitcnt lgkmcnt(5)
  v_mfma_f32_32x32x16_bf16 v[48:63], v[80:83], v[92:95], v[48:63]
  ds_read_b64_tr_b16 v[104:105], v16 offset:19768
  ds_read_b64_tr_b16 v[106:107], v16 offset:19944
  s_waitcnt lgkmcnt(5)
  v_mfma_f32_32x32x16_bf16 v[64:79], v[80:83], v[96:99], v[64:79]
  ds_read_b64_tr_b16 v[108:109], v16 offset:19824
  ds_read_b64_tr_b16 v[110:111], v16 offset:20000
  s_waitcnt lgkmcnt(0)
  s_barrier
  v_mfma_f32_32x32x16_bf16 v[32:47], v[84:87], v[100:103], v[32:47]
  ds_read_b128 v[80:83], v12 offset:32768
  ds_read_b64_tr_b16 v[88:89], v16 offset:22528
  ds_read_b64_tr_b16 v[90:91], v16 offset:22704
  v_mfma_f32_32x32x16_bf16 v[48:63], v[84:87], v[104:107], v[48:63]
  ds_read_b64_tr_b16 v[92:93], v16 offset:22584
  ds_read_b64_tr_b16 v[94:95], v16 offset:22760
  v_mfma_f32_32x32x16_bf16 v[64:79], v[84:87], v[108:111], v[64:79]
  ds_read_b64_tr_b16 v[96:97], v16 offset:22640
  ds_read_b64_tr_b16 v[98:99], v16 offset:22816
  s_waitcnt lgkmcnt(4)
  v_mfma_f32_32x32x16_bf16 v[32:47], v[80:83], v[88:91], v[32:47]
  ds_read_b128 v[84:87], v13 offset:32768
  ds_read_b64_tr_b16 v[100:101], v16 offset:25344
  ds_read_b64_tr_b16 v[102:103], v16 offset:25520
  s_waitcnt lgkmcnt(5)
  v_mfma_f32_32x32x16_bf16 v[48:63], v[80:83], v[92:95], v[48:63]
  ds_read_b64_tr_b16 v[104:105], v16 offset:25400
  ds_read_b64_tr_b16 v[106:107], v16 offset:25576
  s_waitcnt lgkmcnt(5)
  v_mfma_f32_32x32x16_bf16 v[64:79], v[80:83], v[96:99], v[64:79]
  ds_read_b64_tr_b16 v[108:109], v16 offset:25456
  ds_read_b64_tr_b16 v[110:111], v16 offset:25632
  s_waitcnt lgkmcnt(4)
  v_mfma_f32_32x32x16_bf16 v[32:47], v[84:87], v[100:103], v[32:47]
  ds_read_b128 v[80:83], v14 offset:32768
  ds_read_b64_tr_b16 v[88:89], v16 offset:28160
  ds_read_b64_tr_b16 v[90:91], v16 offset:28336
  s_waitcnt lgkmcnt(5)
  v_mfma_f32_32x32x16_bf16 v[48:63], v[84:87], v[104:107], v[48:63]
  ds_read_b64_tr_b16 v[92:93], v16 offset:28216
  ds_read_b64_tr_b16 v[94:95], v16 offset:28392
  s_waitcnt lgkmcnt(5)
  v_mfma_f32_32x32x16_bf16 v[64:79], v[84:87], v[108:111], v[64:79]
  ds_read_b64_tr_b16 v[96:97], v16 offset:28272
  ds_read_b64_tr_b16 v[98:99], v16 offset:28448
  s_waitcnt lgkmcnt(4)
  v_mfma_f32_32x32x16_bf16 v[32:47], v[80:83], v[88:91], v[32:47]
  ds_read_b128 v[84:87], v15 offset:32768
  ds_read_b64_tr_b16 v[100:101], v16 offset:30976
  ds_read_b64_tr_b16 v[102:103], v16 offset:31152
  s_waitcnt lgkmcnt(5)
  v_mfma_f32_32x32x16_bf16 v[48:63], v[80:83], v[92:95], v[48:63]
  ds_read_b64_tr_b16 v[104:105], v16 offset:31032
  ds_read_b64_tr_b16 v[106:107], v16 offset:31208
  s_waitcnt lgkmcnt(5)
  v_mfma_f32_32x32x16_bf16 v[64:79], v[80:83], v[96:99], v[64:79]
  ds_read_b64_tr_b16 v[108:109], v16 offset:31088
  ds_read_b64_tr_b16 v[110:111], v16 offset:31264
  s_waitcnt lgkmcnt(0)
  s_barrier
  v_mfma_f32_32x32x16_bf16 v[32:47], v[84:87], v[100:103], v[32:47]
  ds_read_b128 v[80:83], v12 offset:49152
  ds_read_b64_tr_b16 v[88:89], v16 offset:33792
  ds_read_b64_tr_b16 v[90:91], v16 offset:33968
  v_mfma_f32_32x32x16_bf16 v[48:63], v[84:87], v[104:107], v[48:63]
  ds_read_b64_tr_b16 v[92:93], v16 offset:33848
  ds_read_b64_tr_b16 v[94:95], v16 offset:34024
  v_mfma_f32_32x32x16_bf16 v[64:79], v[84:87], v[108:111], v[64:79]
  ds_read_b64_tr_b16 v[96:97], v16 offset:33904
  ds_read_b64_tr_b16 v[98:99], v16 offset:34080
  s_waitcnt lgkmcnt(4)
  v_mfma_f32_32x32x16_bf16 v[32:47], v[80:83], v[88:91], v[32:47]
  ds_read_b128 v[84:87], v13 offset:49152
  ds_read_b64_tr_b16 v[100:101], v16 offset:36608
  ds_read_b64_tr_b16 v[102:103], v16 offset:36784
  s_waitcnt lgkmcnt(5)
  v_mfma_f32_32x32x16_bf16 v[48:63], v[80:83], v[92:95], v[48:63]
  ds_read_b64_tr_b16 v[104:105], v16 offset:36664
  ds_read_b64_tr_b16 v[106:107], v16 offset:36840
  s_waitcnt lgkmcnt(5)
  v_mfma_f32_32x32x16_bf16 v[64:79], v[80:83], v[96:99], v[64:79]
  ds_read_b64_tr_b16 v[108:109], v16 offset:36720
  ds_read_b64_tr_b16 v[110:111], v16 offset:36896
  s_waitcnt lgkmcnt(4)
  v_mfma_f32_32x32x16_bf16 v[32:47], v[84:87], v[100:103], v[32:47]
  ds_read_b128 v[80:83], v14 offset:49152
  ds_read_b64_tr_b16 v[88:89], v16 offset:39424
  ds_read_b64_tr_b16 v[90:91], v16 offset:39600
  s_waitcnt lgkmcnt(5)
  v_mfma_f32_32x32x16_bf16 v[48:63], v[84:87], v[104:107], v[48:63]
  ds_read_b64_tr_b16 v[92:93], v16 offset:39480
  ds_read_b64_tr_b16 v[94:95], v16 offset:39656
  s_waitcnt lgkmcnt(5)
  v_mfma_f32_32x32x16_bf16 v[64:79], v[84:87], v[108:111], v[64:79]
  ds_read_b64_tr_b16 v[96:97], v16 offset:39536
  ds_read_b64_tr_b16 v[98:99], v16 offset:39712
  s_waitcnt lgkmcnt(4)
  v_mfma_f32_32x32x16_bf16 v[32:47], v[80:83], v[88:91], v[32:47]
  ds_read_b128 v[84:87], v15 offset:49152
  ds_read_b64_tr_b16 v[100:101], v16 offset:42240
  ds_read_b64_tr_b16 v[102:103], v16 offset:42416
  s_waitcnt lgkmcnt(5)
  v_mfma_f32_32x32x16_bf16 v[48:63], v[80:83], v[92:95], v[48:63]
  ds_read_b64_tr_b16 v[104:105], v16 offset:42296
  ds_read_b64_tr_b16 v[106:107], v16 offset:42472
  s_waitcnt lgkmcnt(5)
  v_mfma_f32_32x32x16_bf16 v[64:79], v[80:83], v[96:99], v[64:79]
  ds_read_b64_tr_b16 v[108:109], v16 offset:42352
  ds_read_b64_tr_b16 v[110:111], v16 offset:42528
  s_waitcnt lgkmcnt(0)
  s_barrier
  v_mfma_f32_32x32x16_bf16 v[32:47], v[84:87], v[100:103], v[32:47]
  ds_read_b128 v[80:83], v12 offset:0
  ds_read_b64_tr_b16 v[88:89], v16 offset:0
  ds_read_b64_tr_b16 v[90:91], v16 offset:176
  v_mfma_f32_32x32x16_bf16 v[48:63], v[84:87], v[104:107], v[48:63]
  ds_read_b64_tr_b16 v[92:93], v16 offset:56
  ds_read_b64_tr_b16 v[94:95], v16 offset:232
  v_mfma_f32_32x32x16_bf16 v[64:79], v[84:87], v[108:111], v[64:79]
  ds_read_b64_tr_b16 v[96:97], v16 offset:112
  ds_read_b64_tr_b16 v[98:99], v16 offset:288
  s_waitcnt lgkmcnt(4)
  v_mfma_f32_32x32x16_bf16 v[32:47], v[80:83], v[88:91], v[32:47]
  ds_read_b128 v[84:87], v13 offset:0
  ds_read_b64_tr_b16 v[100:101], v16 offset:2816
  ds_read_b64_tr_b16 v[102:103], v16 offset:2992
  s_waitcnt lgkmcnt(5)
  v_mfma_f32_32x32x16_bf16 v[48:63], v[80:83], v[92:95], v[48:63]
  ds_read_b64_tr_b16 v[104:105], v16 offset:2872
  ds_read_b64_tr_b16 v[106:107], v16 offset:3048
  s_waitcnt lgkmcnt(5)
  v_mfma_f32_32x32x16_bf16 v[64:79], v[80:83], v[96:99], v[64:79]
  ds_read_b64_tr_b16 v[108:109], v16 offset:2928
  ds_read_b64_tr_b16 v[110:111], v16 offset:3104
  s_waitcnt lgkmcnt(4)
  v_mfma_f32_32x32x16_bf16 v[32:47], v[84:87], v[100:103], v[32:47]
  ds_read_b128 v[80:83], v14 offset:0
  ds_read_b64_tr_b16 v[88:89], v16 offset:5632
  ds_read_b64_tr_b16 v[90:91], v16 offset:5808
  s_waitcnt lgkmcnt(5)
  v_mfma_f32_32x32x16_bf16 v[48:63], v[84:87], v[104:107], v[48:63]
  ds_read_b64_tr_b16 v[92:93], v16 offset:5688
  ds_read_b64_tr_b16 v[94:95], v16 offset:5864
  s_waitcnt lgkmcnt(5)
  v_mfma_f32_32x32x16_bf16 v[64:79], v[84:87], v[108:111], v[64:79]
  ds_read_b64_tr_b16 v[96:97], v16 offset:5744
  ds_read_b64_tr_b16 v[98:99], v16 offset:5920
  s_waitcnt lgkmcnt(4)
  v_mfma_f32_32x32x16_bf16 v[32:47], v[80:83], v[88:91], v[32:47]
  ds_read_b128 v[84:87], v15 offset:0
  ds_read_b64_tr_b16 v[100:101], v16 offset:8448
  ds_read_b64_tr_b16 v[102:103], v16 offset:8624
  s_waitcnt lgkmcnt(5)
  v_mfma_f32_32x32x16_bf16 v[48:63], v[80:83], v[92:95], v[48:63]
  ds_read_b64_tr_b16 v[104:105], v16 offset:8504
  ds_read_b64_tr_b16 v[106:107], v16 offset:8680
  s_waitcnt lgkmcnt(5)
  v_mfma_f32_32x32x16_bf16 v[64:79], v[80:83], v[96:99], v[64:79]
  ds_read_b64_tr_b16 v[108:109], v16 offset:8560
  ds_read_b64_tr_b16 v[110:111], v16 offset:8736
  s_waitcnt lgkmcnt(0)
  s_barrier
  v_mfma_f32_32x32x16_bf16 v[32:47], v[84:87], v[100:103], v[32:47]
  ds_read_b128 v[80:83], v12 offset:16384
  ds_read_b64_tr_b16 v[88:89], v16 offset:11264
  ds_read_b64_tr_b16 v[90:91], v16 offset:11440
  v_mfma_f32_32x32x16_bf16 v[48:63], v[84:87], v[104:107], v[48:63]
  ds_read_b64_tr_b16 v[92:93], v16 offset:11320
  ds_read_b64_tr_b16 v[94:95], v16 offset:11496
  v_mfma_f32_32x32x16_bf16 v[64:79], v[84:87], v[108:111], v[64:79]
  ds_read_b64_tr_b16 v[96:97], v16 offset:11376
  ds_read_b64_tr_b16 v[98:99], v16 offset:11552
  s_waitcnt lgkmcnt(4)
  v_mfma_f32_32x32x16_bf16 v[32:47], v[80:83], v[88:91], v[32:47]
  ds_read_b128 v[84:87], v13 offset:16384
  ds_read_b64_tr_b16 v[100:101], v16 offset:14080
  ds_read_b64_tr_b16 v[102:103], v16 offset:14256
  s_waitcnt lgkmcnt(5)
  v_mfma_f32_32x32x16_bf16 v[48:63], v[80:83], v[92:95], v[48:63]
  ds_read_b64_tr_b16 v[104:105], v16 offset:14136
  ds_read_b64_tr_b16 v[106:107], v16 offset:14312
  s_waitcnt lgkmcnt(5)
  v_mfma_f32_32x32x16_bf16 v[64:79], v[80:83], v[96:99], v[64:79]
  ds_read_b64_tr_b16 v[108:109], v16 offset:14192
  ds_read_b64_tr_b16 v[110:111], v16 offset:14368
  s_waitcnt lgkmcnt(4)
  v_mfma_f32_32x32x16_bf16 v[32:47], v[84:87], v[100:103], v[32:47]
  ds_read_b128 v[80:83], v14 offset:16384
  ds_read_b64_tr_b16 v[88:89], v16 offset:16896
  ds_read_b64_tr_b16 v[90:91], v16 offset:17072
  s_waitcnt lgkmcnt(5)
  v_mfma_f32_32x32x16_bf16 v[48:63], v[84:87], v[104:107], v[48:63]
  ds_read_b64_tr_b16 v[92:93], v16 offset:16952
  ds_read_b64_tr_b16 v[94:95], v16 offset:17128
  s_waitcnt lgkmcnt(5)
  v_mfma_f32_32x32x16_bf16 v[64:79], v[84:87], v[108:111], v[64:79]
  ds_read_b64_tr_b16 v[96:97], v16 offset:17008
  ds_read_b64_tr_b16 v[98:99], v16 offset:17184
  s_waitcnt lgkmcnt(4)
  v_mfma_f32_32x32x16_bf16 v[32:47], v[80:83], v[88:91], v[32:47]
  ds_read_b128 v[84:87], v15 offset:16384
  ds_read_b64_tr_b16 v[100:101], v16 offset:19712
  ds_read_b64_tr_b16 v[102:103], v16 offset:19888
  s_waitcnt lgkmcnt(5)
  v_mfma_f32_32x32x16_bf16 v[48:63], v[80:83], v[92:95], v[48:63]
  ds_read_b64_tr_b16 v[104:105], v16 offset:19768
  ds_read_b64_tr_b16 v[106:107], v16 offset:19944
  s_waitcnt lgkmcnt(5)
  v_mfma_f32_32x32x16_bf16 v[64:79], v[80:83], v[96:99], v[64:79]
  ds_read_b64_tr_b16 v[108:109], v16 offset:19824
  ds_read_b64_tr_b16 v[110:111], v16 offset:20000
  s_waitcnt vmcnt(0) lgkmcnt(0)
  s_barrier
  v_mfma_f32_32x32x16_bf16 v[32:47], v[84:87], v[100:103], v[32:47]
  ds_read_b128 v[80:83], v12 offset:32768
  ds_read_b64_tr_b16 v[88:89], v16 offset:22528
  ds_read_b64_tr_b16 v[90:91], v16 offset:22704
  v_mfma_f32_32x32x16_bf16 v[48:63], v[84:87], v[104:107], v[48:63]
  ds_read_b64_tr_b16 v[92:93], v16 offset:22584
  ds_read_b64_tr_b16 v[94:95], v16 offset:22760
  v_mfma_f32_32x32x16_bf16 v[64:79], v[84:87], v[108:111], v[64:79]
  ds_read_b64_tr_b16 v[96:97], v16 offset:22640
  ds_read_b64_tr_b16 v[98:99], v16 offset:22816
  s_waitcnt lgkmcnt(4)
  v_mfma_f32_32x32x16_bf16 v[32:47], v[80:83], v[88:91], v[32:47]
  ds_read_b128 v[84:87], v13 offset:32768
  ds_read_b64_tr_b16 v[100:101], v16 offset:25344
  ds_read_b64_tr_b16 v[102:103], v16 offset:25520
  s_waitcnt lgkmcnt(5)
  v_mfma_f32_32x32x16_bf16 v[48:63], v[80:83], v[92:95], v[48:63]
  ds_read_b64_tr_b16 v[104:105], v16 offset:25400
  ds_read_b64_tr_b16 v[106:107], v16 offset:25576
  s_waitcnt lgkmcnt(5)
  v_mfma_f32_32x32x16_bf16 v[64:79], v[80:83], v[96:99], v[64:79]
  ds_read_b64_tr_b16 v[108:109], v16 offset:25456
  ds_read_b64_tr_b16 v[110:111], v16 offset:25632
  s_waitcnt lgkmcnt(4)
  v_mfma_f32_32x32x16_bf16 v[32:47], v[84:87], v[100:103], v[32:47]
  ds_read_b128 v[80:83], v14 offset:32768
  ds_read_b64_tr_b16 v[88:89], v16 offset:28160
  ds_read_b64_tr_b16 v[90:91], v16 offset:28336
  s_waitcnt lgkmcnt(5)
  v_mfma_f32_32x32x16_bf16 v[48:63], v[84:87], v[104:107], v[48:63]
  ds_read_b64_tr_b16 v[92:93], v16 offset:28216
  ds_read_b64_tr_b16 v[94:95], v16 offset:28392
  s_waitcnt lgkmcnt(5)
  v_mfma_f32_32x32x16_bf16 v[64:79], v[84:87], v[108:111], v[64:79]
  ds_read_b64_tr_b16 v[96:97], v16 offset:28272
  ds_read_b64_tr_b16 v[98:99], v16 offset:28448
  s_waitcnt lgkmcnt(4)
  v_mfma_f32_32x32x16_bf16 v[32:47], v[80:83], v[88:91], v[32:47]
  ds_read_b128 v[84:87], v15 offset:32768
  ds_read_b64_tr_b16 v[100:101], v16 offset:30976
  ds_read_b64_tr_b16 v[102:103], v16 offset:31152
  s_waitcnt lgkmcnt(5)
  v_mfma_f32_32x32x16_bf16 v[48:63], v[80:83], v[92:95], v[48:63]
  ds_read_b64_tr_b16 v[104:105], v16 offset:31032
  ds_read_b64_tr_b16 v[106:107], v16 offset:31208
  s_waitcnt lgkmcnt(5)
  v_mfma_f32_32x32x16_bf16 v[64:79], v[80:83], v[96:99], v[64:79]
  ds_read_b64_tr_b16 v[108:109], v16 offset:31088
  ds_read_b64_tr_b16 v[110:111], v16 offset:31264
  s_waitcnt lgkmcnt(0)
  s_barrier
  v_mfma_f32_32x32x16_bf16 v[32:47], v[84:87], v[100:103], v[32:47]
  ds_read_b128 v[80:83], v12 offset:49152
  ds_read_b64_tr_b16 v[88:89], v16 offset:33792
  ds_read_b64_tr_b16 v[90:91], v16 offset:33968
  v_mfma_f32_32x32x16_bf16 v[48:63], v[84:87], v[104:107], v[48:63]
  ds_read_b64_tr_b16 v[92:93], v16 offset:33848
  ds_read_b64_tr_b16 v[94:95], v16 offset:34024
  v_mfma_f32_32x32x16_bf16 v[64:79], v[84:87], v[108:111], v[64:79]
  ds_read_b64_tr_b16 v[96:97], v16 offset:33904
  ds_read_b64_tr_b16 v[98:99], v16 offset:34080
  s_waitcnt lgkmcnt(4)
  v_mfma_f32_32x32x16_bf16 v[144:159], v[80:83], v[88:91], 0
  ds_read_b128 v[84:87], v13 offset:49152
  ds_read_b64_tr_b16 v[100:101], v16 offset:36608
  ds_read_b64_tr_b16 v[102:103], v16 offset:36784
  s_nop 7
  s_lshl_b32 s54, s22, 2
  s_add_u32 s54, s54, s3
  s_add_u32 s54, s54, 1024
  s_add_u32 s62, s52, 0
  s_and_b32 s56, s62, 15
  s_lshl_b32 s56, s56, 6
  s_add_u32 s56, s56, s54
  s_lshl_b32 s56, s56, 12
  s_add_u32 s48, s56, 4196352
  v_cvt_pk_bf16_f32 v112, v32, v33
  v_cvt_pk_bf16_f32 v113, v34, v35
  v_cvt_pk_bf16_f32 v114, v36, v37
  s_waitcnt lgkmcnt(5)
  v_mfma_f32_32x32x16_bf16 v[160:175], v[80:83], v[92:95], 0
  ds_read_b64_tr_b16 v[104:105], v16 offset:36664
  ds_read_b64_tr_b16 v[106:107], v16 offset:36840
  v_cvt_pk_bf16_f32 v115, v38, v39
  v_cvt_pk_bf16_f32 v116, v40, v41
  v_cvt_pk_bf16_f32 v117, v42, v43
  v_cvt_pk_bf16_f32 v118, v44, v45
  v_cvt_pk_bf16_f32 v119, v46, v47
  v_cndmask_b32_e64 v112, v112, v18, s[58:59]
  v_cndmask_b32_e64 v113, v113, v18, s[58:59]
  v_cndmask_b32_e64 v114, v114, v18, s[58:59]
  v_cndmask_b32_e64 v115, v115, v18, s[58:59]
  v_cndmask_b32_e64 v116, v116, v18, s[58:59]
  v_cndmask_b32_e64 v117, v117, v18, s[58:59]
  v_cndmask_b32_e64 v118, v118, v18, s[58:59]
  v_cndmask_b32_e64 v119, v119, v18, s[58:59]
  s_waitcnt lgkmcnt(5)
  v_mfma_f32_32x32x16_bf16 v[176:191], v[80:83], v[96:99], 0
  ds_read_b64_tr_b16 v[108:109], v16 offset:36720
  ds_read_b64_tr_b16 v[110:111], v16 offset:36896
  s_nop 1
  buffer_store_dwordx4 v[112:115], v2, s[32:35], s48 offen sc1
  buffer_store_dwordx4 v[116:119], v2, s[32:35], s48 offen offset:1024 sc1
  s_add_u32 s62, s52, 1
  s_and_b32 s56, s62, 15
  s_lshl_b32 s56, s56, 6
  s_add_u32 s56, s56, s54
  s_lshl_b32 s56, s56, 12
  s_add_u32 s49, s56, 4196352
  v_cvt_pk_bf16_f32 v120, v48, v49
  v_cvt_pk_bf16_f32 v121, v50, v51
  v_cvt_pk_bf16_f32 v122, v52, v53
  v_cvt_pk_bf16_f32 v123, v54, v55
  v_cvt_pk_bf16_f32 v124, v56, v57
  s_waitcnt lgkmcnt(4)
  v_mfma_f32_32x32x16_bf16 v[144:159], v[84:87], v[100:103], v[144:159]
  ds_read_b128 v[80:83], v14 offset:49152
  ds_read_b64_tr_b16 v[88:89], v16 offset:39424
  ds_read_b64_tr_b16 v[90:91], v16 offset:39600
  v_cvt_pk_bf16_f32 v125, v58, v59
  v_cvt_pk_bf16_f32 v126, v60, v61
  v_cvt_pk_bf16_f32 v127, v62, v63
  v_cndmask_b32_e64 v120, v120, v18, s[58:59]
  v_cndmask_b32_e64 v121, v121, v18, s[58:59]
  v_cndmask_b32_e64 v122, v122, v18, s[58:59]
  v_cndmask_b32_e64 v123, v123, v18, s[58:59]
  v_cndmask_b32_e64 v124, v124, v18, s[58:59]
  v_cndmask_b32_e64 v125, v125, v18, s[58:59]
  v_cndmask_b32_e64 v126, v126, v18, s[58:59]
  v_cndmask_b32_e64 v127, v127, v18, s[58:59]
  s_nop 1
  buffer_store_dwordx4 v[120:123], v2, s[32:35], s49 offen sc1
  buffer_store_dwordx4 v[124:127], v2, s[32:35], s49 offen offset:1024 sc1
  s_waitcnt lgkmcnt(5)
  v_mfma_f32_32x32x16_bf16 v[160:175], v[84:87], v[104:107], v[160:175]
  ds_read_b64_tr_b16 v[92:93], v16 offset:39480
  ds_read_b64_tr_b16 v[94:95], v16 offset:39656
  s_add_u32 s62, s52, 2
  s_and_b32 s56, s62, 15
  s_lshl_b32 s56, s56, 6
  s_add_u32 s56, s56, s54
  s_lshl_b32 s56, s56, 12
  s_add_u32 s53, s56, 4196352
  v_cvt_pk_bf16_f32 v128, v64, v65
  v_cvt_pk_bf16_f32 v129, v66, v67
  v_cvt_pk_bf16_f32 v130, v68, v69
  v_cvt_pk_bf16_f32 v131, v70, v71
  v_cvt_pk_bf16_f32 v132, v72, v73
  v_cvt_pk_bf16_f32 v133, v74, v75
  v_cvt_pk_bf16_f32 v134, v76, v77
  s_waitcnt lgkmcnt(5)
  v_mfma_f32_32x32x16_bf16 v[176:191], v[84:87], v[108:111], v[176:191]
  ds_read_b64_tr_b16 v[96:97], v16 offset:39536
  ds_read_b64_tr_b16 v[98:99], v16 offset:39712
  v_cvt_pk_bf16_f32 v135, v78, v79
  v_cndmask_b32_e64 v128, v128, v18, s[58:59]
  v_cndmask_b32_e64 v129, v129, v18, s[58:59]
  v_cndmask_b32_e64 v130, v130, v18, s[58:59]
  v_cndmask_b32_e64 v131, v131, v18, s[58:59]
  v_cndmask_b32_e64 v132, v132, v18, s[58:59]
  v_cndmask_b32_e64 v133, v133, v18, s[58:59]
  v_cndmask_b32_e64 v134, v134, v18, s[58:59]
  v_cndmask_b32_e64 v135, v135, v18, s[58:59]
  s_nop 1
  buffer_store_dwordx4 v[128:131], v2, s[32:35], s53 offen sc1
  buffer_store_dwordx4 v[132:135], v2, s[32:35], s53 offen offset:1024 sc1
  s_waitcnt lgkmcnt(4)
  v_mfma_f32_32x32x16_bf16 v[144:159], v[80:83], v[88:91], v[144:159]
  ds_read_b128 v[84:87], v15 offset:49152
  ds_read_b64_tr_b16 v[100:101], v16 offset:42240
  ds_read_b64_tr_b16 v[102:103], v16 offset:42416
  s_waitcnt lgkmcnt(5)
  v_mfma_f32_32x32x16_bf16 v[160:175], v[80:83], v[92:95], v[160:175]
  ds_read_b64_tr_b16 v[104:105], v16 offset:42296
  ds_read_b64_tr_b16 v[106:107], v16 offset:42472
  s_waitcnt lgkmcnt(5)
  v_mfma_f32_32x32x16_bf16 v[176:191], v[80:83], v[96:99], v[176:191]
  ds_read_b64_tr_b16 v[108:109], v16 offset:42352
  ds_read_b64_tr_b16 v[110:111], v16 offset:42528
  s_waitcnt lgkmcnt(0)
  s_barrier
  v_mfma_f32_32x32x16_bf16 v[144:159], v[84:87], v[100:103], v[144:159]
  ds_read_b128 v[80:83], v12 offset:0
  ds_read_b64_tr_b16 v[88:89], v16 offset:0
  ds_read_b64_tr_b16 v[90:91], v16 offset:176
  v_mfma_f32_32x32x16_bf16 v[160:175], v[84:87], v[104:107], v[160:175]
  ds_read_b64_tr_b16 v[92:93], v16 offset:56
  ds_read_b64_tr_b16 v[94:95], v16 offset:232
  v_mfma_f32_32x32x16_bf16 v[176:191], v[84:87], v[108:111], v[176:191]
  ds_read_b64_tr_b16 v[96:97], v16 offset:112
  ds_read_b64_tr_b16 v[98:99], v16 offset:288
  s_waitcnt lgkmcnt(4)
  v_mfma_f32_32x32x16_bf16 v[144:159], v[80:83], v[88:91], v[144:159]
  ds_read_b128 v[84:87], v13 offset:0
  ds_read_b64_tr_b16 v[100:101], v16 offset:2816
  ds_read_b64_tr_b16 v[102:103], v16 offset:2992
  s_waitcnt lgkmcnt(5)
  v_mfma_f32_32x32x16_bf16 v[160:175], v[80:83], v[92:95], v[160:175]
  ds_read_b64_tr_b16 v[104:105], v16 offset:2872
  ds_read_b64_tr_b16 v[106:107], v16 offset:3048
  s_waitcnt lgkmcnt(5)
  v_mfma_f32_32x32x16_bf16 v[176:191], v[80:83], v[96:99], v[176:191]
  ds_read_b64_tr_b16 v[108:109], v16 offset:2928
  ds_read_b64_tr_b16 v[110:111], v16 offset:3104
  s_waitcnt lgkmcnt(4)
  v_mfma_f32_32x32x16_bf16 v[144:159], v[84:87], v[100:103], v[144:159]
  ds_read_b128 v[80:83], v14 offset:0
  ds_read_b64_tr_b16 v[88:89], v16 offset:5632
  ds_read_b64_tr_b16 v[90:91], v16 offset:5808
  s_waitcnt lgkmcnt(5)
  v_mfma_f32_32x32x16_bf16 v[160:175], v[84:87], v[104:107], v[160:175]
  ds_read_b64_tr_b16 v[92:93], v16 offset:5688
  ds_read_b64_tr_b16 v[94:95], v16 offset:5864
  s_waitcnt lgkmcnt(5)
  v_mfma_f32_32x32x16_bf16 v[176:191], v[84:87], v[108:111], v[176:191]
  ds_read_b64_tr_b16 v[96:97], v16 offset:5744
  ds_read_b64_tr_b16 v[98:99], v16 offset:5920
  s_waitcnt lgkmcnt(4)
  v_mfma_f32_32x32x16_bf16 v[144:159], v[80:83], v[88:91], v[144:159]
  ds_read_b128 v[84:87], v15 offset:0
  ds_read_b64_tr_b16 v[100:101], v16 offset:8448
  ds_read_b64_tr_b16 v[102:103], v16 offset:8624
  s_waitcnt lgkmcnt(5)
  v_mfma_f32_32x32x16_bf16 v[160:175], v[80:83], v[92:95], v[160:175]
  ds_read_b64_tr_b16 v[104:105], v16 offset:8504
  ds_read_b64_tr_b16 v[106:107], v16 offset:8680
  s_waitcnt lgkmcnt(5)
  v_mfma_f32_32x32x16_bf16 v[176:191], v[80:83], v[96:99], v[176:191]
  ds_read_b64_tr_b16 v[108:109], v16 offset:8560
  ds_read_b64_tr_b16 v[110:111], v16 offset:8736
  s_waitcnt vmcnt(0) lgkmcnt(0)
  s_barrier
  s_cmp_lg_u32 s3, 0
  s_cbranch_scc1 LsigB_33
  v_readfirstlane_b32 s47, v31
  s_cmp_lg_u32 s47, 0
  s_cbranch_scc1 Linited_34
  s_mov_b32 s68, 200000
Linitspin_35:
  buffer_load_dword v31, v30, s[36:39], 0 offen sc1
  s_waitcnt vmcnt(0)
  v_readfirstlane_b32 s47, v31
  s_cmp_lg_u32 s47, 0
  s_cbranch_scc1 Linited_34
  s_sub_u32 s68, s68, 1
  s_cmp_lg_u32 s68, 0
  s_cbranch_scc1 Linitspin_35
Linited_34:
  s_mov_b64 exec, 1
  v_mov_b32 v1, 1
  s_lshl_b32 s47, s23, 8
  s_add_u32 s47, s47, 4096
  v_mov_b32 v29, s47
  buffer_atomic_add v1, v29, s[64:67], 0 offen sc1
  s_mov_b64 exec, -1
LsigB_33:
  v_mfma_f32_32x32x16_bf16 v[144:159], v[84:87], v[100:103], v[144:159]
  ds_read_b128 v[80:83], v12 offset:16384
  ds_read_b64_tr_b16 v[88:89], v16 offset:11264
  ds_read_b64_tr_b16 v[90:91], v16 offset:11440
  v_mfma_f32_32x32x16_bf16 v[160:175], v[84:87], v[104:107], v[160:175]
  ds_read_b64_tr_b16 v[92:93], v16 offset:11320
  ds_read_b64_tr_b16 v[94:95], v16 offset:11496
  v_mfma_f32_32x32x16_bf16 v[176:191], v[84:87], v[108:111], v[176:191]
  ds_read_b64_tr_b16 v[96:97], v16 offset:11376
  ds_read_b64_tr_b16 v[98:99], v16 offset:11552
  s_waitcnt lgkmcnt(4)
  v_mfma_f32_32x32x16_bf16 v[144:159], v[80:83], v[88:91], v[144:159]
  ds_read_b128 v[84:87], v13 offset:16384
  ds_read_b64_tr_b16 v[100:101], v16 offset:14080
  ds_read_b64_tr_b16 v[102:103], v16 offset:14256
  s_waitcnt lgkmcnt(5)
  v_mfma_f32_32x32x16_bf16 v[160:175], v[80:83], v[92:95], v[160:175]
  ds_read_b64_tr_b16 v[104:105], v16 offset:14136
  ds_read_b64_tr_b16 v[106:107], v16 offset:14312
  s_waitcnt lgkmcnt(5)
  v_mfma_f32_32x32x16_bf16 v[176:191], v[80:83], v[96:99], v[176:191]
  ds_read_b64_tr_b16 v[108:109], v16 offset:14192
  ds_read_b64_tr_b16 v[110:111], v16 offset:14368
  s_waitcnt lgkmcnt(4)
  v_mfma_f32_32x32x16_bf16 v[144:159], v[84:87], v[100:103], v[144:159]
  ds_read_b128 v[80:83], v14 offset:16384
  ds_read_b64_tr_b16 v[88:89], v16 offset:16896
  ds_read_b64_tr_b16 v[90:91], v16 offset:17072
  s_waitcnt lgkmcnt(5)
  v_mfma_f32_32x32x16_bf16 v[160:175], v[84:87], v[104:107], v[160:175]
  ds_read_b64_tr_b16 v[92:93], v16 offset:16952
  ds_read_b64_tr_b16 v[94:95], v16 offset:17128
  s_waitcnt lgkmcnt(5)
  v_mfma_f32_32x32x16_bf16 v[176:191], v[84:87], v[108:111], v[176:191]
  ds_read_b64_tr_b16 v[96:97], v16 offset:17008
  ds_read_b64_tr_b16 v[98:99], v16 offset:17184
  s_waitcnt lgkmcnt(4)
  v_mfma_f32_32x32x16_bf16 v[144:159], v[80:83], v[88:91], v[144:159]
  ds_read_b128 v[84:87], v15 offset:16384
  ds_read_b64_tr_b16 v[100:101], v16 offset:19712
  ds_read_b64_tr_b16 v[102:103], v16 offset:19888
  s_waitcnt lgkmcnt(5)
  v_mfma_f32_32x32x16_bf16 v[160:175], v[80:83], v[92:95], v[160:175]
  ds_read_b64_tr_b16 v[104:105], v16 offset:19768
  ds_read_b64_tr_b16 v[106:107], v16 offset:19944
  s_waitcnt lgkmcnt(5)
  v_mfma_f32_32x32x16_bf16 v[176:191], v[80:83], v[96:99], v[176:191]
  ds_read_b64_tr_b16 v[108:109], v16 offset:19824
  ds_read_b64_tr_b16 v[110:111], v16 offset:20000
  s_waitcnt lgkmcnt(0)
  s_barrier
  v_mfma_f32_32x32x16_bf16 v[144:159], v[84:87], v[100:103], v[144:159]
  ds_read_b128 v[80:83], v12 offset:32768
  ds_read_b64_tr_b16 v[88:89], v16 offset:22528
  ds_read_b64_tr_b16 v[90:91], v16 offset:22704
  v_mfma_f32_32x32x16_bf16 v[160:175], v[84:87], v[104:107], v[160:175]
  ds_read_b64_tr_b16 v[92:93], v16 offset:22584
  ds_read_b64_tr_b16 v[94:95], v16 offset:22760
  v_mfma_f32_32x32x16_bf16 v[176:191], v[84:87], v[108:111], v[176:191]
  ds_read_b64_tr_b16 v[96:97], v16 offset:22640
  ds_read_b64_tr_b16 v[98:99], v16 offset:22816
  s_waitcnt lgkmcnt(4)
  v_mfma_f32_32x32x16_bf16 v[144:159], v[80:83], v[88:91], v[144:159]
  ds_read_b128 v[84:87], v13 offset:32768
  ds_read_b64_tr_b16 v[100:101], v16 offset:25344
  ds_read_b64_tr_b16 v[102:103], v16 offset:25520
  s_waitcnt lgkmcnt(5)
  v_mfma_f32_32x32x16_bf16 v[160:175], v[80:83], v[92:95], v[160:175]
  ds_read_b64_tr_b16 v[104:105], v16 offset:25400
  ds_read_b64_tr_b16 v[106:107], v16 offset:25576
  s_waitcnt lgkmcnt(5)
  v_mfma_f32_32x32x16_bf16 v[176:191], v[80:83], v[96:99], v[176:191]
  ds_read_b64_tr_b16 v[108:109], v16 offset:25456
  ds_read_b64_tr_b16 v[110:111], v16 offset:25632
  s_waitcnt lgkmcnt(4)
  v_mfma_f32_32x32x16_bf16 v[144:159], v[84:87], v[100:103], v[144:159]
  ds_read_b128 v[80:83], v14 offset:32768
  ds_read_b64_tr_b16 v[88:89], v16 offset:28160
  ds_read_b64_tr_b16 v[90:91], v16 offset:28336
  s_waitcnt lgkmcnt(5)
  v_mfma_f32_32x32x16_bf16 v[160:175], v[84:87], v[104:107], v[160:175]
  ds_read_b64_tr_b16 v[92:93], v16 offset:28216
  ds_read_b64_tr_b16 v[94:95], v16 offset:28392
  s_waitcnt lgkmcnt(5)
  v_mfma_f32_32x32x16_bf16 v[176:191], v[84:87], v[108:111], v[176:191]
  ds_read_b64_tr_b16 v[96:97], v16 offset:28272
  ds_read_b64_tr_b16 v[98:99], v16 offset:28448
  s_waitcnt lgkmcnt(4)
  v_mfma_f32_32x32x16_bf16 v[144:159], v[80:83], v[88:91], v[144:159]
  ds_read_b128 v[84:87], v15 offset:32768
  ds_read_b64_tr_b16 v[100:101], v16 offset:30976
  ds_read_b64_tr_b16 v[102:103], v16 offset:31152
  s_waitcnt lgkmcnt(5)
  v_mfma_f32_32x32x16_bf16 v[160:175], v[80:83], v[92:95], v[160:175]
  ds_read_b64_tr_b16 v[104:105], v16 offset:31032
  ds_read_b64_tr_b16 v[106:107], v16 offset:31208
  s_waitcnt lgkmcnt(5)
  v_mfma_f32_32x32x16_bf16 v[176:191], v[80:83], v[96:99], v[176:191]
  ds_read_b64_tr_b16 v[108:109], v16 offset:31088
  ds_read_b64_tr_b16 v[110:111], v16 offset:31264
  s_waitcnt lgkmcnt(0)
  s_barrier
  v_mfma_f32_32x32x16_bf16 v[144:159], v[84:87], v[100:103], v[144:159]
  ds_read_b128 v[80:83], v12 offset:49152
  ds_read_b64_tr_b16 v[88:89], v16 offset:33792
  ds_read_b64_tr_b16 v[90:91], v16 offset:33968
  v_mfma_f32_32x32x16_bf16 v[160:175], v[84:87], v[104:107], v[160:175]
  ds_read_b64_tr_b16 v[92:93], v16 offset:33848
  ds_read_b64_tr_b16 v[94:95], v16 offset:34024
  v_mfma_f32_32x32x16_bf16 v[176:191], v[84:87], v[108:111], v[176:191]
  ds_read_b64_tr_b16 v[96:97], v16 offset:33904
  ds_read_b64_tr_b16 v[98:99], v16 offset:34080
  s_waitcnt lgkmcnt(4)
  v_mfma_f32_32x32x16_bf16 v[144:159], v[80:83], v[88:91], v[144:159]
  ds_read_b128 v[84:87], v13 offset:49152
  ds_read_b64_tr_b16 v[100:101], v16 offset:36608
  ds_read_b64_tr_b16 v[102:103], v16 offset:36784
  s_waitcnt lgkmcnt(5)
  v_mfma_f32_32x32x16_bf16 v[160:175], v[80:83], v[92:95], v[160:175]
  ds_read_b64_tr_b16 v[104:105], v16 offset:36664
  ds_read_b64_tr_b16 v[106:107], v16 offset:36840
  s_waitcnt lgkmcnt(5)
  v_mfma_f32_32x32x16_bf16 v[176:191], v[80:83], v[96:99], v[176:191]
  ds_read_b64_tr_b16 v[108:109], v16 offset:36720
  ds_read_b64_tr_b16 v[110:111], v16 offset:36896
  s_waitcnt lgkmcnt(4)
  v_mfma_f32_32x32x16_bf16 v[144:159], v[84:87], v[100:103], v[144:159]
  ds_read_b128 v[80:83], v14 offset:49152
  ds_read_b64_tr_b16 v[88:89], v16 offset:39424
  ds_read_b64_tr_b16 v[90:91], v16 offset:39600
  s_waitcnt lgkmcnt(5)
  v_mfma_f32_32x32x16_bf16 v[160:175], v[84:87], v[104:107], v[160:175]
  ds_read_b64_tr_b16 v[92:93], v16 offset:39480
  ds_read_b64_tr_b16 v[94:95], v16 offset:39656
  s_waitcnt lgkmcnt(5)
  v_mfma_f32_32x32x16_bf16 v[176:191], v[84:87], v[108:111], v[176:191]
  ds_read_b64_tr_b16 v[96:97], v16 offset:39536
  ds_read_b64_tr_b16 v[98:99], v16 offset:39712
  s_waitcnt lgkmcnt(4)
  v_mfma_f32_32x32x16_bf16 v[144:159], v[80:83], v[88:91], v[144:159]
  ds_read_b128 v[84:87], v15 offset:49152
  ds_read_b64_tr_b16 v[100:101], v16 offset:42240
  ds_read_b64_tr_b16 v[102:103], v16 offset:42416
  s_waitcnt lgkmcnt(5)
  v_mfma_f32_32x32x16_bf16 v[160:175], v[80:83], v[92:95], v[160:175]
  ds_read_b64_tr_b16 v[104:105], v16 offset:42296
  ds_read_b64_tr_b16 v[106:107], v16 offset:42472
  s_waitcnt lgkmcnt(5)
  v_mfma_f32_32x32x16_bf16 v[176:191], v[80:83], v[96:99], v[176:191]
  ds_read_b64_tr_b16 v[108:109], v16 offset:42352
  ds_read_b64_tr_b16 v[110:111], v16 offset:42528
  s_waitcnt lgkmcnt(0)
  s_barrier
  v_mfma_f32_32x32x16_bf16 v[144:159], v[84:87], v[100:103], v[144:159]
  ds_read_b128 v[80:83], v12 offset:0
  ds_read_b64_tr_b16 v[88:89], v16 offset:0
  ds_read_b64_tr_b16 v[90:91], v16 offset:176
  v_mfma_f32_32x32x16_bf16 v[160:175], v[84:87], v[104:107], v[160:175]
  ds_read_b64_tr_b16 v[92:93], v16 offset:56
  ds_read_b64_tr_b16 v[94:95], v16 offset:232
  v_mfma_f32_32x32x16_bf16 v[176:191], v[84:87], v[108:111], v[176:191]
  ds_read_b64_tr_b16 v[96:97], v16 offset:112
  ds_read_b64_tr_b16 v[98:99], v16 offset:288
  s_waitcnt lgkmcnt(4)
  v_mfma_f32_32x32x16_bf16 v[144:159], v[80:83], v[88:91], v[144:159]
  ds_read_b128 v[84:87], v13 offset:0
  ds_read_b64_tr_b16 v[100:101], v16 offset:2816
  ds_read_b64_tr_b16 v[102:103], v16 offset:2992
  s_waitcnt lgkmcnt(5)
  v_mfma_f32_32x32x16_bf16 v[160:175], v[80:83], v[92:95], v[160:175]
  ds_read_b64_tr_b16 v[104:105], v16 offset:2872
  ds_read_b64_tr_b16 v[106:107], v16 offset:3048
  s_waitcnt lgkmcnt(5)
  v_mfma_f32_32x32x16_bf16 v[176:191], v[80:83], v[96:99], v[176:191]
  ds_read_b64_tr_b16 v[108:109], v16 offset:2928
  ds_read_b64_tr_b16 v[110:111], v16 offset:3104
  s_waitcnt lgkmcnt(4)
  v_mfma_f32_32x32x16_bf16 v[144:159], v[84:87], v[100:103], v[144:159]
  ds_read_b128 v[80:83], v14 offset:0
  ds_read_b64_tr_b16 v[88:89], v16 offset:5632
  ds_read_b64_tr_b16 v[90:91], v16 offset:5808
  s_waitcnt lgkmcnt(5)
  v_mfma_f32_32x32x16_bf16 v[160:175], v[84:87], v[104:107], v[160:175]
  ds_read_b64_tr_b16 v[92:93], v16 offset:5688
  ds_read_b64_tr_b16 v[94:95], v16 offset:5864
  s_waitcnt lgkmcnt(5)
  v_mfma_f32_32x32x16_bf16 v[176:191], v[84:87], v[108:111], v[176:191]
  ds_read_b64_tr_b16 v[96:97], v16 offset:5744
  ds_read_b64_tr_b16 v[98:99], v16 offset:5920
  s_waitcnt lgkmcnt(4)
  v_mfma_f32_32x32x16_bf16 v[144:159], v[80:83], v[88:91], v[144:159]
  ds_read_b128 v[84:87], v15 offset:0
  ds_read_b64_tr_b16 v[100:101], v16 offset:8448
  ds_read_b64_tr_b16 v[102:103], v16 offset:8624
  s_waitcnt lgkmcnt(5)
  v_mfma_f32_32x32x16_bf16 v[160:175], v[80:83], v[92:95], v[160:175]
  ds_read_b64_tr_b16 v[104:105], v16 offset:8504
  ds_read_b64_tr_b16 v[106:107], v16 offset:8680
  s_waitcnt lgkmcnt(5)
  v_mfma_f32_32x32x16_bf16 v[176:191], v[80:83], v[96:99], v[176:191]
  ds_read_b64_tr_b16 v[108:109], v16 offset:8560
  ds_read_b64_tr_b16 v[110:111], v16 offset:8736
  s_waitcnt lgkmcnt(0)
  s_barrier
  v_mfma_f32_32x32x16_bf16 v[144:159], v[84:87], v[100:103], v[144:159]
  ds_read_b128 v[80:83], v12 offset:16384
  ds_read_b64_tr_b16 v[88:89], v16 offset:11264
  ds_read_b64_tr_b16 v[90:91], v16 offset:11440
  v_mfma_f32_32x32x16_bf16 v[160:175], v[84:87], v[104:107], v[160:175]
  ds_read_b64_tr_b16 v[92:93], v16 offset:11320
  ds_read_b64_tr_b16 v[94:95], v16 offset:11496
  v_mfma_f32_32x32x16_bf16 v[176:191], v[84:87], v[108:111], v[176:191]
  ds_read_b64_tr_b16 v[96:97], v16 offset:11376
  ds_read_b64_tr_b16 v[98:99], v16 offset:11552
  s_waitcnt lgkmcnt(4)
  v_mfma_f32_32x32x16_bf16 v[144:159], v[80:83], v[88:91], v[144:159]
  ds_read_b128 v[84:87], v13 offset:16384
  ds_read_b64_tr_b16 v[100:101], v16 offset:14080
  ds_read_b64_tr_b16 v[102:103], v16 offset:14256
  s_waitcnt lgkmcnt(5)
  v_mfma_f32_32x32x16_bf16 v[160:175], v[80:83], v[92:95], v[160:175]
  ds_read_b64_tr_b16 v[104:105], v16 offset:14136
  ds_read_b64_tr_b16 v[106:107], v16 offset:14312
  s_waitcnt lgkmcnt(5)
  v_mfma_f32_32x32x16_bf16 v[176:191], v[80:83], v[96:99], v[176:191]
  ds_read_b64_tr_b16 v[108:109], v16 offset:14192
  ds_read_b64_tr_b16 v[110:111], v16 offset:14368
  s_waitcnt lgkmcnt(4)
  v_mfma_f32_32x32x16_bf16 v[144:159], v[84:87], v[100:103], v[144:159]
  ds_read_b128 v[80:83], v14 offset:16384
  ds_read_b64_tr_b16 v[88:89], v16 offset:16896
  ds_read_b64_tr_b16 v[90:91], v16 offset:17072
  s_waitcnt lgkmcnt(5)
  v_mfma_f32_32x32x16_bf16 v[160:175], v[84:87], v[104:107], v[160:175]
  ds_read_b64_tr_b16 v[92:93], v16 offset:16952
  ds_read_b64_tr_b16 v[94:95], v16 offset:17128
  s_waitcnt lgkmcnt(5)
  v_mfma_f32_32x32x16_bf16 v[176:191], v[84:87], v[108:111], v[176:191]
  ds_read_b64_tr_b16 v[96:97], v16 offset:17008
  ds_read_b64_tr_b16 v[98:99], v16 offset:17184
  s_waitcnt lgkmcnt(4)
  v_mfma_f32_32x32x16_bf16 v[144:159], v[80:83], v[88:91], v[144:159]
  ds_read_b128 v[84:87], v15 offset:16384
  ds_read_b64_tr_b16 v[100:101], v16 offset:19712
  ds_read_b64_tr_b16 v[102:103], v16 offset:19888
  s_waitcnt lgkmcnt(5)
  v_mfma_f32_32x32x16_bf16 v[160:175], v[80:83], v[92:95], v[160:175]
  ds_read_b64_tr_b16 v[104:105], v16 offset:19768
  ds_read_b64_tr_b16 v[106:107], v16 offset:19944
  s_waitcnt lgkmcnt(5)
  v_mfma_f32_32x32x16_bf16 v[176:191], v[80:83], v[96:99], v[176:191]
  ds_read_b64_tr_b16 v[108:109], v16 offset:19824
  ds_read_b64_tr_b16 v[110:111], v16 offset:20000
  s_waitcnt lgkmcnt(4)
  v_mfma_f32_32x32x16_bf16 v[144:159], v[84:87], v[100:103], v[144:159]
  s_waitcnt lgkmcnt(2)
  v_mfma_f32_32x32x16_bf16 v[160:175], v[84:87], v[104:107], v[160:175]
  s_waitcnt lgkmcnt(0)
  v_mfma_f32_32x32x16_bf16 v[176:191], v[84:87], v[108:111], v[176:191]
  s_barrier
  s_and_b32 s40, s2, 7
  s_bfe_u32 s41, s2, 0x10003
  s_lshl_b32 s40, s40, 1
  s_add_u32 s40, s40, s41
  s_lshl_b32 s47, s40, 18
  s_add_u32 s47, s47, 8388608
  s_add_u32 s32, s20, s47
  s_addc_u32 s33, s21, 0
  s_mov_b32 s34, 0x40000
  s_mov_b32 s35, 0x20000
  s_lshl_b32 s55, s3, 12
  s_add_u32 s54, s55, 0
  s_add_u32 m0, s55, 0
  s_nop 0
  buffer_load_dwordx4 v2, s[32:35], s54 offen offset:0 lds
  buffer_load_dwordx4 v2, s[32:35], s54 offen offset:1024 lds
  buffer_load_dwordx4 v2, s[32:35], s54 offen offset:2048 lds
  buffer_load_dwordx4 v2, s[32:35], s54 offen offset:3072 lds
  s_add_u32 s54, s55, 32768
  s_add_u32 m0, s55, 32768
  s_nop 0
  buffer_load_dwordx4 v2, s[32:35], s54 offen offset:0 lds
  buffer_load_dwordx4 v2, s[32:35], s54 offen offset:1024 lds
  buffer_load_dwordx4 v2, s[32:35], s54 offen offset:2048 lds
  buffer_load_dwordx4 v2, s[32:35], s54 offen offset:3072 lds
  s_lshl_b32 s54, s22, 2
  s_add_u32 s54, s54, s3
  s_add_u32 s62, s63, 0
  s_and_b32 s56, s62, 15
  s_lshl_b32 s56, s56, 6
  s_add_u32 s56, s56, s54
  s_lshl_b32 s56, s56, 12
  s_add_u32 s48, s56, 4196352
  v_cvt_pk_bf16_f32 v208, v144, v145
  v_cvt_pk_bf16_f32 v209, v146, v147
  v_cvt_pk_bf16_f32 v210, v148, v149
  v_cvt_pk_bf16_f32 v211, v150, v151
  v_cvt_pk_bf16_f32 v212, v152, v153
  v_cvt_pk_bf16_f32 v213, v154, v155
  v_cvt_pk_bf16_f32 v214, v156, v157
  v_cvt_pk_bf16_f32 v215, v158, v159
  v_cndmask_b32_e64 v208, v208, v18, s[58:59]
  v_cndmask_b32_e64 v209, v209, v18, s[58:59]
  v_cndmask_b32_e64 v210, v210, v18, s[58:59]
  v_cndmask_b32_e64 v211, v211, v18, s[58:59]
  v_cndmask_b32_e64 v212, v212, v18, s[58:59]
  v_cndmask_b32_e64 v213, v213, v18, s[58:59]
  v_cndmask_b32_e64 v214, v214, v18, s[58:59]
  v_cndmask_b32_e64 v215, v215, v18, s[58:59]
  s_add_u32 s62, s63, 1
  s_and_b32 s56, s62, 15
  s_lshl_b32 s56, s56, 6
  s_add_u32 s56, s56, s54
  s_lshl_b32 s56, s56, 12
  s_add_u32 s49, s56, 4196352
  v_cvt_pk_bf16_f32 v216, v160, v161
  v_cvt_pk_bf16_f32 v217, v162, v163
  v_cvt_pk_bf16_f32 v218, v164, v165
  v_cvt_pk_bf16_f32 v219, v166, v167
  v_cvt_pk_bf16_f32 v220, v168, v169
  v_cvt_pk_bf16_f32 v221, v170, v171
  v_cvt_pk_bf16_f32 v222, v172, v173
  v_cvt_pk_bf16_f32 v223, v174, v175
  v_cndmask_b32_e64 v216, v216, v18, s[58:59]
  v_cndmask_b32_e64 v217, v217, v18, s[58:59]
  v_cndmask_b32_e64 v218, v218, v18, s[58:59]
  v_cndmask_b32_e64 v219, v219, v18, s[58:59]
  v_cndmask_b32_e64 v220, v220, v18, s[58:59]
  v_cndmask_b32_e64 v221, v221, v18, s[58:59]
  v_cndmask_b32_e64 v222, v222, v18, s[58:59]
  v_cndmask_b32_e64 v223, v223, v18, s[58:59]
  s_add_u32 s62, s63, 2
  s_and_b32 s56, s62, 15
  s_lshl_b32 s56, s56, 6
  s_add_u32 s56, s56, s54
  s_lshl_b32 s56, s56, 12
  s_add_u32 s53, s56, 4196352
  v_cvt_pk_bf16_f32 v224, v176, v177
  v_cvt_pk_bf16_f32 v225, v178, v179
  v_cvt_pk_bf16_f32 v226, v180, v181
  v_cvt_pk_bf16_f32 v227, v182, v183
  v_cvt_pk_bf16_f32 v228, v184, v185
  v_cvt_pk_bf16_f32 v229, v186, v187
  v_cvt_pk_bf16_f32 v230, v188, v189
  v_cvt_pk_bf16_f32 v231, v190, v191
  v_cndmask_b32_e64 v224, v224, v18, s[58:59]
  v_cndmask_b32_e64 v225, v225, v18, s[58:59]
  v_cndmask_b32_e64 v226, v226, v18, s[58:59]
  v_cndmask_b32_e64 v227, v227, v18, s[58:59]
  v_cndmask_b32_e64 v228, v228, v18, s[58:59]
  v_cndmask_b32_e64 v229, v229, v18, s[58:59]
  v_cndmask_b32_e64 v230, v230, v18, s[58:59]
  v_cndmask_b32_e64 v231, v231, v18, s[58:59]
  s_branch Lqkv_fin
Lqkv_v4:
  s_barrier
  ds_read_b128 v[80:83], v12 offset:0
  ds_read_b64_tr_b16 v[88:89], v16 offset:0
  ds_read_b64_tr_b16 v[90:91], v16 offset:176
  ds_read_b64_tr_b16 v[92:93], v16 offset:56
  ds_read_b64_tr_b16 v[94:95], v16 offset:232
  ds_read_b64_tr_b16 v[96:97], v16 offset:112
  ds_read_b64_tr_b16 v[98:99], v16 offset:288
  s_cmp_ge_u32 s3, 2
  s_cbranch_scc1 Lpf5_36
  s_cmp_eq_u32 s3, 0
  s_cselect_b32 s24, s8, s14
  s_cselect_b32 s25, s9, s15
  s_mov_b32 s26, 401408
  s_mov_b32 s27, 0x20000
  s_mul_i32 s46, s2, 1568
  v_add_u32 v20, s46, v2
  buffer_load_dwordx4 v[168:171], v20, s[24:27], 0 offen offset:0
  buffer_load_dwordx4 v[172:175], v20, s[24:27], 0 offen offset:1024
Lpf5_36:
  s_waitcnt lgkmcnt(4)
  v_mfma_f32_32x32x16_bf16 v[32:47], v[80:83], v[88:91], 0
  ds_read_b128 v[84:87], v13 offset:0
  ds_read_b64_tr_b16 v[100:101], v16 offset:2816
  ds_read_b64_tr_b16 v[102:103], v16 offset:2992
  s_waitcnt lgkmcnt(5)
  v_mfma_f32_32x32x16_bf16 v[48:63], v[80:83], v[92:95], 0
  ds_read_b64_tr_b16 v[104:105], v16 offset:2872
  ds_read_b64_tr_b16 v[106:107], v16 offset:3048
  s_waitcnt lgkmcnt(5)
  v_mfma_f32_32x32x16_bf16 v[64:79], v[80:83], v[96:99], 0
  ds_read_b64_tr_b16 v[108:109], v16 offset:2928
  ds_read_b64_tr_b16 v[110:111], v16 offset:3104
  s_waitcnt lgkmcnt(4)
  v_mfma_f32_32x32x16_bf16 v[32:47], v[84:87], v[100:103], v[32:47]
  ds_read_b128 v[80:83], v14 offset:0
  ds_read_b64_tr_b16 v[88:89], v16 offset:5632
  ds_read_b64_tr_b16 v[90:91], v16 offset:5808
  s_waitcnt lgkmcnt(5)
  v_mfma_f32_32x32x16_bf16 v[48:63], v[84:87], v[104:107], v[48:63]
  ds_read_b64_tr_b16 v[92:93], v16 offset:5688
  ds_read_b64_tr_b16 v[94:95], v16 offset:5864
  s_waitcnt lgkmcnt(5)
  v_mfma_f32_32x32x16_bf16 v[64:79], v[84:87], v[108:111], v[64:79]
  ds_read_b64_tr_b16 v[96:97], v16 offset:5744
  ds_read_b64_tr_b16 v[98:99], v16 offset:5920
  s_waitcnt lgkmcnt(4)
  v_mfma_f32_32x32x16_bf16 v[32:47], v[80:83], v[88:91], v[32:47]
  ds_read_b128 v[84:87], v15 offset:0
  ds_read_b64_tr_b16 v[100:101], v16 offset:8448
  ds_read_b64_tr_b16 v[102:103], v16 offset:8624
  s_waitcnt lgkmcnt(5)
  v_mfma_f32_32x32x16_bf16 v[48:63], v[80:83], v[92:95], v[48:63]
  ds_read_b64_tr_b16 v[104:105], v16 offset:8504
  ds_read_b64_tr_b16 v[106:107], v16 offset:8680
  s_waitcnt lgkmcnt(5)
  v_mfma_f32_32x32x16_bf16 v[64:79], v[80:83], v[96:99], v[64:79]
  ds_read_b64_tr_b16 v[108:109], v16 offset:8560
  ds_read_b64_tr_b16 v[110:111], v16 offset:8736
  s_waitcnt lgkmcnt(0)
  s_barrier
  v_mfma_f32_32x32x16_bf16 v[32:47], v[84:87], v[100:103], v[32:47]
  ds_read_b128 v[80:83], v12 offset:16384
  ds_read_b64_tr_b16 v[88:89], v16 offset:11264
  ds_read_b64_tr_b16 v[90:91], v16 offset:11440
  v_mfma_f32_32x32x16_bf16 v[48:63], v[84:87], v[104:107], v[48:63]
  ds_read_b64_tr_b16 v[92:93], v16 offset:11320
  ds_read_b64_tr_b16 v[94:95], v16 offset:11496
  v_mfma_f32_32x32x16_bf16 v[64:79], v[84:87], v[108:111], v[64:79]
  ds_read_b64_tr_b16 v[96:97], v16 offset:11376
  ds_read_b64_tr_b16 v[98:99], v16 offset:11552
  s_waitcnt lgkmcnt(4)
  v_mfma_f32_32x32x16_bf16 v[32:47], v[80:83], v[88:91], v[32:47]
  ds_read_b128 v[84:87], v13 offset:16384
  ds_read_b64_tr_b16 v[100:101], v16 offset:14080
  ds_read_b64_tr_b16 v[102:103], v16 offset:14256
  s_waitcnt lgkmcnt(5)
  v_mfma_f32_32x32x16_bf16 v[48:63], v[80:83], v[92:95], v[48:63]
  ds_read_b64_tr_b16 v[104:105], v16 offset:14136
  ds_read_b64_tr_b16 v[106:107], v16 offset:14312
  s_waitcnt lgkmcnt(5)
  v_mfma_f32_32x32x16_bf16 v[64:79], v[80:83], v[96:99], v[64:79]
  ds_read_b64_tr_b16 v[108:109], v16 offset:14192
  ds_read_b64_tr_b16 v[110:111], v16 offset:14368
  s_waitcnt lgkmcnt(4)
  v_mfma_f32_32x32x16_bf16 v[32:47], v[84:87], v[100:103], v[32:47]
  ds_read_b128 v[80:83], v14 offset:16384
  ds_read_b64_tr_b16 v[88:89], v16 offset:16896
  ds_read_b64_tr_b16 v[90:91], v16 offset:17072
  s_waitcnt lgkmcnt(5)
  v_mfma_f32_32x32x16_bf16 v[48:63], v[84:87], v[104:107], v[48:63]
  ds_read_b64_tr_b16 v[92:93], v16 offset:16952
  ds_read_b64_tr_b16 v[94:95], v16 offset:17128
  s_waitcnt lgkmcnt(5)
  v_mfma_f32_32x32x16_bf16 v[64:79], v[84:87], v[108:111], v[64:79]
  ds_read_b64_tr_b16 v[96:97], v16 offset:17008
  ds_read_b64_tr_b16 v[98:99], v16 offset:17184
  s_waitcnt lgkmcnt(4)
  v_mfma_f32_32x32x16_bf16 v[32:47], v[80:83], v[88:91], v[32:47]
  ds_read_b128 v[84:87], v15 offset:16384
  ds_read_b64_tr_b16 v[100:101], v16 offset:19712
  ds_read_b64_tr_b16 v[102:103], v16 offset:19888
  s_waitcnt lgkmcnt(5)
  v_mfma_f32_32x32x16_bf16 v[48:63], v[80:83], v[92:95], v[48:63]
  ds_read_b64_tr_b16 v[104:105], v16 offset:19768
  ds_read_b64_tr_b16 v[106:107], v16 offset:19944
  s_waitcnt lgkmcnt(5)
  v_mfma_f32_32x32x16_bf16 v[64:79], v[80:83], v[96:99], v[64:79]
  ds_read_b64_tr_b16 v[108:109], v16 offset:19824
  ds_read_b64_tr_b16 v[110:111], v16 offset:20000
  s_waitcnt lgkmcnt(0)
  s_barrier
  v_mfma_f32_32x32x16_bf16 v[32:47], v[84:87], v[100:103], v[32:47]
  ds_read_b128 v[80:83], v12 offset:32768
  ds_read_b64_tr_b16 v[88:89], v16 offset:22528
  ds_read_b64_tr_b16 v[90:91], v16 offset:22704
  v_mfma_f32_32x32x16_bf16 v[48:63], v[84:87], v[104:107], v[48:63]
  ds_read_b64_tr_b16 v[92:93], v16 offset:22584
  ds_read_b64_tr_b16 v[94:95], v16 offset:22760
  v_mfma_f32_32x32x16_bf16 v[64:79], v[84:87], v[108:111], v[64:79]
  ds_read_b64_tr_b16 v[96:97], v16 offset:22640
  ds_read_b64_tr_b16 v[98:99], v16 offset:22816
  s_waitcnt lgkmcnt(4)
  v_mfma_f32_32x32x16_bf16 v[32:47], v[80:83], v[88:91], v[32:47]
  ds_read_b128 v[84:87], v13 offset:32768
  ds_read_b64_tr_b16 v[100:101], v16 offset:25344
  ds_read_b64_tr_b16 v[102:103], v16 offset:25520
  s_waitcnt lgkmcnt(5)
  v_mfma_f32_32x32x16_bf16 v[48:63], v[80:83], v[92:95], v[48:63]
  ds_read_b64_tr_b16 v[104:105], v16 offset:25400
  ds_read_b64_tr_b16 v[106:107], v16 offset:25576
  s_waitcnt lgkmcnt(5)
  v_mfma_f32_32x32x16_bf16 v[64:79], v[80:83], v[96:99], v[64:79]
  ds_read_b64_tr_b16 v[108:109], v16 offset:25456
  ds_read_b64_tr_b16 v[110:111], v16 offset:25632
  s_waitcnt lgkmcnt(4)
  v_mfma_f32_32x32x16_bf16 v[32:47], v[84:87], v[100:103], v[32:47]
  ds_read_b128 v[80:83], v14 offset:32768
  ds_read_b64_tr_b16 v[88:89], v16 offset:28160
  ds_read_b64_tr_b16 v[90:91], v16 offset:28336
  s_waitcnt lgkmcnt(5)
  v_mfma_f32_32x32x16_bf16 v[48:63], v[84:87], v[104:107], v[48:63]
  ds_read_b64_tr_b16 v[92:93], v16 offset:28216
  ds_read_b64_tr_b16 v[94:95], v16 offset:28392
  s_waitcnt lgkmcnt(5)
  v_mfma_f32_32x32x16_bf16 v[64:79], v[84:87], v[108:111], v[64:79]
  ds_read_b64_tr_b16 v[96:97], v16 offset:28272
  ds_read_b64_tr_b16 v[98:99], v16 offset:28448
  s_waitcnt lgkmcnt(4)
  v_mfma_f32_32x32x16_bf16 v[32:47], v[80:83], v[88:91], v[32:47]
  ds_read_b128 v[84:87], v15 offset:32768
  ds_read_b64_tr_b16 v[100:101], v16 offset:30976
  ds_read_b64_tr_b16 v[102:103], v16 offset:31152
  s_waitcnt lgkmcnt(5)
  v_mfma_f32_32x32x16_bf16 v[48:63], v[80:83], v[92:95], v[48:63]
  ds_read_b64_tr_b16 v[104:105], v16 offset:31032
  ds_read_b64_tr_b16 v[106:107], v16 offset:31208
  s_waitcnt lgkmcnt(5)
  v_mfma_f32_32x32x16_bf16 v[64:79], v[80:83], v[96:99], v[64:79]
  ds_read_b64_tr_b16 v[108:109], v16 offset:31088
  ds_read_b64_tr_b16 v[110:111], v16 offset:31264
  s_waitcnt lgkmcnt(0)
  s_barrier
  v_mfma_f32_32x32x16_bf16 v[32:47], v[84:87], v[100:103], v[32:47]
  ds_read_b128 v[80:83], v12 offset:49152
  ds_read_b64_tr_b16 v[88:89], v16 offset:33792
  ds_read_b64_tr_b16 v[90:91], v16 offset:33968
  v_mfma_f32_32x32x16_bf16 v[48:63], v[84:87], v[104:107], v[48:63]
  ds_read_b64_tr_b16 v[92:93], v16 offset:33848
  ds_read_b64_tr_b16 v[94:95], v16 offset:34024
  v_mfma_f32_32x32x16_bf16 v[64:79], v[84:87], v[108:111], v[64:79]
  ds_read_b64_tr_b16 v[96:97], v16 offset:33904
  ds_read_b64_tr_b16 v[98:99], v16 offset:34080
  s_waitcnt lgkmcnt(4)
  v_mfma_f32_32x32x16_bf16 v[32:47], v[80:83], v[88:91], v[32:47]
  ds_read_b128 v[84:87], v13 offset:49152
  ds_read_b64_tr_b16 v[100:101], v16 offset:36608
  ds_read_b64_tr_b16 v[102:103], v16 offset:36784
  s_waitcnt lgkmcnt(5)
  v_mfma_f32_32x32x16_bf16 v[48:63], v[80:83], v[92:95], v[48:63]
  ds_read_b64_tr_b16 v[104:105], v16 offset:36664
  ds_read_b64_tr_b16 v[106:107], v16 offset:36840
  s_waitcnt lgkmcnt(5)
  v_mfma_f32_32x32x16_bf16 v[64:79], v[80:83], v[96:99], v[64:79]
  ds_read_b64_tr_b16 v[108:109], v16 offset:36720
  ds_read_b64_tr_b16 v[110:111], v16 offset:36896
  s_waitcnt lgkmcnt(4)
  v_mfma_f32_32x32x16_bf16 v[32:47], v[84:87], v[100:103], v[32:47]
  ds_read_b128 v[80:83], v14 offset:49152
  ds_read_b64_tr_b16 v[88:89], v16 offset:39424
  ds_read_b64_tr_b16 v[90:91], v16 offset:39600
  s_waitcnt lgkmcnt(5)
  v_mfma_f32_32x32x16_bf16 v[48:63], v[84:87], v[104:107], v[48:63]
  ds_read_b64_tr_b16 v[92:93], v16 offset:39480
  ds_read_b64_tr_b16 v[94:95], v16 offset:39656
  s_waitcnt lgkmcnt(5)
  v_mfma_f32_32x32x16_bf16 v[64:79], v[84:87], v[108:111], v[64:79]
  ds_read_b64_tr_b16 v[96:97], v16 offset:39536
  ds_read_b64_tr_b16 v[98:99], v16 offset:39712
  s_waitcnt lgkmcnt(4)
  v_mfma_f32_32x32x16_bf16 v[32:47], v[80:83], v[88:91], v[32:47]
  ds_read_b128 v[84:87], v15 offset:49152
  ds_read_b64_tr_b16 v[100:101], v16 offset:42240
  ds_read_b64_tr_b16 v[102:103], v16 offset:42416
  s_waitcnt lgkmcnt(5)
  v_mfma_f32_32x32x16_bf16 v[48:63], v[80:83], v[92:95], v[48:63]
  ds_read_b64_tr_b16 v[104:105], v16 offset:42296
  ds_read_b64_tr_b16 v[106:107], v16 offset:42472
  s_waitcnt lgkmcnt(5)
  v_mfma_f32_32x32x16_bf16 v[64:79], v[80:83], v[96:99], v[64:79]
  ds_read_b64_tr_b16 v[108:109], v16 offset:42352
  ds_read_b64_tr_b16 v[110:111], v16 offset:42528
  s_waitcnt lgkmcnt(0)
  s_barrier
  v_mfma_f32_32x32x16_bf16 v[32:47], v[84:87], v[100:103], v[32:47]
  ds_read_b128 v[80:83], v12 offset:0
  ds_read_b64_tr_b16 v[88:89], v16 offset:0
  ds_read_b64_tr_b16 v[90:91], v16 offset:176
  v_mfma_f32_32x32x16_bf16 v[48:63], v[84:87], v[104:107], v[48:63]
  ds_read_b64_tr_b16 v[92:93], v16 offset:56
  ds_read_b64_tr_b16 v[94:95], v16 offset:232
  v_mfma_f32_32x32x16_bf16 v[64:79], v[84:87], v[108:111], v[64:79]
  ds_read_b64_tr_b16 v[96:97], v16 offset:112
  ds_read_b64_tr_b16 v[98:99], v16 offset:288
  s_waitcnt lgkmcnt(4)
  v_mfma_f32_32x32x16_bf16 v[32:47], v[80:83], v[88:91], v[32:47]
  ds_read_b128 v[84:87], v13 offset:0
  ds_read_b64_tr_b16 v[100:101], v16 offset:2816
  ds_read_b64_tr_b16 v[102:103], v16 offset:2992
  s_waitcnt lgkmcnt(5)
  v_mfma_f32_32x32x16_bf16 v[48:63], v[80:83], v[92:95], v[48:63]
  ds_read_b64_tr_b16 v[104:105], v16 offset:2872
  ds_read_b64_tr_b16 v[106:107], v16 offset:3048
  s_waitcnt lgkmcnt(5)
  v_mfma_f32_32x32x16_bf16 v[64:79], v[80:83], v[96:99], v[64:79]
  ds_read_b64_tr_b16 v[108:109], v16 offset:2928
  ds_read_b64_tr_b16 v[110:111], v16 offset:3104
  s_waitcnt lgkmcnt(4)
  v_mfma_f32_32x32x16_bf16 v[32:47], v[84:87], v[100:103], v[32:47]
  ds_read_b128 v[80:83], v14 offset:0
  ds_read_b64_tr_b16 v[88:89], v16 offset:5632
  ds_read_b64_tr_b16 v[90:91], v16 offset:5808
  s_waitcnt lgkmcnt(5)
  v_mfma_f32_32x32x16_bf16 v[48:63], v[84:87], v[104:107], v[48:63]
  ds_read_b64_tr_b16 v[92:93], v16 offset:5688
  ds_read_b64_tr_b16 v[94:95], v16 offset:5864
  s_waitcnt lgkmcnt(5)
  v_mfma_f32_32x32x16_bf16 v[64:79], v[84:87], v[108:111], v[64:79]
  ds_read_b64_tr_b16 v[96:97], v16 offset:5744
  ds_read_b64_tr_b16 v[98:99], v16 offset:5920
  s_waitcnt lgkmcnt(4)
  v_mfma_f32_32x32x16_bf16 v[32:47], v[80:83], v[88:91], v[32:47]
  ds_read_b128 v[84:87], v15 offset:0
  ds_read_b64_tr_b16 v[100:101], v16 offset:8448
  ds_read_b64_tr_b16 v[102:103], v16 offset:8624
  s_waitcnt lgkmcnt(5)
  v_mfma_f32_32x32x16_bf16 v[48:63], v[80:83], v[92:95], v[48:63]
  ds_read_b64_tr_b16 v[104:105], v16 offset:8504
  ds_read_b64_tr_b16 v[106:107], v16 offset:8680
  s_waitcnt lgkmcnt(5)
  v_mfma_f32_32x32x16_bf16 v[64:79], v[80:83], v[96:99], v[64:79]
  ds_read_b64_tr_b16 v[108:109], v16 offset:8560
  ds_read_b64_tr_b16 v[110:111], v16 offset:8736
  s_waitcnt lgkmcnt(0)
  s_barrier
  v_mfma_f32_32x32x16_bf16 v[32:47], v[84:87], v[100:103], v[32:47]
  ds_read_b128 v[80:83], v12 offset:16384
  ds_read_b64_tr_b16 v[88:89], v16 offset:11264
  ds_read_b64_tr_b16 v[90:91], v16 offset:11440
  v_mfma_f32_32x32x16_bf16 v[48:63], v[84:87], v[104:107], v[48:63]
  ds_read_b64_tr_b16 v[92:93], v16 offset:11320
  ds_read_b64_tr_b16 v[94:95], v16 offset:11496
  v_mfma_f32_32x32x16_bf16 v[64:79], v[84:87], v[108:111], v[64:79]
  ds_read_b64_tr_b16 v[96:97], v16 offset:11376
  ds_read_b64_tr_b16 v[98:99], v16 offset:11552
  s_waitcnt lgkmcnt(4)
  v_mfma_f32_32x32x16_bf16 v[32:47], v[80:83], v[88:91], v[32:47]
  ds_read_b128 v[84:87], v13 offset:16384
  ds_read_b64_tr_b16 v[100:101], v16 offset:14080
  ds_read_b64_tr_b16 v[102:103], v16 offset:14256
  s_waitcnt lgkmcnt(5)
  v_mfma_f32_32x32x16_bf16 v[48:63], v[80:83], v[92:95], v[48:63]
  ds_read_b64_tr_b16 v[104:105], v16 offset:14136
  ds_read_b64_tr_b16 v[106:107], v16 offset:14312
  s_waitcnt lgkmcnt(5)
  v_mfma_f32_32x32x16_bf16 v[64:79], v[80:83], v[96:99], v[64:79]
  ds_read_b64_tr_b16 v[108:109], v16 offset:14192
  ds_read_b64_tr_b16 v[110:111], v16 offset:14368
  s_waitcnt lgkmcnt(4)
  v_mfma_f32_32x32x16_bf16 v[32:47], v[84:87], v[100:103], v[32:47]
  ds_read_b128 v[80:83], v14 offset:16384
  ds_read_b64_tr_b16 v[88:89], v16 offset:16896
  ds_read_b64_tr_b16 v[90:91], v16 offset:17072
  s_waitcnt lgkmcnt(5)
  v_mfma_f32_32x32x16_bf16 v[48:63], v[84:87], v[104:107], v[48:63]
  ds_read_b64_tr_b16 v[92:93], v16 offset:16952
  ds_read_b64_tr_b16 v[94:95], v16 offset:17128
  s_waitcnt lgkmcnt(5)
  v_mfma_f32_32x32x16_bf16 v[64:79], v[84:87], v[108:111], v[64:79]
  ds_read_b64_tr_b16 v[96:97], v16 offset:17008
  ds_read_b64_tr_b16 v[98:99], v16 offset:17184
  s_waitcnt lgkmcnt(4)
  v_mfma_f32_32x32x16_bf16 v[32:47], v[80:83], v[88:91], v[32:47]
  ds_read_b128 v[84:87], v15 offset:16384
  ds_read_b64_tr_b16 v[100:101], v16 offset:19712
  ds_read_b64_tr_b16 v[102:103], v16 offset:19888
  s_waitcnt lgkmcnt(5)
  v_mfma_f32_32x32x16_bf16 v[48:63], v[80:83], v[92:95], v[48:63]
  ds_read_b64_tr_b16 v[104:105], v16 offset:19768
  ds_read_b64_tr_b16 v[106:107], v16 offset:19944
  s_waitcnt lgkmcnt(5)
  v_mfma_f32_32x32x16_bf16 v[64:79], v[80:83], v[96:99], v[64:79]
  ds_read_b64_tr_b16 v[108:109], v16 offset:19824
  ds_read_b64_tr_b16 v[110:111], v16 offset:20000
  s_waitcnt vmcnt(0) lgkmcnt(0)
  s_barrier
  v_mfma_f32_32x32x16_bf16 v[32:47], v[84:87], v[100:103], v[32:47]
  ds_read_b128 v[80:83], v12 offset:32768
  ds_read_b64_tr_b16 v[88:89], v16 offset:22528
  ds_read_b64_tr_b16 v[90:91], v16 offset:22704
  v_mfma_f32_32x32x16_bf16 v[48:63], v[84:87], v[104:107], v[48:63]
  ds_read_b64_tr_b16 v[92:93], v16 offset:22584
  ds_read_b64_tr_b16 v[94:95], v16 offset:22760
  v_mfma_f32_32x32x16_bf16 v[64:79], v[84:87], v[108:111], v[64:79]
  ds_read_b64_tr_b16 v[96:97], v16 offset:22640
  ds_read_b64_tr_b16 v[98:99], v16 offset:22816
  s_waitcnt lgkmcnt(4)
  v_mfma_f32_32x32x16_bf16 v[32:47], v[80:83], v[88:91], v[32:47]
  ds_read_b128 v[84:87], v13 offset:32768
  ds_read_b64_tr_b16 v[100:101], v16 offset:25344
  ds_read_b64_tr_b16 v[102:103], v16 offset:25520
  s_waitcnt lgkmcnt(5)
  v_mfma_f32_32x32x16_bf16 v[48:63], v[80:83], v[92:95], v[48:63]
  ds_read_b64_tr_b16 v[104:105], v16 offset:25400
  ds_read_b64_tr_b16 v[106:107], v16 offset:25576
  s_waitcnt lgkmcnt(5)
  v_mfma_f32_32x32x16_bf16 v[64:79], v[80:83], v[96:99], v[64:79]
  ds_read_b64_tr_b16 v[108:109], v16 offset:25456
  ds_read_b64_tr_b16 v[110:111], v16 offset:25632
  s_waitcnt lgkmcnt(4)
  v_mfma_f32_32x32x16_bf16 v[32:47], v[84:87], v[100:103], v[32:47]
  ds_read_b128 v[80:83], v14 offset:32768
  ds_read_b64_tr_b16 v[88:89], v16 offset:28160
  ds_read_b64_tr_b16 v[90:91], v16 offset:28336
  s_waitcnt lgkmcnt(5)
  v_mfma_f32_32x32x16_bf16 v[48:63], v[84:87], v[104:107], v[48:63]
  ds_read_b64_tr_b16 v[92:93], v16 offset:28216
  ds_read_b64_tr_b16 v[94:95], v16 offset:28392
  s_waitcnt lgkmcnt(5)
  v_mfma_f32_32x32x16_bf16 v[64:79], v[84:87], v[108:111], v[64:79]
  ds_read_b64_tr_b16 v[96:97], v16 offset:28272
  ds_read_b64_tr_b16 v[98:99], v16 offset:28448
  s_waitcnt lgkmcnt(4)
  v_mfma_f32_32x32x16_bf16 v[32:47], v[80:83], v[88:91], v[32:47]
  ds_read_b128 v[84:87], v15 offset:32768
  ds_read_b64_tr_b16 v[100:101], v16 offset:30976
  ds_read_b64_tr_b16 v[102:103], v16 offset:31152
  s_waitcnt lgkmcnt(5)
  v_mfma_f32_32x32x16_bf16 v[48:63], v[80:83], v[92:95], v[48:63]
  ds_read_b64_tr_b16 v[104:105], v16 offset:31032
  ds_read_b64_tr_b16 v[106:107], v16 offset:31208
  s_waitcnt lgkmcnt(5)
  v_mfma_f32_32x32x16_bf16 v[64:79], v[80:83], v[96:99], v[64:79]
  ds_read_b64_tr_b16 v[108:109], v16 offset:31088
  ds_read_b64_tr_b16 v[110:111], v16 offset:31264
  s_waitcnt lgkmcnt(0)
  s_barrier
  v_mfma_f32_32x32x16_bf16 v[32:47], v[84:87], v[100:103], v[32:47]
  ds_read_b128 v[80:83], v12 offset:49152
  ds_read_b64_tr_b16 v[88:89], v16 offset:33792
  ds_read_b64_tr_b16 v[90:91], v16 offset:33968
  v_mfma_f32_32x32x16_bf16 v[48:63], v[84:87], v[104:107], v[48:63]
  ds_read_b64_tr_b16 v[92:93], v16 offset:33848
  ds_read_b64_tr_b16 v[94:95], v16 offset:34024
  v_mfma_f32_32x32x16_bf16 v[64:79], v[84:87], v[108:111], v[64:79]
  ds_read_b64_tr_b16 v[96:97], v16 offset:33904
  ds_read_b64_tr_b16 v[98:99], v16 offset:34080
  s_waitcnt lgkmcnt(4)
  v_mfma_f32_32x32x16_bf16 v[144:159], v[88:91], v[80:83], 0
  ds_read_b128 v[84:87], v13 offset:49152
  ds_read_b64_tr_b16 v[100:101], v16 offset:36608
  ds_read_b64_tr_b16 v[102:103], v16 offset:36784
  s_nop 7
  s_lshl_b32 s54, s22, 2
  s_add_u32 s54, s54, s3
  s_add_u32 s54, s54, 1024
  s_add_u32 s62, s52, 0
  s_and_b32 s56, s62, 15
  s_lshl_b32 s56, s56, 6
  s_add_u32 s56, s56, s54
  s_lshl_b32 s56, s56, 12
  s_add_u32 s48, s56, 4196352
  v_cvt_pk_bf16_f32 v112, v32, v33
  v_cvt_pk_bf16_f32 v113, v34, v35
  v_cvt_pk_bf16_f32 v114, v36, v37
  s_waitcnt lgkmcnt(5)
  v_mfma_f32_32x32x16_bf16 v[160:175], v[92:95], v[80:83], 0
  ds_read_b64_tr_b16 v[104:105], v16 offset:36664
  ds_read_b64_tr_b16 v[106:107], v16 offset:36840
  v_cvt_pk_bf16_f32 v115, v38, v39
  v_cvt_pk_bf16_f32 v116, v40, v41
  v_cvt_pk_bf16_f32 v117, v42, v43
  v_cvt_pk_bf16_f32 v118, v44, v45
  v_cvt_pk_bf16_f32 v119, v46, v47
  v_cndmask_b32_e64 v112, v112, v18, s[58:59]
  v_cndmask_b32_e64 v113, v113, v18, s[58:59]
  v_cndmask_b32_e64 v114, v114, v18, s[58:59]
  v_cndmask_b32_e64 v115, v115, v18, s[58:59]
  v_cndmask_b32_e64 v116, v116, v18, s[58:59]
  v_cndmask_b32_e64 v117, v117, v18, s[58:59]
  v_cndmask_b32_e64 v118, v118, v18, s[58:59]
  v_cndmask_b32_e64 v119, v119, v18, s[58:59]
  s_waitcnt lgkmcnt(5)
  v_mfma_f32_32x32x16_bf16 v[176:191], v[96:99], v[80:83], 0
  ds_read_b64_tr_b16 v[108:109], v16 offset:36720
  ds_read_b64_tr_b16 v[110:111], v16 offset:36896
  s_nop 1
  buffer_store_dwordx4 v[112:115], v2, s[32:35], s48 offen sc1
  buffer_store_dwordx4 v[116:119], v2, s[32:35], s48 offen offset:1024 sc1
  s_add_u32 s62, s52, 1
  s_and_b32 s56, s62, 15
  s_lshl_b32 s56, s56, 6
  s_add_u32 s56, s56, s54
  s_lshl_b32 s56, s56, 12
  s_add_u32 s49, s56, 4196352
  v_cvt_pk_bf16_f32 v120, v48, v49
  v_cvt_pk_bf16_f32 v121, v50, v51
  v_cvt_pk_bf16_f32 v122, v52, v53
  v_cvt_pk_bf16_f32 v123, v54, v55
  v_cvt_pk_bf16_f32 v124, v56, v57
  s_waitcnt lgkmcnt(4)
  v_mfma_f32_32x32x16_bf16 v[144:159], v[100:103], v[84:87], v[144:159]
  ds_read_b128 v[80:83], v14 offset:49152
  ds_read_b64_tr_b16 v[88:89], v16 offset:39424
  ds_read_b64_tr_b16 v[90:91], v16 offset:39600
  v_cvt_pk_bf16_f32 v125, v58, v59
  v_cvt_pk_bf16_f32 v126, v60, v61
  v_cvt_pk_bf16_f32 v127, v62, v63
  v_cndmask_b32_e64 v120, v120, v18, s[58:59]
  v_cndmask_b32_e64 v121, v121, v18, s[58:59]
  v_cndmask_b32_e64 v122, v122, v18, s[58:59]
  v_cndmask_b32_e64 v123, v123, v18, s[58:59]
  v_cndmask_b32_e64 v124, v124, v18, s[58:59]
  v_cndmask_b32_e64 v125, v125, v18, s[58:59]
  v_cndmask_b32_e64 v126, v126, v18, s[58:59]
  v_cndmask_b32_e64 v127, v127, v18, s[58:59]
  s_nop 1
  buffer_store_dwordx4 v[120:123], v2, s[32:35], s49 offen sc1
  buffer_store_dwordx4 v[124:127], v2, s[32:35], s49 offen offset:1024 sc1
  s_waitcnt lgkmcnt(5)
  v_mfma_f32_32x32x16_bf16 v[160:175], v[104:107], v[84:87], v[160:175]
  ds_read_b64_tr_b16 v[92:93], v16 offset:39480
  ds_read_b64_tr_b16 v[94:95], v16 offset:39656
  s_add_u32 s62, s52, 2
  s_and_b32 s56, s62, 15
  s_lshl_b32 s56, s56, 6
  s_add_u32 s56, s56, s54
  s_lshl_b32 s56, s56, 12
  s_add_u32 s53, s56, 4196352
  v_cvt_pk_bf16_f32 v128, v64, v65
  v_cvt_pk_bf16_f32 v129, v66, v67
  v_cvt_pk_bf16_f32 v130, v68, v69
  v_cvt_pk_bf16_f32 v131, v70, v71
  v_cvt_pk_bf16_f32 v132, v72, v73
  v_cvt_pk_bf16_f32 v133, v74, v75
  v_cvt_pk_bf16_f32 v134, v76, v77
  s_waitcnt lgkmcnt(5)
  v_mfma_f32_32x32x16_bf16 v[176:191], v[108:111], v[84:87], v[176:191]
  ds_read_b64_tr_b16 v[96:97], v16 offset:39536
  ds_read_b64_tr_b16 v[98:99], v16 offset:39712
  v_cvt_pk_bf16_f32 v135, v78, v79
  v_cndmask_b32_e64 v128, v128, v18, s[58:59]
  v_cndmask_b32_e64 v129, v129, v18, s[58:59]
  v_cndmask_b32_e64 v130, v130, v18, s[58:59]
  v_cndmask_b32_e64 v131, v131, v18, s[58:59]
  v_cndmask_b32_e64 v132, v132, v18, s[58:59]
  v_cndmask_b32_e64 v133, v133, v18, s[58:59]
  v_cndmask_b32_e64 v134, v134, v18, s[58:59]
  v_cndmask_b32_e64 v135, v135, v18, s[58:59]
  s_nop 1
  buffer_store_dwordx4 v[128:131], v2, s[32:35], s53 offen sc1
  buffer_store_dwordx4 v[132:135], v2, s[32:35], s53 offen offset:1024 sc1
  s_waitcnt lgkmcnt(4)
  v_mfma_f32_32x32x16_bf16 v[144:159], v[88:91], v[80:83], v[144:159]
  ds_read_b128 v[84:87], v15 offset:49152
  ds_read_b64_tr_b16 v[100:101], v16 offset:42240
  ds_read_b64_tr_b16 v[102:103], v16 offset:42416
  s_waitcnt lgkmcnt(5)
  v_mfma_f32_32x32x16_bf16 v[160:175], v[92:95], v[80:83], v[160:175]
  ds_read_b64_tr_b16 v[104:105], v16 offset:42296
  ds_read_b64_tr_b16 v[106:107], v16 offset:42472
  s_waitcnt lgkmcnt(5)
  v_mfma_f32_32x32x16_bf16 v[176:191], v[96:99], v[80:83], v[176:191]
  ds_read_b64_tr_b16 v[108:109], v16 offset:42352
  ds_read_b64_tr_b16 v[110:111], v16 offset:42528
  s_waitcnt lgkmcnt(0)
  s_barrier
  v_mfma_f32_32x32x16_bf16 v[144:159], v[100:103], v[84:87], v[144:159]
  ds_read_b128 v[80:83], v12 offset:0
  ds_read_b64_tr_b16 v[88:89], v16 offset:0
  ds_read_b64_tr_b16 v[90:91], v16 offset:176
  v_mfma_f32_32x32x16_bf16 v[160:175], v[104:107], v[84:87], v[160:175]
  ds_read_b64_tr_b16 v[92:93], v16 offset:56
  ds_read_b64_tr_b16 v[94:95], v16 offset:232
  v_mfma_f32_32x32x16_bf16 v[176:191], v[108:111], v[84:87], v[176:191]
  ds_read_b64_tr_b16 v[96:97], v16 offset:112
  ds_read_b64_tr_b16 v[98:99], v16 offset:288
  s_waitcnt lgkmcnt(4)
  v_mfma_f32_32x32x16_bf16 v[144:159], v[88:91], v[80:83], v[144:159]
  ds_read_b128 v[84:87], v13 offset:0
  ds_read_b64_tr_b16 v[100:101], v16 offset:2816
  ds_read_b64_tr_b16 v[102:103], v16 offset:2992
  s_waitcnt lgkmcnt(5)
  v_mfma_f32_32x32x16_bf16 v[160:175], v[92:95], v[80:83], v[160:175]
  ds_read_b64_tr_b16 v[104:105], v16 offset:2872
  ds_read_b64_tr_b16 v[106:107], v16 offset:3048
  s_waitcnt lgkmcnt(5)
  v_mfma_f32_32x32x16_bf16 v[176:191], v[96:99], v[80:83], v[176:191]
  ds_read_b64_tr_b16 v[108:109], v16 offset:2928
  ds_read_b64_tr_b16 v[110:111], v16 offset:3104
  s_waitcnt lgkmcnt(4)
  v_mfma_f32_32x32x16_bf16 v[144:159], v[100:103], v[84:87], v[144:159]
  ds_read_b128 v[80:83], v14 offset:0
  ds_read_b64_tr_b16 v[88:89], v16 offset:5632
  ds_read_b64_tr_b16 v[90:91], v16 offset:5808
  s_waitcnt lgkmcnt(5)
  v_mfma_f32_32x32x16_bf16 v[160:175], v[104:107], v[84:87], v[160:175]
  ds_read_b64_tr_b16 v[92:93], v16 offset:5688
  ds_read_b64_tr_b16 v[94:95], v16 offset:5864
  s_waitcnt lgkmcnt(5)
  v_mfma_f32_32x32x16_bf16 v[176:191], v[108:111], v[84:87], v[176:191]
  ds_read_b64_tr_b16 v[96:97], v16 offset:5744
  ds_read_b64_tr_b16 v[98:99], v16 offset:5920
  s_waitcnt lgkmcnt(4)
  v_mfma_f32_32x32x16_bf16 v[144:159], v[88:91], v[80:83], v[144:159]
  ds_read_b128 v[84:87], v15 offset:0
  ds_read_b64_tr_b16 v[100:101], v16 offset:8448
  ds_read_b64_tr_b16 v[102:103], v16 offset:8624
  s_waitcnt lgkmcnt(5)
  v_mfma_f32_32x32x16_bf16 v[160:175], v[92:95], v[80:83], v[160:175]
  ds_read_b64_tr_b16 v[104:105], v16 offset:8504
  ds_read_b64_tr_b16 v[106:107], v16 offset:8680
  s_waitcnt lgkmcnt(5)
  v_mfma_f32_32x32x16_bf16 v[176:191], v[96:99], v[80:83], v[176:191]
  ds_read_b64_tr_b16 v[108:109], v16 offset:8560
  ds_read_b64_tr_b16 v[110:111], v16 offset:8736
  s_waitcnt vmcnt(0) lgkmcnt(0)
  s_barrier
  s_cmp_lg_u32 s3, 0
  s_cbranch_scc1 LsigB_37
  v_readfirstlane_b32 s47, v31
  s_cmp_lg_u32 s47, 0
  s_cbranch_scc1 Linited_38
  s_mov_b32 s68, 200000
Linitspin_39:
  buffer_load_dword v31, v30, s[36:39], 0 offen sc1
  s_waitcnt vmcnt(0)
  v_readfirstlane_b32 s47, v31
  s_cmp_lg_u32 s47, 0
  s_cbranch_scc1 Linited_38
  s_sub_u32 s68, s68, 1
  s_cmp_lg_u32 s68, 0
  s_cbranch_scc1 Linitspin_39
Linited_38:
  s_mov_b64 exec, 1
  v_mov_b32 v1, 1
  s_lshl_b32 s47, s23, 8
  s_add_u32 s47, s47, 4096
  v_mov_b32 v29, s47
  buffer_atomic_add v1, v29, s[64:67], 0 offen sc1
  s_mov_b64 exec, -1
LsigB_37:
  v_mfma_f32_32x32x16_bf16 v[144:159], v[100:103], v[84:87], v[144:159]
  ds_read_b128 v[80:83], v12 offset:16384
  ds_read_b64_tr_b16 v[88:89], v16 offset:11264
  ds_read_b64_tr_b16 v[90:91], v16 offset:11440
  v_mfma_f32_32x32x16_bf16 v[160:175], v[104:107], v[84:87], v[160:175]
  ds_read_b64_tr_b16 v[92:93], v16 offset:11320
  ds_read_b64_tr_b16 v[94:95], v16 offset:11496
  v_mfma_f32_32x32x16_bf16 v[176:191], v[108:111], v[84:87], v[176:191]
  ds_read_b64_tr_b16 v[96:97], v16 offset:11376
  ds_read_b64_tr_b16 v[98:99], v16 offset:11552
  s_waitcnt lgkmcnt(4)
  v_mfma_f32_32x32x16_bf16 v[144:159], v[88:91], v[80:83], v[144:159]
  ds_read_b128 v[84:87], v13 offset:16384
  ds_read_b64_tr_b16 v[100:101], v16 offset:14080
  ds_read_b64_tr_b16 v[102:103], v16 offset:14256
  s_waitcnt lgkmcnt(5)
  v_mfma_f32_32x32x16_bf16 v[160:175], v[92:95], v[80:83], v[160:175]
  ds_read_b64_tr_b16 v[104:105], v16 offset:14136
  ds_read_b64_tr_b16 v[106:107], v16 offset:14312
  s_waitcnt lgkmcnt(5)
  v_mfma_f32_32x32x16_bf16 v[176:191], v[96:99], v[80:83], v[176:191]
  ds_read_b64_tr_b16 v[108:109], v16 offset:14192
  ds_read_b64_tr_b16 v[110:111], v16 offset:14368
  s_waitcnt lgkmcnt(4)
  v_mfma_f32_32x32x16_bf16 v[144:159], v[100:103], v[84:87], v[144:159]
  ds_read_b128 v[80:83], v14 offset:16384
  ds_read_b64_tr_b16 v[88:89], v16 offset:16896
  ds_read_b64_tr_b16 v[90:91], v16 offset:17072
  s_waitcnt lgkmcnt(5)
  v_mfma_f32_32x32x16_bf16 v[160:175], v[104:107], v[84:87], v[160:175]
  ds_read_b64_tr_b16 v[92:93], v16 offset:16952
  ds_read_b64_tr_b16 v[94:95], v16 offset:17128
  s_waitcnt lgkmcnt(5)
  v_mfma_f32_32x32x16_bf16 v[176:191], v[108:111], v[84:87], v[176:191]
  ds_read_b64_tr_b16 v[96:97], v16 offset:17008
  ds_read_b64_tr_b16 v[98:99], v16 offset:17184
  s_waitcnt lgkmcnt(4)
  v_mfma_f32_32x32x16_bf16 v[144:159], v[88:91], v[80:83], v[144:159]
  ds_read_b128 v[84:87], v15 offset:16384
  ds_read_b64_tr_b16 v[100:101], v16 offset:19712
  ds_read_b64_tr_b16 v[102:103], v16 offset:19888
  s_waitcnt lgkmcnt(5)
  v_mfma_f32_32x32x16_bf16 v[160:175], v[92:95], v[80:83], v[160:175]
  ds_read_b64_tr_b16 v[104:105], v16 offset:19768
  ds_read_b64_tr_b16 v[106:107], v16 offset:19944
  s_waitcnt lgkmcnt(5)
  v_mfma_f32_32x32x16_bf16 v[176:191], v[96:99], v[80:83], v[176:191]
  ds_read_b64_tr_b16 v[108:109], v16 offset:19824
  ds_read_b64_tr_b16 v[110:111], v16 offset:20000
  s_waitcnt lgkmcnt(0)
  s_barrier
  v_mfma_f32_32x32x16_bf16 v[144:159], v[100:103], v[84:87], v[144:159]
  ds_read_b128 v[80:83], v12 offset:32768
  ds_read_b64_tr_b16 v[88:89], v16 offset:22528
  ds_read_b64_tr_b16 v[90:91], v16 offset:22704
  v_mfma_f32_32x32x16_bf16 v[160:175], v[104:107], v[84:87], v[160:175]
  ds_read_b64_tr_b16 v[92:93], v16 offset:22584
  ds_read_b64_tr_b16 v[94:95], v16 offset:22760
  v_mfma_f32_32x32x16_bf16 v[176:191], v[108:111], v[84:87], v[176:191]
  ds_read_b64_tr_b16 v[96:97], v16 offset:22640
  ds_read_b64_tr_b16 v[98:99], v16 offset:22816
  s_waitcnt lgkmcnt(4)
  v_mfma_f32_32x32x16_bf16 v[144:159], v[88:91], v[80:83], v[144:159]
  ds_read_b128 v[84:87], v13 offset:32768
  ds_read_b64_tr_b16 v[100:101], v16 offset:25344
  ds_read_b64_tr_b16 v[102:103], v16 offset:25520
  s_waitcnt lgkmcnt(5)
  v_mfma_f32_32x32x16_bf16 v[160:175], v[92:95], v[80:83], v[160:175]
  ds_read_b64_tr_b16 v[104:105], v16 offset:25400
  ds_read_b64_tr_b16 v[106:107], v16 offset:25576
  s_waitcnt lgkmcnt(5)
  v_mfma_f32_32x32x16_bf16 v[176:191], v[96:99], v[80:83], v[176:191]
  ds_read_b64_tr_b16 v[108:109], v16 offset:25456
  ds_read_b64_tr_b16 v[110:111], v16 offset:25632
  s_waitcnt lgkmcnt(4)
  v_mfma_f32_32x32x16_bf16 v[144:159], v[100:103], v[84:87], v[144:159]
  ds_read_b128 v[80:83], v14 offset:32768
  ds_read_b64_tr_b16 v[88:89], v16 offset:28160
  ds_read_b64_tr_b16 v[90:91], v16 offset:28336
  s_waitcnt lgkmcnt(5)
  v_mfma_f32_32x32x16_bf16 v[160:175], v[104:107], v[84:87], v[160:175]
  ds_read_b64_tr_b16 v[92:93], v16 offset:28216
  ds_read_b64_tr_b16 v[94:95], v16 offset:28392
  s_waitcnt lgkmcnt(5)
  v_mfma_f32_32x32x16_bf16 v[176:191], v[108:111], v[84:87], v[176:191]
  ds_read_b64_tr_b16 v[96:97], v16 offset:28272
  ds_read_b64_tr_b16 v[98:99], v16 offset:28448
  s_waitcnt lgkmcnt(4)
  v_mfma_f32_32x32x16_bf16 v[144:159], v[88:91], v[80:83], v[144:159]
  ds_read_b128 v[84:87], v15 offset:32768
  ds_read_b64_tr_b16 v[100:101], v16 offset:30976
  ds_read_b64_tr_b16 v[102:103], v16 offset:31152
  s_waitcnt lgkmcnt(5)
  v_mfma_f32_32x32x16_bf16 v[160:175], v[92:95], v[80:83], v[160:175]
  ds_read_b64_tr_b16 v[104:105], v16 offset:31032
  ds_read_b64_tr_b16 v[106:107], v16 offset:31208
  s_waitcnt lgkmcnt(5)
  v_mfma_f32_32x32x16_bf16 v[176:191], v[96:99], v[80:83], v[176:191]
  ds_read_b64_tr_b16 v[108:109], v16 offset:31088
  ds_read_b64_tr_b16 v[110:111], v16 offset:31264
  s_waitcnt lgkmcnt(0)
  s_barrier
  v_mfma_f32_32x32x16_bf16 v[144:159], v[100:103], v[84:87], v[144:159]
  ds_read_b128 v[80:83], v12 offset:49152
  ds_read_b64_tr_b16 v[88:89], v16 offset:33792
  ds_read_b64_tr_b16 v[90:91], v16 offset:33968
  v_mfma_f32_32x32x16_bf16 v[160:175], v[104:107], v[84:87], v[160:175]
  ds_read_b64_tr_b16 v[92:93], v16 offset:33848
  ds_read_b64_tr_b16 v[94:95], v16 offset:34024
  v_mfma_f32_32x32x16_bf16 v[176:191], v[108:111], v[84:87], v[176:191]
  ds_read_b64_tr_b16 v[96:97], v16 offset:33904
  ds_read_b64_tr_b16 v[98:99], v16 offset:34080
  s_waitcnt lgkmcnt(4)
  v_mfma_f32_32x32x16_bf16 v[144:159], v[88:91], v[80:83], v[144:159]
  ds_read_b128 v[84:87], v13 offset:49152
  ds_read_b64_tr_b16 v[100:101], v16 offset:36608
  ds_read_b64_tr_b16 v[102:103], v16 offset:36784
  s_waitcnt lgkmcnt(5)
  v_mfma_f32_32x32x16_bf16 v[160:175], v[92:95], v[80:83], v[160:175]
  ds_read_b64_tr_b16 v[104:105], v16 offset:36664
  ds_read_b64_tr_b16 v[106:107], v16 offset:36840
  s_waitcnt lgkmcnt(5)
  v_mfma_f32_32x32x16_bf16 v[176:191], v[96:99], v[80:83], v[176:191]
  ds_read_b64_tr_b16 v[108:109], v16 offset:36720
  ds_read_b64_tr_b16 v[110:111], v16 offset:36896
  s_waitcnt lgkmcnt(4)
  v_mfma_f32_32x32x16_bf16 v[144:159], v[100:103], v[84:87], v[144:159]
  ds_read_b128 v[80:83], v14 offset:49152
  ds_read_b64_tr_b16 v[88:89], v16 offset:39424
  ds_read_b64_tr_b16 v[90:91], v16 offset:39600
  s_waitcnt lgkmcnt(5)
  v_mfma_f32_32x32x16_bf16 v[160:175], v[104:107], v[84:87], v[160:175]
  ds_read_b64_tr_b16 v[92:93], v16 offset:39480
  ds_read_b64_tr_b16 v[94:95], v16 offset:39656
  s_waitcnt lgkmcnt(5)
  v_mfma_f32_32x32x16_bf16 v[176:191], v[108:111], v[84:87], v[176:191]
  ds_read_b64_tr_b16 v[96:97], v16 offset:39536
  ds_read_b64_tr_b16 v[98:99], v16 offset:39712
  s_waitcnt lgkmcnt(4)
  v_mfma_f32_32x32x16_bf16 v[144:159], v[88:91], v[80:83], v[144:159]
  ds_read_b128 v[84:87], v15 offset:49152
  ds_read_b64_tr_b16 v[100:101], v16 offset:42240
  ds_read_b64_tr_b16 v[102:103], v16 offset:42416
  s_waitcnt lgkmcnt(5)
  v_mfma_f32_32x32x16_bf16 v[160:175], v[92:95], v[80:83], v[160:175]
  ds_read_b64_tr_b16 v[104:105], v16 offset:42296
  ds_read_b64_tr_b16 v[106:107], v16 offset:42472
  s_waitcnt lgkmcnt(5)
  v_mfma_f32_32x32x16_bf16 v[176:191], v[96:99], v[80:83], v[176:191]
  ds_read_b64_tr_b16 v[108:109], v16 offset:42352
  ds_read_b64_tr_b16 v[110:111], v16 offset:42528
  s_waitcnt lgkmcnt(0)
  s_barrier
  v_mfma_f32_32x32x16_bf16 v[144:159], v[100:103], v[84:87], v[144:159]
  ds_read_b128 v[80:83], v12 offset:0
  ds_read_b64_tr_b16 v[88:89], v16 offset:0
  ds_read_b64_tr_b16 v[90:91], v16 offset:176
  v_mfma_f32_32x32x16_bf16 v[160:175], v[104:107], v[84:87], v[160:175]
  ds_read_b64_tr_b16 v[92:93], v16 offset:56
  ds_read_b64_tr_b16 v[94:95], v16 offset:232
  v_mfma_f32_32x32x16_bf16 v[176:191], v[108:111], v[84:87], v[176:191]
  ds_read_b64_tr_b16 v[96:97], v16 offset:112
  ds_read_b64_tr_b16 v[98:99], v16 offset:288
  s_waitcnt lgkmcnt(4)
  v_mfma_f32_32x32x16_bf16 v[144:159], v[88:91], v[80:83], v[144:159]
  ds_read_b128 v[84:87], v13 offset:0
  ds_read_b64_tr_b16 v[100:101], v16 offset:2816
  ds_read_b64_tr_b16 v[102:103], v16 offset:2992
  s_waitcnt lgkmcnt(5)
  v_mfma_f32_32x32x16_bf16 v[160:175], v[92:95], v[80:83], v[160:175]
  ds_read_b64_tr_b16 v[104:105], v16 offset:2872
  ds_read_b64_tr_b16 v[106:107], v16 offset:3048
  s_waitcnt lgkmcnt(5)
  v_mfma_f32_32x32x16_bf16 v[176:191], v[96:99], v[80:83], v[176:191]
  ds_read_b64_tr_b16 v[108:109], v16 offset:2928
  ds_read_b64_tr_b16 v[110:111], v16 offset:3104
  s_waitcnt lgkmcnt(4)
  v_mfma_f32_32x32x16_bf16 v[144:159], v[100:103], v[84:87], v[144:159]
  ds_read_b128 v[80:83], v14 offset:0
  ds_read_b64_tr_b16 v[88:89], v16 offset:5632
  ds_read_b64_tr_b16 v[90:91], v16 offset:5808
  s_waitcnt lgkmcnt(5)
  v_mfma_f32_32x32x16_bf16 v[160:175], v[104:107], v[84:87], v[160:175]
  ds_read_b64_tr_b16 v[92:93], v16 offset:5688
  ds_read_b64_tr_b16 v[94:95], v16 offset:5864
  s_waitcnt lgkmcnt(5)
  v_mfma_f32_32x32x16_bf16 v[176:191], v[108:111], v[84:87], v[176:191]
  ds_read_b64_tr_b16 v[96:97], v16 offset:5744
  ds_read_b64_tr_b16 v[98:99], v16 offset:5920
  s_waitcnt lgkmcnt(4)
  v_mfma_f32_32x32x16_bf16 v[144:159], v[88:91], v[80:83], v[144:159]
  ds_read_b128 v[84:87], v15 offset:0
  ds_read_b64_tr_b16 v[100:101], v16 offset:8448
  ds_read_b64_tr_b16 v[102:103], v16 offset:8624
  s_waitcnt lgkmcnt(5)
  v_mfma_f32_32x32x16_bf16 v[160:175], v[92:95], v[80:83], v[160:175]
  ds_read_b64_tr_b16 v[104:105], v16 offset:8504
  ds_read_b64_tr_b16 v[106:107], v16 offset:8680
  s_waitcnt lgkmcnt(5)
  v_mfma_f32_32x32x16_bf16 v[176:191], v[96:99], v[80:83], v[176:191]
  ds_read_b64_tr_b16 v[108:109], v16 offset:8560
  ds_read_b64_tr_b16 v[110:111], v16 offset:8736
  s_waitcnt lgkmcnt(0)
  s_barrier
  v_mfma_f32_32x32x16_bf16 v[144:159], v[100:103], v[84:87], v[144:159]
  ds_read_b128 v[80:83], v12 offset:16384
  ds_read_b64_tr_b16 v[88:89], v16 offset:11264
  ds_read_b64_tr_b16 v[90:91], v16 offset:11440
  v_mfma_f32_32x32x16_bf16 v[160:175], v[104:107], v[84:87], v[160:175]
  ds_read_b64_tr_b16 v[92:93], v16 offset:11320
  ds_read_b64_tr_b16 v[94:95], v16 offset:11496
  v_mfma_f32_32x32x16_bf16 v[176:191], v[108:111], v[84:87], v[176:191]
  ds_read_b64_tr_b16 v[96:97], v16 offset:11376
  ds_read_b64_tr_b16 v[98:99], v16 offset:11552
  s_waitcnt lgkmcnt(4)
  v_mfma_f32_32x32x16_bf16 v[144:159], v[88:91], v[80:83], v[144:159]
  ds_read_b128 v[84:87], v13 offset:16384
  ds_read_b64_tr_b16 v[100:101], v16 offset:14080
  ds_read_b64_tr_b16 v[102:103], v16 offset:14256
  s_waitcnt lgkmcnt(5)
  v_mfma_f32_32x32x16_bf16 v[160:175], v[92:95], v[80:83], v[160:175]
  ds_read_b64_tr_b16 v[104:105], v16 offset:14136
  ds_read_b64_tr_b16 v[106:107], v16 offset:14312
  s_waitcnt lgkmcnt(5)
  v_mfma_f32_32x32x16_bf16 v[176:191], v[96:99], v[80:83], v[176:191]
  ds_read_b64_tr_b16 v[108:109], v16 offset:14192
  ds_read_b64_tr_b16 v[110:111], v16 offset:14368
  s_waitcnt lgkmcnt(4)
  v_mfma_f32_32x32x16_bf16 v[144:159], v[100:103], v[84:87], v[144:159]
  ds_read_b128 v[80:83], v14 offset:16384
  ds_read_b64_tr_b16 v[88:89], v16 offset:16896
  ds_read_b64_tr_b16 v[90:91], v16 offset:17072
  s_waitcnt lgkmcnt(5)
  v_mfma_f32_32x32x16_bf16 v[160:175], v[104:107], v[84:87], v[160:175]
  ds_read_b64_tr_b16 v[92:93], v16 offset:16952
  ds_read_b64_tr_b16 v[94:95], v16 offset:17128
  s_waitcnt lgkmcnt(5)
  v_mfma_f32_32x32x16_bf16 v[176:191], v[108:111], v[84:87], v[176:191]
  ds_read_b64_tr_b16 v[96:97], v16 offset:17008
  ds_read_b64_tr_b16 v[98:99], v16 offset:17184
  s_waitcnt lgkmcnt(4)
  v_mfma_f32_32x32x16_bf16 v[144:159], v[88:91], v[80:83], v[144:159]
  ds_read_b128 v[84:87], v15 offset:16384
  ds_read_b64_tr_b16 v[100:101], v16 offset:19712
  ds_read_b64_tr_b16 v[102:103], v16 offset:19888
  s_waitcnt lgkmcnt(5)
  v_mfma_f32_32x32x16_bf16 v[160:175], v[92:95], v[80:83], v[160:175]
  ds_read_b64_tr_b16 v[104:105], v16 offset:19768
  ds_read_b64_tr_b16 v[106:107], v16 offset:19944
  s_waitcnt lgkmcnt(5)
  v_mfma_f32_32x32x16_bf16 v[176:191], v[96:99], v[80:83], v[176:191]
  ds_read_b64_tr_b16 v[108:109], v16 offset:19824
  ds_read_b64_tr_b16 v[110:111], v16 offset:20000
  s_waitcnt lgkmcnt(4)
  v_mfma_f32_32x32x16_bf16 v[144:159], v[100:103], v[84:87], v[144:159]
  s_waitcnt lgkmcnt(2)
  v_mfma_f32_32x32x16_bf16 v[160:175], v[104:107], v[84:87], v[160:175]
  s_waitcnt lgkmcnt(0)
  v_mfma_f32_32x32x16_bf16 v[176:191], v[108:111], v[84:87], v[176:191]
  s_barrier
  s_and_b32 s40, s2, 7
  s_bfe_u32 s41, s2, 0x10003
  s_lshl_b32 s40, s40, 1
  s_add_u32 s40, s40, s41
  s_lshl_b32 s47, s40, 18
  s_add_u32 s47, s47, 8388608
  s_add_u32 s32, s20, s47
  s_addc_u32 s33, s21, 0
  s_mov_b32 s34, 0x40000
  s_mov_b32 s35, 0x20000
  s_lshl_b32 s55, s3, 12
  s_add_u32 s54, s55, 0
  s_add_u32 m0, s55, 0
  s_nop 0
  buffer_load_dwordx4 v2, s[32:35], s54 offen offset:0 lds
  buffer_load_dwordx4 v2, s[32:35], s54 offen offset:1024 lds
  buffer_load_dwordx4 v2, s[32:35], s54 offen offset:2048 lds
  buffer_load_dwordx4 v2, s[32:35], s54 offen offset:3072 lds
  s_add_u32 s54, s55, 32768
  s_add_u32 m0, s55, 32768
  s_nop 0
  buffer_load_dwordx4 v2, s[32:35], s54 offen offset:0 lds
  buffer_load_dwordx4 v2, s[32:35], s54 offen offset:1024 lds
  buffer_load_dwordx4 v2, s[32:35], s54 offen offset:2048 lds
  buffer_load_dwordx4 v2, s[32:35], s54 offen offset:3072 lds
  s_lshl_b32 s54, s22, 2
  s_add_u32 s54, s54, s3
  s_add_u32 s62, s63, 0
  s_and_b32 s56, s62, 15
  s_lshl_b32 s56, s56, 6
  s_add_u32 s56, s56, s54
  s_cmp_lt_u32 s62, 16
  s_cselect_b32 s57, 0x3e8b97f6, 1.0
  s_cselect_b32 s45, 0, 0x3f80
  s_cselect_b32 s46, 11, 12
  s_cselect_b32 s47, 0, 4194304
  s_lshl_b32 s56, s56, s46
  s_add_u32 s48, s56, s47
  v_mov_b32 v19, s45
  v_mul_f32 v144, s57, v144
  v_mul_f32 v145, s57, v145
  v_mul_f32 v146, s57, v146
  v_mul_f32 v147, s57, v147
  v_mul_f32 v148, s57, v148
  v_mul_f32 v149, s57, v149
  v_mul_f32 v150, s57, v150
  v_mul_f32 v151, s57, v151
  v_mul_f32 v152, s57, v152
  v_mul_f32 v153, s57, v153
  v_mul_f32 v154, s57, v154
  v_mul_f32 v155, s57, v155
  v_mul_f32 v156, s57, v156
  v_mul_f32 v157, s57, v157
  v_mul_f32 v158, s57, v158
  v_mul_f32 v159, s57, v159
  v_cvt_pk_bf16_f32 v208, v144, v145
  v_cvt_pk_bf16_f32 v209, v146, v147
  v_cvt_pk_bf16_f32 v210, v148, v149
  v_cvt_pk_bf16_f32 v211, v150, v151
  v_cvt_pk_bf16_f32 v212, v152, v153
  v_cvt_pk_bf16_f32 v213, v154, v155
  v_cvt_pk_bf16_f32 v214, v156, v157
  v_cvt_pk_bf16_f32 v215, v158, v159
  v_cndmask_b32_e64 v214, v214, v19, s[60:61]
  v_cndmask_b32_e64 v215, v215, 0, s[60:61]
  s_add_u32 s62, s63, 1
  s_and_b32 s56, s62, 15
  s_lshl_b32 s56, s56, 6
  s_add_u32 s56, s56, s54
  s_cmp_lt_u32 s62, 16
  s_cselect_b32 s57, 0x3e8b97f6, 1.0
  s_cselect_b32 s45, 0, 0x3f80
  s_cselect_b32 s46, 11, 12
  s_cselect_b32 s47, 0, 4194304
  s_lshl_b32 s56, s56, s46
  s_add_u32 s49, s56, s47
  v_mov_b32 v19, s45
  v_mul_f32 v160, s57, v160
  v_mul_f32 v161, s57, v161
  v_mul_f32 v162, s57, v162
  v_mul_f32 v163, s57, v163
  v_mul_f32 v164, s57, v164
  v_mul_f32 v165, s57, v165
  v_mul_f32 v166, s57, v166
  v_mul_f32 v167, s57, v167
  v_mul_f32 v168, s57, v168
  v_mul_f32 v169, s57, v169
  v_mul_f32 v170, s57, v170
  v_mul_f32 v171, s57, v171
  v_mul_f32 v172, s57, v172
  v_mul_f32 v173, s57, v173
  v_mul_f32 v174, s57, v174
  v_mul_f32 v175, s57, v175
  v_cvt_pk_bf16_f32 v216, v160, v161
  v_cvt_pk_bf16_f32 v217, v162, v163
  v_cvt_pk_bf16_f32 v218, v164, v165
  v_cvt_pk_bf16_f32 v219, v166, v167
  v_cvt_pk_bf16_f32 v220, v168, v169
  v_cvt_pk_bf16_f32 v221, v170, v171
  v_cvt_pk_bf16_f32 v222, v172, v173
  v_cvt_pk_bf16_f32 v223, v174, v175
  v_cndmask_b32_e64 v222, v222, v19, s[60:61]
  v_cndmask_b32_e64 v223, v223, 0, s[60:61]
  s_add_u32 s62, s63, 2
  s_and_b32 s56, s62, 15
  s_lshl_b32 s56, s56, 6
  s_add_u32 s56, s56, s54
  s_cmp_lt_u32 s62, 16
  s_cselect_b32 s57, 0x3e8b97f6, 1.0
  s_cselect_b32 s45, 0, 0x3f80
  s_cselect_b32 s46, 11, 12
  s_cselect_b32 s47, 0, 4194304
  s_lshl_b32 s56, s56, s46
  s_add_u32 s53, s56, s47
  v_mov_b32 v19, s45
  v_mul_f32 v176, s57, v176
  v_mul_f32 v177, s57, v177
  v_mul_f32 v178, s57, v178
  v_mul_f32 v179, s57, v179
  v_mul_f32 v180, s57, v180
  v_mul_f32 v181, s57, v181
  v_mul_f32 v182, s57, v182
  v_mul_f32 v183, s57, v183
  v_mul_f32 v184, s57, v184
  v_mul_f32 v185, s57, v185
  v_mul_f32 v186, s57, v186
  v_mul_f32 v187, s57, v187
  v_mul_f32 v188, s57, v188
  v_mul_f32 v189, s57, v189
  v_mul_f32 v190, s57, v190
  v_mul_f32 v191, s57, v191
  v_cvt_pk_bf16_f32 v224, v176, v177
  v_cvt_pk_bf16_f32 v225, v178, v179
  v_cvt_pk_bf16_f32 v226, v180, v181
  v_cvt_pk_bf16_f32 v227, v182, v183
  v_cvt_pk_bf16_f32 v228, v184, v185
  v_cvt_pk_bf16_f32 v229, v186, v187
  v_cvt_pk_bf16_f32 v230, v188, v189
  v_cvt_pk_bf16_f32 v231, v190, v191
  v_cndmask_b32_e64 v230, v230, v19, s[60:61]
  v_cndmask_b32_e64 v231, v231, 0, s[60:61]
Lqkv_fin:
  s_branch Lattn_setup
Lattn_setup:
  s_and_b32 s40, s2, 7
  s_bfe_u32 s41, s2, 0x10003
  s_lshl_b32 s40, s40, 1
  s_add_u32 s40, s40, s41
  s_lshl_b32 s47, s40, 18
  s_add_u32 s47, s47, 8388608
  s_add_u32 s32, s20, s47
  s_addc_u32 s33, s21, 0
  s_mov_b32 s34, 0x40000
  s_mov_b32 s35, 0x20000
  s_lshl_b32 s55, s3, 12
  s_lshr_b32 s41, s2, 4
  s_and_b32 s42, s3, 3
  s_lshr_b32 s43, s3, 2
  v_lshlrev_b32 v2, 4, v0
  s_lshl_b32 s44, s40, 6
  s_lshl_b32 s45, s41, 2
  s_add_u32 s45, s45, s42
  s_add_u32 s44, s44, s45
  s_lshl_b32 s44, s44, 11
  s_mov_b32 s24, s20
  s_mov_b32 s25, s21
  s_mov_b32 s26, 4194304
  s_mov_b32 s27, 0x20000
  s_sub_u32 s28, s32, 0x400000
  s_subb_u32 s29, s33, 0
  s_mov_b32 s30, 0x40000
  s_mov_b32 s31, 0x20000
  s_add_u32 s36, s20, 12582912
  s_addc_u32 s37, s21, 0
  s_mov_b32 s38, 4194304
  s_mov_b32 s39, 0x20000
  v_min_u32 v30, 2, v0
  v_lshlrev_b32 v30, 4, v30
  v_add_u32 v30, s40, v30
  v_mul_u32_u24 v30, 43, v30
  v_lshrrev_b32 v30, 7, v30
  v_lshlrev_b32 v31, 8, v30
  v_add_u32 v203, 4096, v31
  s_lshl_b32 s47, s41, 2
  s_add_u32 s47, s47, s3
  s_sub_u32 s47, s47, 8
  s_lshl_b32 s50, s47, 12
  s_cmp_lt_i32 s47, 0
  s_cselect_b32 s50, 0x40000000, s50
  v_add_u32 v28, s50, v2
  s_add_u32 s47, s47, 8
  s_lshl_b32 s50, s47, 12
  v_add_u32 v29, s50, v2
  s_lshl_b32 s47, s42, 12
  v_add_u32 v3, s47, v2
  s_lshl_b32 s47, s43, 14
  v_add_u32 v4, s47, v2
  v_add_u32 v5, 32768, v4
  v_add_u32 v6, 131072, v3
  s_lshl_b32 s47, s42, 8
  s_add_u32 s47, s47, 147456
  v_lshlrev_b32 v7, 2, v0
  v_add_u32 v7, s47, v7
  s_lshl_b32 s47, s42, 11
  s_add_u32 s51, s47, 131072
  v_add_u32 v200, s51, v2
  v_and_b32 v24, 31, v0
  v_lshrrev_b32 v25, 5, v0
  v_lshlrev_b32 v25, 2, v25
  v_sub_u32 v24, v24, v25
  v_mov_b32 v25, 0xf149f2ca
  s_mov_b32 s60, 0
  s_mov_b32 s61, -1
  s_mov_b32 s56, s20
  s_mov_b32 s57, s21
  s_mov_b32 s58, 16777216
  s_mov_b32 s59, 0x20000
  v_cmp_le_i32 vcc, 0, v24
  s_nop 1
  v_cndmask_b32_e64 v32, v25, 0, vcc
  v_cmp_le_i32 vcc, 1, v24
  s_nop 1
  v_cndmask_b32_e64 v33, v25, 0, vcc
  v_cmp_le_i32 vcc, 2, v24
  s_nop 1
  v_cndmask_b32_e64 v34, v25, 0, vcc
  v_cmp_le_i32 vcc, 3, v24
  s_nop 1
  v_cndmask_b32_e64 v35, v25, 0, vcc
  v_cmp_le_i32 vcc, 8, v24
  s_nop 1
  v_cndmask_b32_e64 v36, v25, 0, vcc
  v_cmp_le_i32 vcc, 9, v24
  s_nop 1
  v_cndmask_b32_e64 v37, v25, 0, vcc
  v_cmp_le_i32 vcc, 10, v24
  s_nop 1
  v_cndmask_b32_e64 v38, v25, 0, vcc
  v_cmp_le_i32 vcc, 11, v24
  s_nop 1
  v_cndmask_b32_e64 v39, v25, 0, vcc
  v_cmp_le_i32 vcc, 16, v24
  s_nop 1
  v_cndmask_b32_e64 v40, v25, 0, vcc
  v_cmp_le_i32 vcc, 17, v24
  s_nop 1
  v_cndmask_b32_e64 v41, v25, 0, vcc
  v_cmp_le_i32 vcc, 18, v24
  s_nop 1
  v_cndmask_b32_e64 v42, v25, 0, vcc
  v_cmp_le_i32 vcc, 19, v24
  s_nop 1
  v_cndmask_b32_e64 v43, v25, 0, vcc
  v_cmp_le_i32 vcc, 24, v24
  s_nop 1
  v_cndmask_b32_e64 v44, v25, 0, vcc
  v_cmp_le_i32 vcc, 25, v24
  s_nop 1
  v_cndmask_b32_e64 v45, v25, 0, vcc
  v_cmp_le_i32 vcc, 26, v24
  s_nop 1
  v_cndmask_b32_e64 v46, v25, 0, vcc
  v_cmp_le_i32 vcc, 27, v24
  s_nop 1
  v_cndmask_b32_e64 v47, v25, 0, vcc
  s_waitcnt vmcnt(4)
  s_barrier
Lattn_go:
  ds_read_b128 v[16:19], v200
  ds_read_b128 v[20:23], v200 offset:1024
  s_cmp_eq_u32 s43, 0
  s_cbranch_scc0 Lattn_kh1
  ds_read_b128 v[120:123], v4 offset:0
  ds_read_b128 v[124:127], v4 offset:1024
  s_waitcnt lgkmcnt(0)
  v_mfma_f32_32x32x16_bf16 v[48:63], v[120:123], v[16:19], 0
  v_mfma_f32_32x32x16_bf16 v[48:63], v[124:127], v[20:23], v[48:63]
  s_nop 15
  v_max3_f32 v136, v48, v49, v50
  v_max3_f32 v136, v136, v51, v52
  v_max3_f32 v136, v136, v53, v54
  v_max3_f32 v136, v136, v55, v56
  v_max3_f32 v136, v136, v57, v58
  v_max3_f32 v136, v136, v59, v60
  v_max3_f32 v136, v136, v61, v62
  v_max_f32 v136, v136, v63
  v_mov_b32 v137, v136
  s_nop 1
  v_permlane32_swap_b32 v136, v137
  s_nop 1
  v_max_f32 v136, v136, v137
  v_sub_f32 v136, 0, v136
  v_cvt_pk_bf16_f32 v136, v136, 0
  v_lshlrev_b32 v27, 16, v136
  s_mov_b64 exec, s[60:61]
  v_mov_b32 v22, v136
  s_mov_b64 exec, -1
  s_nop 1
  v_mfma_f32_32x32x16_bf16 v[48:63], v[120:123], v[16:19], 0
  v_mfma_f32_32x32x16_bf16 v[48:63], v[124:127], v[20:23], v[48:63]
  ds_read_b128 v[120:123], v4 offset:4096
  ds_read_b128 v[124:127], v4 offset:5120
  ds_read_b128 v[128:131], v4 offset:2048
  s_nop 15
  s_waitcnt lgkmcnt(0)
  s_setprio 1
  v_exp_f32 v48, v48
  ds_read_b128 v[132:135], v4 offset:3072
  v_exp_f32 v49, v49
  v_exp_f32 v50, v50
  v_exp_f32 v51, v51
  v_cvt_pk_bf16_f32 v80, v48, v49
  v_mfma_f32_32x32x16_bf16 v[64:79], v[120:123], v[16:19], 0
  v_exp_f32 v52, v52
  v_exp_f32 v53, v53
  v_cvt_pk_bf16_f32 v81, v50, v51
  v_exp_f32 v54, v54
  v_exp_f32 v55, v55
  v_cvt_pk_bf16_f32 v82, v52, v53
  v_mfma_f32_32x32x16_bf16 v[64:79], v[124:127], v[20:23], v[64:79]
  ds_read_b128 v[120:123], v4 offset:8192
  ds_read_b128 v[124:127], v4 offset:9216
  v_exp_f32 v56, v56
  v_cvt_pk_bf16_f32 v83, v54, v55
  v_exp_f32 v57, v57
  v_exp_f32 v58, v58
  s_add_u32 s54, s55, 65536
  s_add_u32 m0, s55, 65536
  s_nop 0
  buffer_load_dwordx4 v2, s[32:35], s54 offen offset:0 lds
  buffer_load_dwordx4 v2, s[32:35], s54 offen offset:1024 lds
  buffer_load_dwordx4 v2, s[32:35], s54 offen offset:2048 lds
  buffer_load_dwordx4 v2, s[32:35], s54 offen offset:3072 lds
  v_exp_f32 v59, v59
  v_mfma_f32_32x32x16_bf16 v[104:119], v[128:131], v[80:83], 0
  ds_read_b128 v[128:131], v4 offset:6144
  v_exp_f32 v60, v60
  v_exp_f32 v61, v61
  v_exp_f32 v62, v62
  v_exp_f32 v63, v63
  v_cvt_pk_bf16_f32 v84, v56, v57
  v_cvt_pk_bf16_f32 v85, v58, v59
  v_cvt_pk_bf16_f32 v86, v60, v61
  v_cvt_pk_bf16_f32 v87, v62, v63
  s_waitcnt lgkmcnt(0)
  s_setprio 0
  v_exp_f32 v64, v64
  v_mfma_f32_32x32x16_bf16 v[104:119], v[132:135], v[84:87], v[104:119]
  ds_read_b128 v[132:135], v4 offset:7168
  v_exp_f32 v65, v65
  v_exp_f32 v66, v66
  v_exp_f32 v67, v67
  v_cvt_pk_bf16_f32 v80, v64, v65
  v_mfma_f32_32x32x16_bf16 v[48:63], v[120:123], v[16:19], 0
  v_exp_f32 v68, v68
  v_exp_f32 v69, v69
  v_cvt_pk_bf16_f32 v81, v66, v67
  v_exp_f32 v70, v70
  v_exp_f32 v71, v71
  v_cvt_pk_bf16_f32 v82, v68, v69
  v_mfma_f32_32x32x16_bf16 v[48:63], v[124:127], v[20:23], v[48:63]
  ds_read_b128 v[120:123], v4 offset:12288
  ds_read_b128 v[124:127], v4 offset:13312
  v_exp_f32 v72, v72
  v_cvt_pk_bf16_f32 v83, v70, v71
  v_exp_f32 v73, v73
  v_exp_f32 v74, v74
  s_add_u32 s54, s55, 98304
  s_add_u32 m0, s55, 98304
  s_nop 0
  buffer_load_dwordx4 v2, s[32:35], s54 offen offset:0 lds
  buffer_load_dwordx4 v2, s[32:35], s54 offen offset:1024 lds
  buffer_load_dwordx4 v2, s[32:35], s54 offen offset:2048 lds
  buffer_load_dwordx4 v2, s[32:35], s54 offen offset:3072 lds
  v_exp_f32 v75, v75
  v_mfma_f32_32x32x16_bf16 v[104:119], v[128:131], v[80:83], v[104:119]
  ds_read_b128 v[128:131], v4 offset:10240
  v_exp_f32 v76, v76
  v_exp_f32 v77, v77
  v_exp_f32 v78, v78
  v_exp_f32 v79, v79
  v_cvt_pk_bf16_f32 v84, v72, v73
  v_cvt_pk_bf16_f32 v85, v74, v75
  v_cvt_pk_bf16_f32 v86, v76, v77
  v_cvt_pk_bf16_f32 v87, v78, v79
  s_waitcnt vmcnt(8) lgkmcnt(0)
  s_barrier
  s_setprio 3
  v_exp_f32 v48, v48
  v_mfma_f32_32x32x16_bf16 v[104:119], v[132:135], v[84:87], v[104:119]
  ds_read_b128 v[132:135], v4 offset:11264
  v_exp_f32 v49, v49
  v_exp_f32 v50, v50
  v_exp_f32 v51, v51
  v_cvt_pk_bf16_f32 v80, v48, v49
  v_mfma_f32_32x32x16_bf16 v[64:79], v[120:123], v[16:19], 0
  v_exp_f32 v52, v52
  v_exp_f32 v53, v53
  v_cvt_pk_bf16_f32 v81, v50, v51
  v_exp_f32 v54, v54
  v_exp_f32 v55, v55
  v_cvt_pk_bf16_f32 v82, v52, v53
  v_mfma_f32_32x32x16_bf16 v[64:79], v[124:127], v[20:23], v[64:79]
  ds_read_b128 v[120:123], v5 offset:0
  ds_read_b128 v[124:127], v5 offset:1024
  v_exp_f32 v56, v56
  v_cvt_pk_bf16_f32 v83, v54, v55
  v_exp_f32 v57, v57
  v_exp_f32 v58, v58
  buffer_store_dwordx4 v[208:211], v2, s[56:59], s48 offen sc1
  buffer_store_dwordx4 v[212:215], v2, s[56:59], s48 offen offset:1024 sc1
  buffer_store_dwordx4 v[216:219], v2, s[56:59], s49 offen sc1
  buffer_store_dwordx4 v[220:223], v2, s[56:59], s49 offen offset:1024 sc1
  buffer_store_dwordx4 v[224:227], v2, s[56:59], s53 offen sc1
  buffer_store_dwordx4 v[228:231], v2, s[56:59], s53 offen offset:1024 sc1
  v_exp_f32 v59, v59
  v_mfma_f32_32x32x16_bf16 v[104:119], v[128:131], v[80:83], v[104:119]
  ds_read_b128 v[128:131], v4 offset:14336
  v_exp_f32 v60, v60
  v_exp_f32 v61, v61
  v_exp_f32 v62, v62
  v_exp_f32 v63, v63
  v_cvt_pk_bf16_f32 v84, v56, v57
  v_cvt_pk_bf16_f32 v85, v58, v59
  v_cvt_pk_bf16_f32 v86, v60, v61
  v_cvt_pk_bf16_f32 v87, v62, v63
  s_waitcnt lgkmcnt(0)
  s_setprio 2
  v_exp_f32 v64, v64
  v_mfma_f32_32x32x16_bf16 v[104:119], v[132:135], v[84:87], v[104:119]
  ds_read_b128 v[132:135], v4 offset:15360
  v_exp_f32 v65, v65
  v_exp_f32 v66, v66
  v_exp_f32 v67, v67
  v_cvt_pk_bf16_f32 v80, v64, v65
  v_mfma_f32_32x32x16_bf16 v[48:63], v[120:123], v[16:19], 0
  v_exp_f32 v68, v68
  v_exp_f32 v69, v69
  v_cvt_pk_bf16_f32 v81, v66, v67
  v_exp_f32 v70, v70
  v_exp_f32 v71, v71
  v_cvt_pk_bf16_f32 v82, v68, v69
  v_mfma_f32_32x32x16_bf16 v[48:63], v[124:127], v[20:23], v[48:63]
  ds_read_b128 v[120:123], v5 offset:4096
  ds_read_b128 v[124:127], v5 offset:5120
  v_exp_f32 v72, v72
  v_cvt_pk_bf16_f32 v83, v70, v71
  v_exp_f32 v73, v73
  v_exp_f32 v74, v74
  v_exp_f32 v75, v75
  v_mfma_f32_32x32x16_bf16 v[104:119], v[128:131], v[80:83], v[104:119]
  ds_read_b128 v[128:131], v5 offset:2048
  v_exp_f32 v76, v76
  v_exp_f32 v77, v77
  v_exp_f32 v78, v78
  v_exp_f32 v79, v79
  v_cvt_pk_bf16_f32 v84, v72, v73
  v_cvt_pk_bf16_f32 v85, v74, v75
  v_cvt_pk_bf16_f32 v86, v76, v77
  v_cvt_pk_bf16_f32 v87, v78, v79
  v_mov_b32 v4, v5
  v_add_u32 v5, 32768, v5
  v_and_b32 v5, 0x1ffff, v5
  s_waitcnt lgkmcnt(0)
  s_setprio 1
  v_exp_f32 v48, v48
  v_mfma_f32_32x32x16_bf16 v[104:119], v[132:135], v[84:87], v[104:119]
  ds_read_b128 v[132:135], v4 offset:3072
  v_exp_f32 v49, v49
  v_exp_f32 v50, v50
  v_exp_f32 v51, v51
  v_cvt_pk_bf16_f32 v80, v48, v49
  v_mfma_f32_32x32x16_bf16 v[64:79], v[120:123], v[16:19], 0
  v_exp_f32 v52, v52
  v_exp_f32 v53, v53
  v_cvt_pk_bf16_f32 v81, v50, v51
  v_exp_f32 v54, v54
  v_exp_f32 v55, v55
  v_cvt_pk_bf16_f32 v82, v52, v53
  v_mfma_f32_32x32x16_bf16 v[64:79], v[124:127], v[20:23], v[64:79]
  ds_read_b128 v[120:123], v4 offset:8192
  ds_read_b128 v[124:127], v4 offset:9216
  v_exp_f32 v56, v56
  v_cvt_pk_bf16_f32 v83, v54, v55
  v_exp_f32 v57, v57
  v_exp_f32 v58, v58
  v_exp_f32 v59, v59
  v_mfma_f32_32x32x16_bf16 v[104:119], v[128:131], v[80:83], v[104:119]
  ds_read_b128 v[128:131], v4 offset:6144
  v_exp_f32 v60, v60
  v_exp_f32 v61, v61
  v_exp_f32 v62, v62
  v_exp_f32 v63, v63
  v_cvt_pk_bf16_f32 v84, v56, v57
  v_cvt_pk_bf16_f32 v85, v58, v59
  v_cvt_pk_bf16_f32 v86, v60, v61
  v_cvt_pk_bf16_f32 v87, v62, v63
  s_waitcnt lgkmcnt(0)
  s_setprio 0
  v_exp_f32 v64, v64
  v_mfma_f32_32x32x16_bf16 v[104:119], v[132:135], v[84:87], v[104:119]
  ds_read_b128 v[132:135], v4 offset:7168
  v_exp_f32 v65, v65
  v_exp_f32 v66, v66
  v_exp_f32 v67, v67
  v_cvt_pk_bf16_f32 v80, v64, v65
  v_mfma_f32_32x32x16_bf16 v[48:63], v[120:123], v[16:19], 0
  v_exp_f32 v68, v68
  v_exp_f32 v69, v69
  v_cvt_pk_bf16_f32 v81, v66, v67
  v_exp_f32 v70, v70
  v_exp_f32 v71, v71
  v_cvt_pk_bf16_f32 v82, v68, v69
  v_mfma_f32_32x32x16_bf16 v[48:63], v[124:127], v[20:23], v[48:63]
  ds_read_b128 v[120:123], v4 offset:12288
  ds_read_b128 v[124:127], v4 offset:13312
  v_exp_f32 v72, v72
  v_cvt_pk_bf16_f32 v83, v70, v71
  v_exp_f32 v73, v73
  v_exp_f32 v74, v74
  v_exp_f32 v75, v75
  v_mfma_f32_32x32x16_bf16 v[104:119], v[128:131], v[80:83], v[104:119]
  ds_read_b128 v[128:131], v4 offset:10240
  v_exp_f32 v76, v76
  v_exp_f32 v77, v77
  v_exp_f32 v78, v78
  v_exp_f32 v79, v79
  v_cvt_pk_bf16_f32 v84, v72, v73
  v_cvt_pk_bf16_f32 v85, v74, v75
  v_cvt_pk_bf16_f32 v86, v76, v77
  v_cvt_pk_bf16_f32 v87, v78, v79
  s_waitcnt vmcnt(10) lgkmcnt(0)
  s_barrier
  s_setprio 3
  v_exp_f32 v48, v48
  v_mfma_f32_32x32x16_bf16 v[104:119], v[132:135], v[84:87], v[104:119]
  ds_read_b128 v[132:135], v4 offset:11264
  v_exp_f32 v49, v49
  v_exp_f32 v50, v50
  v_exp_f32 v51, v51
  v_cvt_pk_bf16_f32 v80, v48, v49
  v_mfma_f32_32x32x16_bf16 v[64:79], v[120:123], v[16:19], 0
  v_exp_f32 v52, v52
  v_exp_f32 v53, v53
  v_cvt_pk_bf16_f32 v81, v50, v51
  v_exp_f32 v54, v54
  v_exp_f32 v55, v55
  v_cvt_pk_bf16_f32 v82, v52, v53
  v_mfma_f32_32x32x16_bf16 v[64:79], v[124:127], v[20:23], v[64:79]
  ds_read_b128 v[120:123], v5 offset:0
  ds_read_b128 v[124:127], v5 offset:1024
  v_exp_f32 v56, v56
  v_cvt_pk_bf16_f32 v83, v54, v55
  v_exp_f32 v57, v57
  v_exp_f32 v58, v58
  s_add_u32 s54, s55, 131072
  s_add_u32 m0, s55, 0
  s_nop 0
  buffer_load_dwordx4 v2, s[32:35], s54 offen offset:0 lds
  v_exp_f32 v59, v59
  v_mfma_f32_32x32x16_bf16 v[104:119], v[128:131], v[80:83], v[104:119]
  ds_read_b128 v[128:131], v4 offset:14336
  v_exp_f32 v60, v60
  v_exp_f32 v61, v61
  v_exp_f32 v62, v62
  v_exp_f32 v63, v63
  v_cvt_pk_bf16_f32 v84, v56, v57
  v_cvt_pk_bf16_f32 v85, v58, v59
  v_cvt_pk_bf16_f32 v86, v60, v61
  v_cvt_pk_bf16_f32 v87, v62, v63
  s_waitcnt lgkmcnt(0)
  s_setprio 2
  v_exp_f32 v64, v64
  v_mfma_f32_32x32x16_bf16 v[104:119], v[132:135], v[84:87], v[104:119]
  ds_read_b128 v[132:135], v4 offset:15360
  v_exp_f32 v65, v65
  v_exp_f32 v66, v66
  v_exp_f32 v67, v67
  v_cvt_pk_bf16_f32 v80, v64, v65
  v_mfma_f32_32x32x16_bf16 v[48:63], v[120:123], v[16:19], 0
  v_exp_f32 v68, v68
  v_exp_f32 v69, v69
  v_cvt_pk_bf16_f32 v81, v66, v67
  v_exp_f32 v70, v70
  v_exp_f32 v71, v71
  v_cvt_pk_bf16_f32 v82, v68, v69
  v_mfma_f32_32x32x16_bf16 v[48:63], v[124:127], v[20:23], v[48:63]
  ds_read_b128 v[120:123], v5 offset:4096
  ds_read_b128 v[124:127], v5 offset:5120
  v_exp_f32 v72, v72
  v_cvt_pk_bf16_f32 v83, v70, v71
  v_exp_f32 v73, v73
  v_exp_f32 v74, v74
  buffer_load_dwordx4 v2, s[32:35], s54 offen offset:1024 lds
  v_exp_f32 v75, v75
  v_mfma_f32_32x32x16_bf16 v[104:119], v[128:131], v[80:83], v[104:119]
  ds_read_b128 v[128:131], v5 offset:2048
  v_exp_f32 v76, v76
  v_exp_f32 v77, v77
  v_exp_f32 v78, v78
  v_exp_f32 v79, v79
  v_cvt_pk_bf16_f32 v84, v72, v73
  v_cvt_pk_bf16_f32 v85, v74, v75
  v_cvt_pk_bf16_f32 v86, v76, v77
  v_cvt_pk_bf16_f32 v87, v78, v79
  v_mov_b32 v4, v5
  v_add_u32 v5, 32768, v5
  v_and_b32 v5, 0x1ffff, v5
  s_waitcnt lgkmcnt(0)
  s_setprio 1
  v_exp_f32 v48, v48
  v_mfma_f32_32x32x16_bf16 v[104:119], v[132:135], v[84:87], v[104:119]
  ds_read_b128 v[132:135], v4 offset:3072
  v_exp_f32 v49, v49
  v_exp_f32 v50, v50
  v_exp_f32 v51, v51
  v_cvt_pk_bf16_f32 v80, v48, v49
  v_mfma_f32_32x32x16_bf16 v[64:79], v[120:123], v[16:19], 0
  v_exp_f32 v52, v52
  v_exp_f32 v53, v53
  v_cvt_pk_bf16_f32 v81, v50, v51
  v_exp_f32 v54, v54
  v_exp_f32 v55, v55
  v_cvt_pk_bf16_f32 v82, v52, v53
  v_mfma_f32_32x32x16_bf16 v[64:79], v[124:127], v[20:23], v[64:79]
  ds_read_b128 v[120:123], v4 offset:8192
  ds_read_b128 v[124:127], v4 offset:9216
  v_exp_f32 v56, v56
  v_cvt_pk_bf16_f32 v83, v54, v55
  v_exp_f32 v57, v57
  v_exp_f32 v58, v58
  buffer_load_dwordx4 v2, s[32:35], s54 offen offset:2048 lds
  v_exp_f32 v59, v59
  v_mfma_f32_32x32x16_bf16 v[104:119], v[128:131], v[80:83], v[104:119]
  ds_read_b128 v[128:131], v4 offset:6144
  v_exp_f32 v60, v60
  v_exp_f32 v61, v61
  v_exp_f32 v62, v62
  v_exp_f32 v63, v63
  v_cvt_pk_bf16_f32 v84, v56, v57
  v_cvt_pk_bf16_f32 v85, v58, v59
  v_cvt_pk_bf16_f32 v86, v60, v61
  v_cvt_pk_bf16_f32 v87, v62, v63
  s_waitcnt lgkmcnt(0)
  s_setprio 0
  v_exp_f32 v64, v64
  v_mfma_f32_32x32x16_bf16 v[104:119], v[132:135], v[84:87], v[104:119]
  ds_read_b128 v[132:135], v4 offset:7168
  v_exp_f32 v65, v65
  v_exp_f32 v66, v66
  v_exp_f32 v67, v67
  v_cvt_pk_bf16_f32 v80, v64, v65
  v_mfma_f32_32x32x16_bf16 v[48:63], v[120:123], v[16:19], 0
  v_exp_f32 v68, v68
  v_exp_f32 v69, v69
  v_cvt_pk_bf16_f32 v81, v66, v67
  v_exp_f32 v70, v70
  v_exp_f32 v71, v71
  v_cvt_pk_bf16_f32 v82, v68, v69
  v_mfma_f32_32x32x16_bf16 v[48:63], v[124:127], v[20:23], v[48:63]
  ds_read_b128 v[120:123], v4 offset:12288
  ds_read_b128 v[124:127], v4 offset:13312
  v_exp_f32 v72, v72
  v_cvt_pk_bf16_f32 v83, v70, v71
  v_exp_f32 v73, v73
  v_exp_f32 v74, v74
  buffer_load_dwordx4 v2, s[32:35], s54 offen offset:3072 lds
  v_exp_f32 v75, v75
  v_mfma_f32_32x32x16_bf16 v[104:119], v[128:131], v[80:83], v[104:119]
  ds_read_b128 v[128:131], v4 offset:10240
  v_exp_f32 v76, v76
  v_exp_f32 v77, v77
  v_exp_f32 v78, v78
  v_exp_f32 v79, v79
  v_cvt_pk_bf16_f32 v84, v72, v73
  v_cvt_pk_bf16_f32 v85, v74, v75
  v_cvt_pk_bf16_f32 v86, v76, v77
  v_cvt_pk_bf16_f32 v87, v78, v79
  s_waitcnt vmcnt(4) lgkmcnt(0)
  s_barrier
  s_setprio 3
  v_exp_f32 v48, v48
  v_mfma_f32_32x32x16_bf16 v[104:119], v[132:135], v[84:87], v[104:119]
  ds_read_b128 v[132:135], v4 offset:11264
  v_exp_f32 v49, v49
  v_exp_f32 v50, v50
  v_exp_f32 v51, v51
  v_cvt_pk_bf16_f32 v80, v48, v49
  v_mfma_f32_32x32x16_bf16 v[64:79], v[120:123], v[16:19], 0
  v_exp_f32 v52, v52
  v_exp_f32 v53, v53
  v_cvt_pk_bf16_f32 v81, v50, v51
  v_exp_f32 v54, v54
  v_exp_f32 v55, v55
  v_cvt_pk_bf16_f32 v82, v52, v53
  v_mfma_f32_32x32x16_bf16 v[64:79], v[124:127], v[20:23], v[64:79]
  ds_read_b128 v[120:123], v5 offset:0
  ds_read_b128 v[124:127], v5 offset:1024
  v_exp_f32 v56, v56
  v_cvt_pk_bf16_f32 v83, v54, v55
  v_exp_f32 v57, v57
  v_exp_f32 v58, v58
  s_add_u32 s54, s55, 163840
  s_add_u32 m0, s55, 32768
  s_nop 0
  buffer_load_dwordx4 v2, s[32:35], s54 offen offset:0 lds
  v_exp_f32 v59, v59
  v_mfma_f32_32x32x16_bf16 v[104:119], v[128:131], v[80:83], v[104:119]
  ds_read_b128 v[128:131], v4 offset:14336
  v_exp_f32 v60, v60
  v_exp_f32 v61, v61
  v_exp_f32 v62, v62
  v_exp_f32 v63, v63
  v_cvt_pk_bf16_f32 v84, v56, v57
  v_cvt_pk_bf16_f32 v85, v58, v59
  v_cvt_pk_bf16_f32 v86, v60, v61
  v_cvt_pk_bf16_f32 v87, v62, v63
  s_waitcnt lgkmcnt(0)
  s_setprio 2
  v_exp_f32 v64, v64
  v_mfma_f32_32x32x16_bf16 v[104:119], v[132:135], v[84:87], v[104:119]
  ds_read_b128 v[132:135], v4 offset:15360
  v_exp_f32 v65, v65
  v_exp_f32 v66, v66
  v_exp_f32 v67, v67
  v_cvt_pk_bf16_f32 v80, v64, v65
  v_mfma_f32_32x32x16_bf16 v[48:63], v[120:123], v[16:19], 0
  v_exp_f32 v68, v68
  v_exp_f32 v69, v69
  v_cvt_pk_bf16_f32 v81, v66, v67
  v_exp_f32 v70, v70
  v_exp_f32 v71, v71
  v_cvt_pk_bf16_f32 v82, v68, v69
  v_mfma_f32_32x32x16_bf16 v[48:63], v[124:127], v[20:23], v[48:63]
  ds_read_b128 v[120:123], v5 offset:4096
  ds_read_b128 v[124:127], v5 offset:5120
  v_exp_f32 v72, v72
  v_cvt_pk_bf16_f32 v83, v70, v71
  v_exp_f32 v73, v73
  v_exp_f32 v74, v74
  buffer_load_dwordx4 v2, s[32:35], s54 offen offset:1024 lds
  v_exp_f32 v75, v75
  v_mfma_f32_32x32x16_bf16 v[104:119], v[128:131], v[80:83], v[104:119]
  ds_read_b128 v[128:131], v5 offset:2048
  v_exp_f32 v76, v76
  v_exp_f32 v77, v77
  v_exp_f32 v78, v78
  v_exp_f32 v79, v79
  v_cvt_pk_bf16_f32 v84, v72, v73
  v_cvt_pk_bf16_f32 v85, v74, v75
  v_cvt_pk_bf16_f32 v86, v76, v77
  v_cvt_pk_bf16_f32 v87, v78, v79
  v_mov_b32 v4, v5
  v_add_u32 v5, 32768, v5
  v_and_b32 v5, 0x1ffff, v5
  s_waitcnt lgkmcnt(0)
  s_setprio 1
  v_exp_f32 v48, v48
  v_mfma_f32_32x32x16_bf16 v[104:119], v[132:135], v[84:87], v[104:119]
  ds_read_b128 v[132:135], v4 offset:3072
  v_exp_f32 v49, v49
  v_exp_f32 v50, v50
  v_exp_f32 v51, v51
  v_cvt_pk_bf16_f32 v80, v48, v49
  v_mfma_f32_32x32x16_bf16 v[64:79], v[120:123], v[16:19], 0
  v_exp_f32 v52, v52
  v_exp_f32 v53, v53
  v_cvt_pk_bf16_f32 v81, v50, v51
  v_exp_f32 v54, v54
  v_exp_f32 v55, v55
  v_cvt_pk_bf16_f32 v82, v52, v53
  v_mfma_f32_32x32x16_bf16 v[64:79], v[124:127], v[20:23], v[64:79]
  ds_read_b128 v[120:123], v4 offset:8192
  ds_read_b128 v[124:127], v4 offset:9216
  v_exp_f32 v56, v56
  v_cvt_pk_bf16_f32 v83, v54, v55
  v_exp_f32 v57, v57
  v_exp_f32 v58, v58
  buffer_load_dwordx4 v2, s[32:35], s54 offen offset:2048 lds
  v_exp_f32 v59, v59
  v_mfma_f32_32x32x16_bf16 v[104:119], v[128:131], v[80:83], v[104:119]
  ds_read_b128 v[128:131], v4 offset:6144
  v_exp_f32 v60, v60
  v_exp_f32 v61, v61
  v_exp_f32 v62, v62
  v_exp_f32 v63, v63
  v_cvt_pk_bf16_f32 v84, v56, v57
  v_cvt_pk_bf16_f32 v85, v58, v59
  v_cvt_pk_bf16_f32 v86, v60, v61
  v_cvt_pk_bf16_f32 v87, v62, v63
  s_waitcnt lgkmcnt(0)
  s_setprio 0
  v_exp_f32 v64, v64
  v_mfma_f32_32x32x16_bf16 v[104:119], v[132:135], v[84:87], v[104:119]
  ds_read_b128 v[132:135], v4 offset:7168
  v_exp_f32 v65, v65
  v_exp_f32 v66, v66
  v_exp_f32 v67, v67
  v_cvt_pk_bf16_f32 v80, v64, v65
  v_mfma_f32_32x32x16_bf16 v[48:63], v[120:123], v[16:19], 0
  v_exp_f32 v68, v68
  v_exp_f32 v69, v69
  v_cvt_pk_bf16_f32 v81, v66, v67
  v_exp_f32 v70, v70
  v_exp_f32 v71, v71
  v_cvt_pk_bf16_f32 v82, v68, v69
  v_mfma_f32_32x32x16_bf16 v[48:63], v[124:127], v[20:23], v[48:63]
  ds_read_b128 v[120:123], v4 offset:12288
  ds_read_b128 v[124:127], v4 offset:13312
  v_exp_f32 v72, v72
  v_cvt_pk_bf16_f32 v83, v70, v71
  v_exp_f32 v73, v73
  v_exp_f32 v74, v74
  buffer_load_dwordx4 v2, s[32:35], s54 offen offset:3072 lds
  v_exp_f32 v75, v75
  v_mfma_f32_32x32x16_bf16 v[104:119], v[128:131], v[80:83], v[104:119]
  ds_read_b128 v[128:131], v4 offset:10240
  v_exp_f32 v76, v76
  v_exp_f32 v77, v77
  v_exp_f32 v78, v78
  v_exp_f32 v79, v79
  v_cvt_pk_bf16_f32 v84, v72, v73
  v_cvt_pk_bf16_f32 v85, v74, v75
  v_cvt_pk_bf16_f32 v86, v76, v77
  v_cvt_pk_bf16_f32 v87, v78, v79
  s_waitcnt vmcnt(4) lgkmcnt(0)
  s_barrier
  s_setprio 3
  v_exp_f32 v48, v48
  v_mfma_f32_32x32x16_bf16 v[104:119], v[132:135], v[84:87], v[104:119]
  ds_read_b128 v[132:135], v4 offset:11264
  v_exp_f32 v49, v49
  v_exp_f32 v50, v50
  v_exp_f32 v51, v51
  v_cvt_pk_bf16_f32 v80, v48, v49
  v_mfma_f32_32x32x16_bf16 v[64:79], v[120:123], v[16:19], 0
  v_exp_f32 v52, v52
  v_exp_f32 v53, v53
  v_cvt_pk_bf16_f32 v81, v50, v51
  v_exp_f32 v54, v54
  v_exp_f32 v55, v55
  v_cvt_pk_bf16_f32 v82, v52, v53
  v_mfma_f32_32x32x16_bf16 v[64:79], v[124:127], v[20:23], v[64:79]
  ds_read_b128 v[120:123], v5 offset:0
  ds_read_b128 v[124:127], v5 offset:1024
  v_exp_f32 v56, v56
  v_cvt_pk_bf16_f32 v83, v54, v55
  v_exp_f32 v57, v57
  v_exp_f32 v58, v58
  s_add_u32 s54, s55, 196608
  s_add_u32 m0, s55, 65536
  s_nop 0
  buffer_load_dwordx4 v2, s[32:35], s54 offen offset:0 lds
  v_exp_f32 v59, v59
  v_mfma_f32_32x32x16_bf16 v[104:119], v[128:131], v[80:83], v[104:119]
  ds_read_b128 v[128:131], v4 offset:14336
  v_exp_f32 v60, v60
  v_exp_f32 v61, v61
  v_exp_f32 v62, v62
  v_exp_f32 v63, v63
  v_cvt_pk_bf16_f32 v84, v56, v57
  v_cvt_pk_bf16_f32 v85, v58, v59
  v_cvt_pk_bf16_f32 v86, v60, v61
  v_cvt_pk_bf16_f32 v87, v62, v63
  s_waitcnt lgkmcnt(0)
  s_setprio 2
  v_exp_f32 v64, v64
  v_mfma_f32_32x32x16_bf16 v[104:119], v[132:135], v[84:87], v[104:119]
  ds_read_b128 v[132:135], v4 offset:15360
  v_exp_f32 v65, v65
  v_exp_f32 v66, v66
  v_exp_f32 v67, v67
  v_cvt_pk_bf16_f32 v80, v64, v65
  v_mfma_f32_32x32x16_bf16 v[48:63], v[120:123], v[16:19], 0
  v_exp_f32 v68, v68
  v_exp_f32 v69, v69
  v_cvt_pk_bf16_f32 v81, v66, v67
  v_exp_f32 v70, v70
  v_exp_f32 v71, v71
  v_cvt_pk_bf16_f32 v82, v68, v69
  v_mfma_f32_32x32x16_bf16 v[48:63], v[124:127], v[20:23], v[48:63]
  ds_read_b128 v[120:123], v5 offset:4096
  ds_read_b128 v[124:127], v5 offset:5120
  v_exp_f32 v72, v72
  v_cvt_pk_bf16_f32 v83, v70, v71
  v_exp_f32 v73, v73
  v_exp_f32 v74, v74
  buffer_load_dwordx4 v2, s[32:35], s54 offen offset:1024 lds
  v_exp_f32 v75, v75
  v_mfma_f32_32x32x16_bf16 v[104:119], v[128:131], v[80:83], v[104:119]
  ds_read_b128 v[128:131], v5 offset:2048
  v_exp_f32 v76, v76
  v_exp_f32 v77, v77
  v_exp_f32 v78, v78
  v_exp_f32 v79, v79
  v_cvt_pk_bf16_f32 v84, v72, v73
  v_cvt_pk_bf16_f32 v85, v74, v75
  v_cvt_pk_bf16_f32 v86, v76, v77
  v_cvt_pk_bf16_f32 v87, v78, v79
  v_mov_b32 v4, v5
  v_add_u32 v5, 32768, v5
  v_and_b32 v5, 0x1ffff, v5
  s_waitcnt lgkmcnt(0)
  s_setprio 1
  v_exp_f32 v48, v48
  v_mfma_f32_32x32x16_bf16 v[104:119], v[132:135], v[84:87], v[104:119]
  ds_read_b128 v[132:135], v4 offset:3072
  v_exp_f32 v49, v49
  v_exp_f32 v50, v50
  v_exp_f32 v51, v51
  v_cvt_pk_bf16_f32 v80, v48, v49
  v_mfma_f32_32x32x16_bf16 v[64:79], v[120:123], v[16:19], 0
  v_exp_f32 v52, v52
  v_exp_f32 v53, v53
  v_cvt_pk_bf16_f32 v81, v50, v51
  v_exp_f32 v54, v54
  v_exp_f32 v55, v55
  v_cvt_pk_bf16_f32 v82, v52, v53
  v_mfma_f32_32x32x16_bf16 v[64:79], v[124:127], v[20:23], v[64:79]
  ds_read_b128 v[120:123], v4 offset:8192
  ds_read_b128 v[124:127], v4 offset:9216
  v_exp_f32 v56, v56
  v_cvt_pk_bf16_f32 v83, v54, v55
  v_exp_f32 v57, v57
  v_exp_f32 v58, v58
  buffer_load_dwordx4 v2, s[32:35], s54 offen offset:2048 lds
  v_exp_f32 v59, v59
  v_mfma_f32_32x32x16_bf16 v[104:119], v[128:131], v[80:83], v[104:119]
  ds_read_b128 v[128:131], v4 offset:6144
  v_exp_f32 v60, v60
  v_exp_f32 v61, v61
  v_exp_f32 v62, v62
  v_exp_f32 v63, v63
  v_cvt_pk_bf16_f32 v84, v56, v57
  v_cvt_pk_bf16_f32 v85, v58, v59
  v_cvt_pk_bf16_f32 v86, v60, v61
  v_cvt_pk_bf16_f32 v87, v62, v63
  s_waitcnt lgkmcnt(0)
  s_setprio 0
  v_exp_f32 v64, v64
  v_mfma_f32_32x32x16_bf16 v[104:119], v[132:135], v[84:87], v[104:119]
  ds_read_b128 v[132:135], v4 offset:7168
  v_exp_f32 v65, v65
  v_exp_f32 v66, v66
  v_exp_f32 v67, v67
  v_cvt_pk_bf16_f32 v80, v64, v65
  v_mfma_f32_32x32x16_bf16 v[48:63], v[120:123], v[16:19], 0
  v_exp_f32 v68, v68
  v_exp_f32 v69, v69
  v_cvt_pk_bf16_f32 v81, v66, v67
  v_exp_f32 v70, v70
  v_exp_f32 v71, v71
  v_cvt_pk_bf16_f32 v82, v68, v69
  v_mfma_f32_32x32x16_bf16 v[48:63], v[124:127], v[20:23], v[48:63]
  ds_read_b128 v[120:123], v4 offset:12288
  ds_read_b128 v[124:127], v4 offset:13312
  v_exp_f32 v72, v72
  v_cvt_pk_bf16_f32 v83, v70, v71
  v_exp_f32 v73, v73
  v_exp_f32 v74, v74
  buffer_load_dwordx4 v2, s[32:35], s54 offen offset:3072 lds
  v_exp_f32 v75, v75
  v_mfma_f32_32x32x16_bf16 v[104:119], v[128:131], v[80:83], v[104:119]
  ds_read_b128 v[128:131], v4 offset:10240
  v_exp_f32 v76, v76
  v_exp_f32 v77, v77
  v_exp_f32 v78, v78
  v_exp_f32 v79, v79
  v_cvt_pk_bf16_f32 v84, v72, v73
  v_cvt_pk_bf16_f32 v85, v74, v75
  v_cvt_pk_bf16_f32 v86, v76, v77
  v_cvt_pk_bf16_f32 v87, v78, v79
  s_waitcnt vmcnt(4) lgkmcnt(0)
  s_barrier
  s_setprio 3
  v_exp_f32 v48, v48
  v_mfma_f32_32x32x16_bf16 v[104:119], v[132:135], v[84:87], v[104:119]
  ds_read_b128 v[132:135], v4 offset:11264
  v_exp_f32 v49, v49
  v_exp_f32 v50, v50
  v_exp_f32 v51, v51
  v_cvt_pk_bf16_f32 v80, v48, v49
  v_mfma_f32_32x32x16_bf16 v[64:79], v[120:123], v[16:19], 0
  v_exp_f32 v52, v52
  v_exp_f32 v53, v53
  v_cvt_pk_bf16_f32 v81, v50, v51
  v_exp_f32 v54, v54
  v_exp_f32 v55, v55
  v_cvt_pk_bf16_f32 v82, v52, v53
  v_mfma_f32_32x32x16_bf16 v[64:79], v[124:127], v[20:23], v[64:79]
  ds_read_b128 v[120:123], v5 offset:0
  ds_read_b128 v[124:127], v5 offset:1024
  v_exp_f32 v56, v56
  v_cvt_pk_bf16_f32 v83, v54, v55
  v_exp_f32 v57, v57
  v_exp_f32 v58, v58
  buffer_load_dword v201, v31, s[64:67], 0 offen sc1
  s_add_u32 s54, s55, 229376
  s_add_u32 m0, s55, 98304
  s_nop 0
  buffer_load_dwordx4 v2, s[32:35], s54 offen offset:0 lds
  v_exp_f32 v59, v59
  v_mfma_f32_32x32x16_bf16 v[104:119], v[128:131], v[80:83], v[104:119]
  ds_read_b128 v[128:131], v4 offset:14336
  v_exp_f32 v60, v60
  v_exp_f32 v61, v61
  v_exp_f32 v62, v62
  v_exp_f32 v63, v63
  v_cvt_pk_bf16_f32 v84, v56, v57
  v_cvt_pk_bf16_f32 v85, v58, v59
  v_cvt_pk_bf16_f32 v86, v60, v61
  v_cvt_pk_bf16_f32 v87, v62, v63
  s_waitcnt lgkmcnt(0)
  s_setprio 2
  v_exp_f32 v64, v64
  v_mfma_f32_32x32x16_bf16 v[104:119], v[132:135], v[84:87], v[104:119]
  ds_read_b128 v[132:135], v4 offset:15360
  v_exp_f32 v65, v65
  v_exp_f32 v66, v66
  v_exp_f32 v67, v67
  v_cvt_pk_bf16_f32 v80, v64, v65
  v_mfma_f32_32x32x16_bf16 v[48:63], v[120:123], v[16:19], 0
  v_exp_f32 v68, v68
  v_exp_f32 v69, v69
  v_cvt_pk_bf16_f32 v81, v66, v67
  v_exp_f32 v70, v70
  v_exp_f32 v71, v71
  v_cvt_pk_bf16_f32 v82, v68, v69
  v_mfma_f32_32x32x16_bf16 v[48:63], v[124:127], v[20:23], v[48:63]
  ds_read_b128 v[120:123], v5 offset:4096
  ds_read_b128 v[124:127], v5 offset:5120
  v_exp_f32 v72, v72
  v_cvt_pk_bf16_f32 v83, v70, v71
  v_exp_f32 v73, v73
  v_exp_f32 v74, v74
  buffer_load_dwordx4 v2, s[32:35], s54 offen offset:1024 lds
  v_exp_f32 v75, v75
  v_mfma_f32_32x32x16_bf16 v[104:119], v[128:131], v[80:83], v[104:119]
  ds_read_b128 v[128:131], v5 offset:2048
  v_exp_f32 v76, v76
  v_exp_f32 v77, v77
  v_exp_f32 v78, v78
  v_exp_f32 v79, v79
  v_cvt_pk_bf16_f32 v84, v72, v73
  v_cvt_pk_bf16_f32 v85, v74, v75
  v_cvt_pk_bf16_f32 v86, v76, v77
  v_cvt_pk_bf16_f32 v87, v78, v79
  v_mov_b32 v4, v5
  v_add_u32 v5, 32768, v5
  v_and_b32 v5, 0x1ffff, v5
  s_waitcnt lgkmcnt(0)
  s_setprio 1
  v_exp_f32 v48, v48
  v_mfma_f32_32x32x16_bf16 v[104:119], v[132:135], v[84:87], v[104:119]
  ds_read_b128 v[132:135], v4 offset:3072
  v_exp_f32 v49, v49
  v_exp_f32 v50, v50
  v_exp_f32 v51, v51
  v_cvt_pk_bf16_f32 v80, v48, v49
  v_mfma_f32_32x32x16_bf16 v[64:79], v[120:123], v[16:19], 0
  v_exp_f32 v52, v52
  v_exp_f32 v53, v53
  v_cvt_pk_bf16_f32 v81, v50, v51
  v_exp_f32 v54, v54
  v_exp_f32 v55, v55
  v_cvt_pk_bf16_f32 v82, v52, v53
  v_mfma_f32_32x32x16_bf16 v[64:79], v[124:127], v[20:23], v[64:79]
  ds_read_b128 v[120:123], v4 offset:8192
  ds_read_b128 v[124:127], v4 offset:9216
  v_exp_f32 v56, v56
  v_cvt_pk_bf16_f32 v83, v54, v55
  v_exp_f32 v57, v57
  v_exp_f32 v58, v58
  buffer_load_dwordx4 v2, s[32:35], s54 offen offset:2048 lds
  v_exp_f32 v59, v59
  v_mfma_f32_32x32x16_bf16 v[104:119], v[128:131], v[80:83], v[104:119]
  ds_read_b128 v[128:131], v4 offset:6144
  v_exp_f32 v60, v60
  v_exp_f32 v61, v61
  v_exp_f32 v62, v62
  v_exp_f32 v63, v63
  v_cvt_pk_bf16_f32 v84, v56, v57
  v_cvt_pk_bf16_f32 v85, v58, v59
  v_cvt_pk_bf16_f32 v86, v60, v61
  v_cvt_pk_bf16_f32 v87, v62, v63
  s_waitcnt lgkmcnt(0)
  s_setprio 0
  v_exp_f32 v64, v64
  v_mfma_f32_32x32x16_bf16 v[104:119], v[132:135], v[84:87], v[104:119]
  ds_read_b128 v[132:135], v4 offset:7168
  v_exp_f32 v65, v65
  v_exp_f32 v66, v66
  v_exp_f32 v67, v67
  v_cvt_pk_bf16_f32 v80, v64, v65
  v_mfma_f32_32x32x16_bf16 v[48:63], v[120:123], v[16:19], 0
  v_exp_f32 v68, v68
  v_exp_f32 v69, v69
  v_cvt_pk_bf16_f32 v81, v66, v67
  v_exp_f32 v70, v70
  v_exp_f32 v71, v71
  v_cvt_pk_bf16_f32 v82, v68, v69
  v_mfma_f32_32x32x16_bf16 v[48:63], v[124:127], v[20:23], v[48:63]
  ds_read_b128 v[120:123], v4 offset:12288
  ds_read_b128 v[124:127], v4 offset:13312
  v_exp_f32 v72, v72
  v_cvt_pk_bf16_f32 v83, v70, v71
  v_exp_f32 v73, v73
  v_exp_f32 v74, v74
  buffer_load_dwordx4 v2, s[32:35], s54 offen offset:3072 lds
  v_exp_f32 v75, v75
  v_mfma_f32_32x32x16_bf16 v[104:119], v[128:131], v[80:83], v[104:119]
  ds_read_b128 v[128:131], v4 offset:10240
  v_exp_f32 v76, v76
  v_exp_f32 v77, v77
  v_exp_f32 v78, v78
  v_exp_f32 v79, v79
  v_cvt_pk_bf16_f32 v84, v72, v73
  v_cvt_pk_bf16_f32 v85, v74, v75
  v_cvt_pk_bf16_f32 v86, v76, v77
  v_cvt_pk_bf16_f32 v87, v78, v79
  s_waitcnt vmcnt(4) lgkmcnt(0)
  s_barrier
  s_setprio 3
  v_exp_f32 v48, v48
  v_mfma_f32_32x32x16_bf16 v[104:119], v[132:135], v[84:87], v[104:119]
  ds_read_b128 v[132:135], v4 offset:11264
  v_exp_f32 v49, v49
  v_exp_f32 v50, v50
  v_exp_f32 v51, v51
  v_cvt_pk_bf16_f32 v80, v48, v49
  v_mfma_f32_32x32x16_bf16 v[64:79], v[120:123], v[16:19], 0
  v_exp_f32 v52, v52
  v_exp_f32 v53, v53
  v_cvt_pk_bf16_f32 v81, v50, v51
  v_exp_f32 v54, v54
  v_exp_f32 v55, v55
  v_cvt_pk_bf16_f32 v82, v52, v53
  v_mfma_f32_32x32x16_bf16 v[64:79], v[124:127], v[20:23], v[64:79]
  ds_read_b128 v[120:123], v5 offset:0
  ds_read_b128 v[124:127], v5 offset:1024
  v_exp_f32 v56, v56
  v_cvt_pk_bf16_f32 v83, v54, v55
  v_exp_f32 v57, v57
  v_exp_f32 v58, v58
  v_cmp_ne_u32 vcc, 16, v201
  s_nop 4
  s_cbranch_vccz Laok_40
  s_mov_b32 s68, 200000
Lpoll_41:
  buffer_load_dword v201, v31, s[64:67], 0 offen sc1
  s_waitcnt vmcnt(0)
  v_cmp_ne_u32 vcc, 16, v201
  s_nop 4
  s_cbranch_vccz Lpdone_42
  s_sleep 1
  s_sub_u32 s68, s68, 1
  s_cmp_lg_u32 s68, 0
  s_cbranch_scc1 Lpoll_41
Lpdone_42:
Laok_40:
  s_mov_b32 m0, s55
  s_nop 0
  buffer_load_dwordx4 v28, s[28:31], 0 offen offset:0 lds
  v_exp_f32 v59, v59
  v_mfma_f32_32x32x16_bf16 v[104:119], v[128:131], v[80:83], v[104:119]
  ds_read_b128 v[128:131], v4 offset:14336
  v_exp_f32 v60, v60
  v_exp_f32 v61, v61
  v_exp_f32 v62, v62
  v_exp_f32 v63, v63
  v_cvt_pk_bf16_f32 v84, v56, v57
  v_cvt_pk_bf16_f32 v85, v58, v59
  v_cvt_pk_bf16_f32 v86, v60, v61
  v_cvt_pk_bf16_f32 v87, v62, v63
  s_waitcnt lgkmcnt(0)
  s_setprio 2
  v_exp_f32 v64, v64
  v_mfma_f32_32x32x16_bf16 v[104:119], v[132:135], v[84:87], v[104:119]
  ds_read_b128 v[132:135], v4 offset:15360
  v_exp_f32 v65, v65
  v_exp_f32 v66, v66
  v_exp_f32 v67, v67
  v_cvt_pk_bf16_f32 v80, v64, v65
  v_mfma_f32_32x32x16_bf16 v[48:63], v[120:123], v[16:19], 0
  v_exp_f32 v68, v68
  v_exp_f32 v69, v69
  v_cvt_pk_bf16_f32 v81, v66, v67
  v_exp_f32 v70, v70
  v_exp_f32 v71, v71
  v_cvt_pk_bf16_f32 v82, v68, v69
  v_mfma_f32_32x32x16_bf16 v[48:63], v[124:127], v[20:23], v[48:63]
  ds_read_b128 v[120:123], v5 offset:4096
  ds_read_b128 v[124:127], v5 offset:5120
  v_exp_f32 v72, v72
  v_cvt_pk_bf16_f32 v83, v70, v71
  v_exp_f32 v73, v73
  v_exp_f32 v74, v74
  buffer_load_dwordx4 v28, s[28:31], 0 offen offset:1024 lds
  v_exp_f32 v75, v75
  v_mfma_f32_32x32x16_bf16 v[104:119], v[128:131], v[80:83], v[104:119]
  ds_read_b128 v[128:131], v5 offset:2048
  v_exp_f32 v76, v76
  v_exp_f32 v77, v77
  v_exp_f32 v78, v78
  v_exp_f32 v79, v79
  v_cvt_pk_bf16_f32 v84, v72, v73
  v_cvt_pk_bf16_f32 v85, v74, v75
  v_cvt_pk_bf16_f32 v86, v76, v77
  v_cvt_pk_bf16_f32 v87, v78, v79
  v_mov_b32 v4, v5
  v_add_u32 v5, 32768, v5
  v_and_b32 v5, 0x1ffff, v5
  s_waitcnt lgkmcnt(0)
  s_setprio 1
  v_exp_f32 v48, v48
  v_mfma_f32_32x32x16_bf16 v[104:119], v[132:135], v[84:87], v[104:119]
  ds_read_b128 v[132:135], v4 offset:3072
  v_exp_f32 v49, v49
  v_exp_f32 v50, v50
  v_exp_f32 v51, v51
  v_cvt_pk_bf16_f32 v80, v48, v49
  v_mfma_f32_32x32x16_bf16 v[64:79], v[120:123], v[16:19], 0
  v_exp_f32 v52, v52
  v_exp_f32 v53, v53
  v_cvt_pk_bf16_f32 v81, v50, v51
  v_exp_f32 v54, v54
  v_exp_f32 v55, v55
  v_cvt_pk_bf16_f32 v82, v52, v53
  v_mfma_f32_32x32x16_bf16 v[64:79], v[124:127], v[20:23], v[64:79]
  ds_read_b128 v[120:123], v4 offset:8192
  ds_read_b128 v[124:127], v4 offset:9216
  v_exp_f32 v56, v56
  v_cvt_pk_bf16_f32 v83, v54, v55
  v_exp_f32 v57, v57
  v_exp_f32 v58, v58
  buffer_load_dwordx4 v28, s[28:31], 0 offen offset:2048 lds
  v_exp_f32 v59, v59
  v_mfma_f32_32x32x16_bf16 v[104:119], v[128:131], v[80:83], v[104:119]
  ds_read_b128 v[128:131], v4 offset:6144
  v_exp_f32 v60, v60
  v_exp_f32 v61, v61
  v_exp_f32 v62, v62
  v_exp_f32 v63, v63
  v_cvt_pk_bf16_f32 v84, v56, v57
  v_cvt_pk_bf16_f32 v85, v58, v59
  v_cvt_pk_bf16_f32 v86, v60, v61
  v_cvt_pk_bf16_f32 v87, v62, v63
  s_waitcnt lgkmcnt(0)
  s_setprio 0
  v_exp_f32 v64, v64
  v_mfma_f32_32x32x16_bf16 v[104:119], v[132:135], v[84:87], v[104:119]
  ds_read_b128 v[132:135], v4 offset:7168
  v_exp_f32 v65, v65
  v_exp_f32 v66, v66
  v_exp_f32 v67, v67
  v_cvt_pk_bf16_f32 v80, v64, v65
  v_mfma_f32_32x32x16_bf16 v[48:63], v[120:123], v[16:19], 0
  v_exp_f32 v68, v68
  v_exp_f32 v69, v69
  v_cvt_pk_bf16_f32 v81, v66, v67
  v_exp_f32 v70, v70
  v_exp_f32 v71, v71
  v_cvt_pk_bf16_f32 v82, v68, v69
  v_mfma_f32_32x32x16_bf16 v[48:63], v[124:127], v[20:23], v[48:63]
  ds_read_b128 v[120:123], v4 offset:12288
  ds_read_b128 v[124:127], v4 offset:13312
  v_exp_f32 v72, v72
  v_cvt_pk_bf16_f32 v83, v70, v71
  v_exp_f32 v73, v73
  v_exp_f32 v74, v74
  buffer_load_dwordx4 v28, s[28:31], 0 offen offset:3072 lds
  v_exp_f32 v75, v75
  v_mfma_f32_32x32x16_bf16 v[104:119], v[128:131], v[80:83], v[104:119]
  ds_read_b128 v[128:131], v4 offset:10240
  v_exp_f32 v76, v76
  v_exp_f32 v77, v77
  v_exp_f32 v78, v78
  v_exp_f32 v79, v79
  v_cvt_pk_bf16_f32 v84, v72, v73
  v_cvt_pk_bf16_f32 v85, v74, v75
  v_cvt_pk_bf16_f32 v86, v76, v77
  v_cvt_pk_bf16_f32 v87, v78, v79
  s_waitcnt vmcnt(4) lgkmcnt(0)
  s_barrier
  ds_read_b128 v[8:11], v200 offset:8192
  ds_read_b128 v[12:15], v200 offset:9216
  s_setprio 3
  v_exp_f32 v48, v48
  v_mfma_f32_32x32x16_bf16 v[104:119], v[132:135], v[84:87], v[104:119]
  ds_read_b128 v[132:135], v4 offset:11264
  v_exp_f32 v49, v49
  v_exp_f32 v50, v50
  v_exp_f32 v51, v51
  v_cvt_pk_bf16_f32 v80, v48, v49
  v_mfma_f32_32x32x16_bf16 v[64:79], v[120:123], v[16:19], 0
  v_exp_f32 v52, v52
  v_exp_f32 v53, v53
  v_cvt_pk_bf16_f32 v81, v50, v51
  v_exp_f32 v54, v54
  v_exp_f32 v55, v55
  v_cvt_pk_bf16_f32 v82, v52, v53
  v_mfma_f32_32x32x16_bf16 v[64:79], v[124:127], v[20:23], v[64:79]
  ds_read_b128 v[120:123], v5 offset:0
  ds_read_b128 v[124:127], v5 offset:1024
  v_exp_f32 v56, v56
  v_cvt_pk_bf16_f32 v83, v54, v55
  v_exp_f32 v57, v57
  v_exp_f32 v58, v58
  s_add_u32 m0, s55, 32768
  s_nop 0
  buffer_load_dwordx4 v29, s[28:31], 0 offen offset:0 lds
  buffer_load_dwordx4 v29, s[28:31], 0 offen offset:1024 lds
  v_exp_f32 v59, v59
  v_mfma_f32_32x32x16_bf16 v[104:119], v[128:131], v[80:83], v[104:119]
  ds_read_b128 v[128:131], v4 offset:14336
  v_exp_f32 v60, v60
  v_exp_f32 v61, v61
  v_exp_f32 v62, v62
  v_exp_f32 v63, v63
  v_cvt_pk_bf16_f32 v84, v56, v57
  v_cvt_pk_bf16_f32 v85, v58, v59
  v_cvt_pk_bf16_f32 v86, v60, v61
  v_cvt_pk_bf16_f32 v87, v62, v63
  s_waitcnt lgkmcnt(0)
  s_setprio 2
  v_exp_f32 v64, v64
  v_mfma_f32_32x32x16_bf16 v[104:119], v[132:135], v[84:87], v[104:119]
  ds_read_b128 v[132:135], v4 offset:15360
  v_exp_f32 v65, v65
  v_exp_f32 v66, v66
  v_exp_f32 v67, v67
  v_cvt_pk_bf16_f32 v80, v64, v65
  v_mfma_f32_32x32x16_bf16 v[48:63], v[120:123], v[16:19], 0
  v_exp_f32 v68, v68
  v_exp_f32 v69, v69
  v_cvt_pk_bf16_f32 v81, v66, v67
  v_exp_f32 v70, v70
  v_exp_f32 v71, v71
  v_cvt_pk_bf16_f32 v82, v68, v69
  v_mfma_f32_32x32x16_bf16 v[48:63], v[124:127], v[20:23], v[48:63]
  ds_read_b128 v[120:123], v5 offset:4096
  ds_read_b128 v[124:127], v5 offset:5120
  v_exp_f32 v72, v72
  v_cvt_pk_bf16_f32 v83, v70, v71
  v_exp_f32 v73, v73
  v_exp_f32 v74, v74
  buffer_load_dwordx4 v29, s[28:31], 0 offen offset:2048 lds
  buffer_load_dwordx4 v29, s[28:31], 0 offen offset:3072 lds
  v_exp_f32 v75, v75
  v_mfma_f32_32x32x16_bf16 v[104:119], v[128:131], v[80:83], v[104:119]
  ds_read_b128 v[128:131], v5 offset:2048
  v_exp_f32 v76, v76
  v_exp_f32 v77, v77
  v_exp_f32 v78, v78
  v_exp_f32 v79, v79
  v_cvt_pk_bf16_f32 v84, v72, v73
  v_cvt_pk_bf16_f32 v85, v74, v75
  v_cvt_pk_bf16_f32 v86, v76, v77
  v_cvt_pk_bf16_f32 v87, v78, v79
  v_mov_b32 v4, v5
  v_add_u32 v5, 32768, v5
  v_and_b32 v5, 0x1ffff, v5
  s_waitcnt lgkmcnt(0)
  s_setprio 1
  v_exp_f32 v48, v48
  v_mfma_f32_32x32x16_bf16 v[104:119], v[132:135], v[84:87], v[104:119]
  ds_read_b128 v[132:135], v4 offset:3072
  v_exp_f32 v49, v49
  v_exp_f32 v50, v50
  v_exp_f32 v51, v51
  v_cvt_pk_bf16_f32 v80, v48, v49
  v_mfma_f32_32x32x16_bf16 v[64:79], v[120:123], v[16:19], 0
  v_exp_f32 v52, v52
  v_exp_f32 v53, v53
  v_cvt_pk_bf16_f32 v81, v50, v51
  v_exp_f32 v54, v54
  v_exp_f32 v55, v55
  v_cvt_pk_bf16_f32 v82, v52, v53
  v_mfma_f32_32x32x16_bf16 v[64:79], v[124:127], v[20:23], v[64:79]
  ds_read_b128 v[120:123], v4 offset:8192
  ds_read_b128 v[124:127], v4 offset:9216
  v_exp_f32 v56, v56
  v_cvt_pk_bf16_f32 v83, v54, v55
  v_exp_f32 v57, v57
  v_exp_f32 v58, v58
  v_exp_f32 v59, v59
  v_mfma_f32_32x32x16_bf16 v[104:119], v[128:131], v[80:83], v[104:119]
  ds_read_b128 v[128:131], v4 offset:6144
  v_exp_f32 v60, v60
  v_exp_f32 v61, v61
  v_exp_f32 v62, v62
  v_exp_f32 v63, v63
  v_cvt_pk_bf16_f32 v84, v56, v57
  v_cvt_pk_bf16_f32 v85, v58, v59
  v_cvt_pk_bf16_f32 v86, v60, v61
  v_cvt_pk_bf16_f32 v87, v62, v63
  s_waitcnt lgkmcnt(0)
  s_setprio 0
  v_exp_f32 v64, v64
  v_mfma_f32_32x32x16_bf16 v[104:119], v[132:135], v[84:87], v[104:119]
  ds_read_b128 v[132:135], v4 offset:7168
  v_exp_f32 v65, v65
  v_exp_f32 v66, v66
  v_exp_f32 v67, v67
  v_cvt_pk_bf16_f32 v80, v64, v65
  v_mfma_f32_32x32x16_bf16 v[48:63], v[120:123], v[16:19], 0
  v_exp_f32 v68, v68
  v_exp_f32 v69, v69
  v_cvt_pk_bf16_f32 v81, v66, v67
  v_exp_f32 v70, v70
  v_exp_f32 v71, v71
  v_cvt_pk_bf16_f32 v82, v68, v69
  v_mfma_f32_32x32x16_bf16 v[48:63], v[124:127], v[20:23], v[48:63]
  ds_read_b128 v[120:123], v4 offset:12288
  ds_read_b128 v[124:127], v4 offset:13312
  v_exp_f32 v72, v72
  v_cvt_pk_bf16_f32 v83, v70, v71
  v_exp_f32 v73, v73
  v_exp_f32 v74, v74
  v_exp_f32 v75, v75
  v_mfma_f32_32x32x16_bf16 v[104:119], v[128:131], v[80:83], v[104:119]
  ds_read_b128 v[128:131], v4 offset:10240
  v_exp_f32 v76, v76
  v_exp_f32 v77, v77
  v_exp_f32 v78, v78
  v_exp_f32 v79, v79
  v_cvt_pk_bf16_f32 v84, v72, v73
  v_cvt_pk_bf16_f32 v85, v74, v75
  v_cvt_pk_bf16_f32 v86, v76, v77
  v_cvt_pk_bf16_f32 v87, v78, v79
  s_waitcnt vmcnt(0) lgkmcnt(0)
  s_barrier
  v_mov_b32 v204, 65472
  v_mov_b32 v205, 0
  ds_write_b32 v204, v205
  ds_write_b32 v204, v205 offset:4
  ds_read_b128 v[144:147], v3 offset:32768
  ds_read_b128 v[148:151], v3 offset:33792
  s_waitcnt lgkmcnt(0)
  v_mfma_f32_32x32x16_bf16 v[152:167], v[144:147], v[8:11], v[32:47]
  v_mfma_f32_32x32x16_bf16 v[152:167], v[148:151], v[12:15], v[152:167]
  s_nop 15
  v_max3_f32 v136, v152, v153, v154
  v_max3_f32 v136, v136, v155, v156
  v_max3_f32 v136, v136, v157, v158
  v_max3_f32 v136, v136, v159, v160
  v_max3_f32 v136, v136, v161, v162
  v_max3_f32 v136, v136, v163, v164
  v_max3_f32 v136, v136, v165, v166
  v_max_f32 v136, v136, v167
  v_mov_b32 v137, v136
  s_nop 1
  v_permlane32_swap_b32 v136, v137
  s_nop 1
  v_max_f32 v136, v136, v137
  v_sub_f32 v136, 0, v136
  v_cvt_pk_bf16_f32 v136, v136, 0
  v_lshlrev_b32 v26, 16, v136
  s_mov_b64 exec, s[60:61]
  v_mov_b32 v14, v136
  s_mov_b64 exec, -1
  s_setprio 3
  v_exp_f32 v48, v48
  v_mfma_f32_32x32x16_bf16 v[104:119], v[132:135], v[84:87], v[104:119]
  ds_read_b128 v[132:135], v4 offset:11264
  v_exp_f32 v49, v49
  v_exp_f32 v50, v50
  v_exp_f32 v51, v51
  v_cvt_pk_bf16_f32 v80, v48, v49
  v_mfma_f32_32x32x16_bf16 v[64:79], v[120:123], v[16:19], 0
  v_exp_f32 v52, v52
  v_exp_f32 v53, v53
  v_cvt_pk_bf16_f32 v81, v50, v51
  v_exp_f32 v54, v54
  v_exp_f32 v55, v55
  v_cvt_pk_bf16_f32 v82, v52, v53
  v_mfma_f32_32x32x16_bf16 v[64:79], v[124:127], v[20:23], v[64:79]
  ds_read_b128 v[120:123], v3 offset:32768
  ds_read_b128 v[124:127], v3 offset:33792
  v_exp_f32 v56, v56
  v_cvt_pk_bf16_f32 v83, v54, v55
  v_exp_f32 v57, v57
  v_exp_f32 v58, v58
  s_mov_b32 s56, s14
  s_mov_b32 s57, s15
  s_mov_b32 s58, 401408
  s_mov_b32 s59, 0x20000
  v_lshrrev_b32 v30, 3, v0
  v_and_b32 v31, 7, v0
  v_and_b32 v1, 2, v30
  v_lshlrev_b32 v1, 1, v1
  v_xor_b32 v31, v31, v1
  s_lshl_b32 s50, s3, 3
  v_add_u32 v30, s50, v30
  v_mul_u32_u24 v30, 896, v30
  v_lshl_add_u32 v30, v31, 4, v30
  s_lshr_b32 s50, s2, 5
  s_lshl_b32 s50, s50, 7
  s_cmp_ge_u32 s2, 224
  s_cselect_b32 s50, 0x40000000, s50
  v_add_u32 v30, s50, v30
  s_lshl_b32 s45, s3, 10
  s_add_u32 m0, s45, 65536
  s_mov_b32 s50, 0
  buffer_load_dwordx4 v30, s[56:59], s50 offen lds
  v_exp_f32 v59, v59
  v_mfma_f32_32x32x16_bf16 v[104:119], v[128:131], v[80:83], v[104:119]
  ds_read_b128 v[128:131], v4 offset:14336
  v_exp_f32 v60, v60
  v_exp_f32 v61, v61
  v_exp_f32 v62, v62
  v_exp_f32 v63, v63
  v_cvt_pk_bf16_f32 v84, v56, v57
  v_cvt_pk_bf16_f32 v85, v58, v59
  v_cvt_pk_bf16_f32 v86, v60, v61
  v_cvt_pk_bf16_f32 v87, v62, v63
  s_waitcnt lgkmcnt(0)
  s_setprio 2
  v_exp_f32 v64, v64
  v_mfma_f32_32x32x16_bf16 v[104:119], v[132:135], v[84:87], v[104:119]
  ds_read_b128 v[132:135], v4 offset:15360
  v_exp_f32 v65, v65
  v_exp_f32 v66, v66
  v_exp_f32 v67, v67
  v_cvt_pk_bf16_f32 v80, v64, v65
  v_mfma_f32_32x32x16_bf16 v[48:63], v[120:123], v[8:11], v[32:47]
  v_exp_f32 v68, v68
  v_exp_f32 v69, v69
  v_cvt_pk_bf16_f32 v81, v66, v67
  v_exp_f32 v70, v70
  v_exp_f32 v71, v71
  v_cvt_pk_bf16_f32 v82, v68, v69
  v_mfma_f32_32x32x16_bf16 v[48:63], v[124:127], v[12:15], v[48:63]
  ds_read_b128 v[120:123], v3 offset:28672
  ds_read_b128 v[124:127], v3 offset:29696
  v_exp_f32 v72, v72
  v_cvt_pk_bf16_f32 v83, v70, v71
  v_exp_f32 v73, v73
  v_exp_f32 v74, v74
  s_add_u32 m0, s45, 73728
  s_mov_b32 s50, 57344
  buffer_load_dwordx4 v30, s[56:59], s50 offen lds
  v_exp_f32 v75, v75
  v_mfma_f32_32x32x16_bf16 v[104:119], v[128:131], v[80:83], v[104:119]
  ds_read_b128 v[128:131], v3 offset:34816
  v_exp_f32 v76, v76
  v_exp_f32 v77, v77
  v_exp_f32 v78, v78
  v_exp_f32 v79, v79
  v_cvt_pk_bf16_f32 v84, v72, v73
  v_cvt_pk_bf16_f32 v85, v74, v75
  v_cvt_pk_bf16_f32 v86, v76, v77
  v_cvt_pk_bf16_f32 v87, v78, v79
  s_waitcnt lgkmcnt(0)
  s_setprio 1
  v_exp_f32 v48, v48
  v_mfma_f32_32x32x16_bf16 v[104:119], v[132:135], v[84:87], v[104:119]
  ds_read_b128 v[132:135], v3 offset:35840
  v_exp_f32 v49, v49
  v_exp_f32 v50, v50
  v_exp_f32 v51, v51
  v_cvt_pk_bf16_f32 v80, v48, v49
  v_mfma_f32_32x32x16_bf16 v[64:79], v[120:123], v[8:11], 0
  v_exp_f32 v52, v52
  v_exp_f32 v53, v53
  v_cvt_pk_bf16_f32 v81, v50, v51
  v_exp_f32 v54, v54
  v_exp_f32 v55, v55
  v_cvt_pk_bf16_f32 v82, v52, v53
  v_mfma_f32_32x32x16_bf16 v[64:79], v[124:127], v[12:15], v[64:79]
  ds_read_b128 v[120:123], v3 offset:24576
  ds_read_b128 v[124:127], v3 offset:25600
  v_exp_f32 v56, v56
  v_cvt_pk_bf16_f32 v83, v54, v55
  v_exp_f32 v57, v57
  v_exp_f32 v58, v58
  s_add_u32 m0, s45, 81920
  s_mov_b32 s50, 114688
  buffer_load_dwordx4 v30, s[56:59], s50 offen lds
  v_exp_f32 v59, v59
  v_mfma_f32_32x32x16_bf16 v[88:103], v[128:131], v[80:83], 0
  ds_read_b128 v[128:131], v3 offset:30720
  v_exp_f32 v60, v60
  v_exp_f32 v61, v61
  v_exp_f32 v62, v62
  v_exp_f32 v63, v63
  v_cvt_pk_bf16_f32 v84, v56, v57
  v_cvt_pk_bf16_f32 v85, v58, v59
  v_cvt_pk_bf16_f32 v86, v60, v61
  v_cvt_pk_bf16_f32 v87, v62, v63
  s_waitcnt lgkmcnt(0)
  s_setprio 0
  v_exp_f32 v64, v64
  v_mfma_f32_32x32x16_bf16 v[88:103], v[132:135], v[84:87], v[88:103]
  ds_read_b128 v[132:135], v3 offset:31744
  v_exp_f32 v65, v65
  v_exp_f32 v66, v66
  v_exp_f32 v67, v67
  v_cvt_pk_bf16_f32 v80, v64, v65
  ds_write_b128 v6, v[112:115] offset:2048
  ds_write_b128 v6, v[116:119] offset:3072
  ds_write_b32 v7, v27 offset:0
  v_mfma_f32_32x32x16_bf16 v[48:63], v[120:123], v[8:11], 0
  v_exp_f32 v68, v68
  v_exp_f32 v69, v69
  v_cvt_pk_bf16_f32 v81, v66, v67
  v_exp_f32 v70, v70
  v_exp_f32 v71, v71
  v_cvt_pk_bf16_f32 v82, v68, v69
  v_mfma_f32_32x32x16_bf16 v[48:63], v[124:127], v[12:15], v[48:63]
  ds_read_b128 v[120:123], v3 offset:20480
  ds_read_b128 v[124:127], v3 offset:21504
  v_exp_f32 v72, v72
  v_cvt_pk_bf16_f32 v83, v70, v71
  v_exp_f32 v73, v73
  v_exp_f32 v74, v74
  s_add_u32 m0, s45, 90112
  s_mov_b32 s50, 172032
  buffer_load_dwordx4 v30, s[56:59], s50 offen lds
  v_exp_f32 v75, v75
  v_mfma_f32_32x32x16_bf16 v[88:103], v[128:131], v[80:83], v[88:103]
  ds_read_b128 v[128:131], v3 offset:26624
  v_exp_f32 v76, v76
  v_exp_f32 v77, v77
  v_exp_f32 v78, v78
  v_exp_f32 v79, v79
  v_cvt_pk_bf16_f32 v84, v72, v73
  v_cvt_pk_bf16_f32 v85, v74, v75
  v_cvt_pk_bf16_f32 v86, v76, v77
  v_cvt_pk_bf16_f32 v87, v78, v79
  s_waitcnt lgkmcnt(0)
  s_barrier
  ds_read_b128 v[152:155], v6 offset:0
  ds_read_b128 v[156:159], v6 offset:1024
  ds_read_b32 v136, v7 offset:1024
  ds_read_b32 v141, v7 offset:2048
  s_waitcnt lgkmcnt(0)
  v_min_f32 v137, v27, v136
  v_sub_f32 v138, v137, v27
  v_sub_f32 v139, v137, v136
  v_exp_f32 v138, v138
  v_exp_f32 v139, v139
  s_nop 0
  v_mul_f32 v136, v116, v138
  v_fmac_f32 v136, v141, v139
  v_mul_f32 v104, v104, v138
  v_mul_f32 v105, v105, v138
  v_mul_f32 v106, v106, v138
  v_mul_f32 v107, v107, v138
  v_mul_f32 v108, v108, v138
  v_mul_f32 v109, v109, v138
  v_mul_f32 v110, v110, v138
  v_mul_f32 v111, v111, v138
  v_mov_b32 v137, v136
  v_fmac_f32 v104, v152, v139
  v_fmac_f32 v105, v153, v139
  v_fmac_f32 v106, v154, v139
  v_fmac_f32 v107, v155, v139
  v_fmac_f32 v108, v156, v139
  v_fmac_f32 v109, v157, v139
  v_fmac_f32 v110, v158, v139
  v_fmac_f32 v111, v159, v139
  v_permlane32_swap_b32 v136, v137
  v_mul_f32 v140, 0, v104
  v_fmac_f32 v140, 0, v105
  v_fmac_f32 v140, 0, v106
  v_fmac_f32 v140, 0, v107
  v_fmac_f32 v140, 0, v108
  v_fmac_f32 v140, 0, v109
  v_fmac_f32 v140, 0, v110
  v_fmac_f32 v140, 0, v111
  v_add_f32 v140, v140, v137
  v_subrev_u32 v140, 0x2b800000, v140
  v_cmp_le_u32 vcc, 0x46000000, v140
  s_nop 4
  s_cbranch_vccz LFB0_ok
  v_mov_b32 v208, v16
  v_mov_b32 v209, v17
  v_mov_b32 v210, v18
  v_mov_b32 v211, v19
  v_mov_b32 v212, v20
  v_mov_b32 v213, v21
  v_mov_b32 v214, v22
  v_mov_b32 v215, v23
  s_mov_b64 exec, s[60:61]
  v_mov_b32 v214, 0
  s_mov_b64 exec, -1
  v_mov_b32 v104, 0
  v_mov_b32 v105, 0
  v_mov_b32 v106, 0
  v_mov_b32 v107, 0
  v_mov_b32 v108, 0
  v_mov_b32 v109, 0
  v_mov_b32 v110, 0
  v_mov_b32 v111, 0
  v_mov_b32 v112, 0
  v_mov_b32 v113, 0
  v_mov_b32 v114, 0
  v_mov_b32 v115, 0
  v_mov_b32 v116, 0
  v_mov_b32 v117, 0
  v_mov_b32 v118, 0
  v_mov_b32 v119, 0
  v_mov_b32 v216, v25
  s_mov_b32 s54, 63
LFB0_fb_loop:
  s_lshl_b32 s55, s54, 12
  buffer_load_dwordx4 v[184:187], v2, s[32:35], s55 offen offset:0
  buffer_load_dwordx4 v[192:195], v2, s[32:35], s55 offen offset:2048
  buffer_load_dwordx4 v[188:191], v2, s[32:35], s55 offen offset:1024
  buffer_load_dwordx4 v[196:199], v2, s[32:35], s55 offen offset:3072
  v_mov_b32 v168, 0
  v_mov_b32 v169, 0
  v_mov_b32 v170, 0
  v_mov_b32 v171, 0
  v_mov_b32 v172, 0
  v_mov_b32 v173, 0
  v_mov_b32 v174, 0
  v_mov_b32 v175, 0
  v_mov_b32 v176, 0
  v_mov_b32 v177, 0
  v_mov_b32 v178, 0
  v_mov_b32 v179, 0
  v_mov_b32 v180, 0
  v_mov_b32 v181, 0
  v_mov_b32 v182, 0
  v_mov_b32 v183, 0
  s_waitcnt vmcnt(0)
  s_nop 1
  v_mfma_f32_32x32x16_bf16 v[168:183], v[184:187], v[208:211], v[168:183]
  v_mfma_f32_32x32x16_bf16 v[168:183], v[188:191], v[212:215], v[168:183]
  s_nop 15
  v_max3_f32 v217, v168, v169, v170
  v_max3_f32 v217, v217, v171, v172
  v_max3_f32 v217, v217, v173, v174
  v_max3_f32 v217, v217, v175, v176
  v_max3_f32 v217, v217, v177, v178
  v_max3_f32 v217, v217, v179, v180
  v_max3_f32 v217, v217, v181, v182
  v_max_f32 v217, v217, v183
  v_mov_b32 v218, v217
  s_nop 1
  v_permlane32_swap_b32 v217, v218
  s_nop 1
  v_max_f32 v217, v217, v218
  v_max_f32 v217, v217, v216
  v_sub_f32 v218, v216, v217
  v_exp_f32 v218, v218
  v_mov_b32 v216, v217
  v_sub_f32 v168, v168, v216
  v_sub_f32 v169, v169, v216
  v_sub_f32 v170, v170, v216
  v_sub_f32 v171, v171, v216
  v_sub_f32 v172, v172, v216
  v_sub_f32 v173, v173, v216
  v_sub_f32 v174, v174, v216
  v_sub_f32 v175, v175, v216
  v_sub_f32 v176, v176, v216
  v_sub_f32 v177, v177, v216
  v_sub_f32 v178, v178, v216
  v_sub_f32 v179, v179, v216
  v_sub_f32 v180, v180, v216
  v_sub_f32 v181, v181, v216
  v_sub_f32 v182, v182, v216
  v_sub_f32 v183, v183, v216
  v_exp_f32 v168, v168
  v_exp_f32 v169, v169
  v_exp_f32 v170, v170
  v_exp_f32 v171, v171
  v_exp_f32 v172, v172
  v_exp_f32 v173, v173
  v_exp_f32 v174, v174
  v_exp_f32 v175, v175
  v_exp_f32 v176, v176
  v_exp_f32 v177, v177
  v_exp_f32 v178, v178
  v_exp_f32 v179, v179
  v_exp_f32 v180, v180
  v_exp_f32 v181, v181
  v_exp_f32 v182, v182
  v_exp_f32 v183, v183
  v_mul_f32 v104, v104, v218
  v_mul_f32 v105, v105, v218
  v_mul_f32 v106, v106, v218
  v_mul_f32 v107, v107, v218
  v_mul_f32 v108, v108, v218
  v_mul_f32 v109, v109, v218
  v_mul_f32 v110, v110, v218
  v_mul_f32 v111, v111, v218
  v_mul_f32 v112, v112, v218
  v_mul_f32 v113, v113, v218
  v_mul_f32 v114, v114, v218
  v_mul_f32 v115, v115, v218
  v_mul_f32 v116, v116, v218
  v_mul_f32 v117, v117, v218
  v_mul_f32 v118, v118, v218
  v_mul_f32 v119, v119, v218
  v_cvt_pk_bf16_f32 v200, v168, v169
  v_cvt_pk_bf16_f32 v201, v170, v171
  v_cvt_pk_bf16_f32 v202, v172, v173
  v_cvt_pk_bf16_f32 v203, v174, v175
  v_cvt_pk_bf16_f32 v204, v176, v177
  v_cvt_pk_bf16_f32 v205, v178, v179
  v_cvt_pk_bf16_f32 v206, v180, v181
  v_cvt_pk_bf16_f32 v207, v182, v183
  s_nop 1
  v_mfma_f32_32x32x16_bf16 v[104:119], v[192:195], v[200:203], v[104:119]
  v_mfma_f32_32x32x16_bf16 v[104:119], v[196:199], v[204:207], v[104:119]
  s_nop 15
  s_sub_u32 s54, s54, 1
  s_cmp_lt_i32 s54, 0
  s_cbranch_scc1 LFB0_fb_end
  s_branch LFB0_fb_loop
LFB0_fb_end:
  v_mov_b32 v136, v116
  v_mov_b32 v137, v116
  s_nop 1
  v_permlane32_swap_b32 v136, v137
  s_nop 1
LFB0_ok:
  v_rcp_f32 v137, v137
  s_lshl_b32 s47, s41, 2
  s_add_u32 s47, s47, s42
  v_mul_f32 v104, v104, v137
  v_mul_f32 v105, v105, v137
  v_mul_f32 v106, v106, v137
  v_mul_f32 v107, v107, v137
  v_mul_f32 v108, v108, v137
  v_mul_f32 v109, v109, v137
  v_mul_f32 v110, v110, v137
  v_mul_f32 v111, v111, v137
  s_add_u32 s47, s47, 64
  s_lshl_b32 s47, s47, 4
  s_add_u32 s47, s47, s40
  s_lshl_b32 s47, s47, 11
  v_cvt_pk_bf16_f32 v152, v104, v105
  v_cvt_pk_bf16_f32 v153, v106, v107
  v_cvt_pk_bf16_f32 v154, v108, v109
  v_cvt_pk_bf16_f32 v155, v110, v111
  s_nop 1
  buffer_store_dwordx4 v[152:155], v2, s[36:39], s47 offen offset:0 sc1
  s_nop 1
  s_setprio 3
  v_exp_f32 v48, v48
  v_mfma_f32_32x32x16_bf16 v[88:103], v[132:135], v[84:87], v[88:103]
  ds_read_b128 v[132:135], v3 offset:27648
  v_exp_f32 v49, v49
  v_exp_f32 v50, v50
  v_exp_f32 v51, v51
  v_cvt_pk_bf16_f32 v80, v48, v49
  v_mfma_f32_32x32x16_bf16 v[64:79], v[120:123], v[8:11], 0
  v_exp_f32 v52, v52
  v_exp_f32 v53, v53
  v_cvt_pk_bf16_f32 v81, v50, v51
  v_exp_f32 v54, v54
  v_exp_f32 v55, v55
  v_cvt_pk_bf16_f32 v82, v52, v53
  v_mfma_f32_32x32x16_bf16 v[64:79], v[124:127], v[12:15], v[64:79]
  ds_read_b128 v[120:123], v3 offset:16384
  ds_read_b128 v[124:127], v3 offset:17408
  v_exp_f32 v56, v56
  v_cvt_pk_bf16_f32 v83, v54, v55
  v_exp_f32 v57, v57
  v_exp_f32 v58, v58
  s_add_u32 m0, s45, 98304
  s_mov_b32 s50, 229376
  buffer_load_dwordx4 v30, s[56:59], s50 offen lds
  s_add_u32 m0, s45, 106496
  s_mov_b32 s50, 286720
  buffer_load_dwordx4 v30, s[56:59], s50 offen lds
  v_exp_f32 v59, v59
  v_mfma_f32_32x32x16_bf16 v[88:103], v[128:131], v[80:83], v[88:103]
  ds_read_b128 v[128:131], v3 offset:22528
  v_exp_f32 v60, v60
  v_exp_f32 v61, v61
  v_exp_f32 v62, v62
  v_exp_f32 v63, v63
  v_cvt_pk_bf16_f32 v84, v56, v57
  v_cvt_pk_bf16_f32 v85, v58, v59
  v_cvt_pk_bf16_f32 v86, v60, v61
  v_cvt_pk_bf16_f32 v87, v62, v63
  s_waitcnt lgkmcnt(0)
  s_setprio 2
  v_exp_f32 v64, v64
  v_mfma_f32_32x32x16_bf16 v[88:103], v[132:135], v[84:87], v[88:103]
  ds_read_b128 v[132:135], v3 offset:23552
  v_exp_f32 v65, v65
  v_exp_f32 v66, v66
  v_exp_f32 v67, v67
  v_cvt_pk_bf16_f32 v80, v64, v65
  v_mfma_f32_32x32x16_bf16 v[48:63], v[120:123], v[8:11], 0
  v_exp_f32 v68, v68
  v_exp_f32 v69, v69
  v_cvt_pk_bf16_f32 v81, v66, v67
  v_exp_f32 v70, v70
  v_exp_f32 v71, v71
  v_cvt_pk_bf16_f32 v82, v68, v69
  v_mfma_f32_32x32x16_bf16 v[48:63], v[124:127], v[12:15], v[48:63]
  v_exp_f32 v72, v72
  v_cvt_pk_bf16_f32 v83, v70, v71
  v_exp_f32 v73, v73
  v_exp_f32 v74, v74
  s_add_u32 m0, s45, 114688
  s_mov_b32 s50, 344064
  buffer_load_dwordx4 v30, s[56:59], s50 offen lds
  s_cmp_lg_u32 s3, 0
  s_cbranch_scc1 Lwo7_43
  s_add_u32 m0, s45, 122880
  v_add_u32 v31, 401408, v30
  buffer_load_dwordx4 v31, s[56:59], 0 offen lds
Lwo7_43:
  v_exp_f32 v75, v75
  v_mfma_f32_32x32x16_bf16 v[88:103], v[128:131], v[80:83], v[88:103]
  ds_read_b128 v[128:131], v3 offset:18432
  v_exp_f32 v76, v76
  v_exp_f32 v77, v77
  v_exp_f32 v78, v78
  v_exp_f32 v79, v79
  v_cvt_pk_bf16_f32 v84, v72, v73
  v_cvt_pk_bf16_f32 v85, v74, v75
  v_cvt_pk_bf16_f32 v86, v76, v77
  v_cvt_pk_bf16_f32 v87, v78, v79
  s_waitcnt lgkmcnt(0)
  s_setprio 1
  v_exp_f32 v48, v48
  v_mfma_f32_32x32x16_bf16 v[88:103], v[132:135], v[84:87], v[88:103]
  ds_read_b128 v[132:135], v3 offset:19456
  v_exp_f32 v49, v49
  v_exp_f32 v50, v50
  v_exp_f32 v51, v51
  v_cvt_pk_bf16_f32 v80, v48, v49
  v_exp_f32 v52, v52
  v_exp_f32 v53, v53
  v_cvt_pk_bf16_f32 v81, v50, v51
  v_exp_f32 v54, v54
  v_exp_f32 v55, v55
  v_cvt_pk_bf16_f32 v82, v52, v53
  v_exp_f32 v56, v56
  v_cvt_pk_bf16_f32 v83, v54, v55
  v_exp_f32 v57, v57
  v_exp_f32 v58, v58
  v_exp_f32 v59, v59
  v_mfma_f32_32x32x16_bf16 v[88:103], v[128:131], v[80:83], v[88:103]
  v_exp_f32 v60, v60
  v_exp_f32 v61, v61
  v_exp_f32 v62, v62
  v_exp_f32 v63, v63
  v_cvt_pk_bf16_f32 v84, v56, v57
  v_cvt_pk_bf16_f32 v85, v58, v59
  v_cvt_pk_bf16_f32 v86, v60, v61
  v_cvt_pk_bf16_f32 v87, v62, v63
  s_waitcnt lgkmcnt(0)
  s_nop 1
  v_mfma_f32_32x32x16_bf16 v[88:103], v[132:135], v[84:87], v[88:103]
  s_nop 15
  ds_write_b128 v6, v[96:99] offset:0
  ds_write_b128 v6, v[100:103] offset:1024
  ds_write_b32 v7, v26 offset:1024
  s_waitcnt vmcnt(3) lgkmcnt(0)
  s_barrier
  ds_read_b128 v[152:155], v6 offset:2048
  ds_read_b128 v[156:159], v6 offset:3072
  ds_read_b32 v136, v7 offset:0
  ds_read_b32 v141, v7 offset:3072
  s_waitcnt lgkmcnt(0)
  v_min_f32 v137, v26, v136
  v_sub_f32 v138, v137, v26
  v_sub_f32 v139, v137, v136
  v_exp_f32 v138, v138
  v_exp_f32 v139, v139
  s_nop 0
  v_mul_f32 v136, v100, v138
  v_fmac_f32 v136, v141, v139
  v_mul_f32 v88, v88, v138
  v_mul_f32 v89, v89, v138
  v_mul_f32 v90, v90, v138
  v_mul_f32 v91, v91, v138
  v_mul_f32 v92, v92, v138
  v_mul_f32 v93, v93, v138
  v_mul_f32 v94, v94, v138
  v_mul_f32 v95, v95, v138
  v_mov_b32 v137, v136
  v_fmac_f32 v88, v152, v139
  v_fmac_f32 v89, v153, v139
  v_fmac_f32 v90, v154, v139
  v_fmac_f32 v91, v155, v139
  v_fmac_f32 v92, v156, v139
  v_fmac_f32 v93, v157, v139
  v_fmac_f32 v94, v158, v139
  v_fmac_f32 v95, v159, v139
  v_permlane32_swap_b32 v136, v137
  v_mul_f32 v140, 0, v88
  v_fmac_f32 v140, 0, v89
  v_fmac_f32 v140, 0, v90
  v_fmac_f32 v140, 0, v91
  v_fmac_f32 v140, 0, v92
  v_fmac_f32 v140, 0, v93
  v_fmac_f32 v140, 0, v94
  v_fmac_f32 v140, 0, v95
  v_add_f32 v140, v140, v137
  v_subrev_u32 v140, 0x2b800000, v140
  v_cmp_le_u32 vcc, 0x46000000, v140
  s_nop 4
  s_cbranch_vccz LFA0_ok
  v_mov_b32 v208, v8
  v_mov_b32 v209, v9
  v_mov_b32 v210, v10
  v_mov_b32 v211, v11
  v_mov_b32 v212, v12
  v_mov_b32 v213, v13
  v_mov_b32 v214, v14
  v_mov_b32 v215, v15
  s_mov_b64 exec, s[60:61]
  v_mov_b32 v214, 0
  s_mov_b64 exec, -1
  v_mov_b32 v88, 0
  v_mov_b32 v89, 0
  v_mov_b32 v90, 0
  v_mov_b32 v91, 0
  v_mov_b32 v92, 0
  v_mov_b32 v93, 0
  v_mov_b32 v94, 0
  v_mov_b32 v95, 0
  v_mov_b32 v96, 0
  v_mov_b32 v97, 0
  v_mov_b32 v98, 0
  v_mov_b32 v99, 0
  v_mov_b32 v100, 0
  v_mov_b32 v101, 0
  v_mov_b32 v102, 0
  v_mov_b32 v103, 0
  v_mov_b32 v216, v25
  s_lshl_b32 s52, s41, 2
  s_add_u32 s52, s52, s42
  s_sub_u32 s53, s52, 8
  s_mov_b32 s54, s52
LFA0_fb_loop:
  s_lshl_b32 s55, s54, 12
  buffer_load_dwordx4 v[184:187], v2, s[28:31], s55 offen offset:0
  buffer_load_dwordx4 v[192:195], v2, s[28:31], s55 offen offset:2048
  buffer_load_dwordx4 v[188:191], v2, s[28:31], s55 offen offset:1024
  buffer_load_dwordx4 v[196:199], v2, s[28:31], s55 offen offset:3072
  s_cmp_eq_u32 s54, s52
  s_cbranch_scc1 LFA0_fb_diag
  s_cmp_eq_u32 s54, s53
  s_cbranch_scc1 LFA0_fb_first
  v_mov_b32 v168, 0
  v_mov_b32 v169, 0
  v_mov_b32 v170, 0
  v_mov_b32 v171, 0
  v_mov_b32 v172, 0
  v_mov_b32 v173, 0
  v_mov_b32 v174, 0
  v_mov_b32 v175, 0
  v_mov_b32 v176, 0
  v_mov_b32 v177, 0
  v_mov_b32 v178, 0
  v_mov_b32 v179, 0
  v_mov_b32 v180, 0
  v_mov_b32 v181, 0
  v_mov_b32 v182, 0
  v_mov_b32 v183, 0
  s_branch LFA0_fb_go
LFA0_fb_diag:
  v_cmp_le_i32 vcc, 0, v24
  s_nop 1
  v_cndmask_b32_e64 v168, v25, 0, vcc
  v_cmp_le_i32 vcc, 1, v24
  s_nop 1
  v_cndmask_b32_e64 v169, v25, 0, vcc
  v_cmp_le_i32 vcc, 2, v24
  s_nop 1
  v_cndmask_b32_e64 v170, v25, 0, vcc
  v_cmp_le_i32 vcc, 3, v24
  s_nop 1
  v_cndmask_b32_e64 v171, v25, 0, vcc
  v_cmp_le_i32 vcc, 8, v24
  s_nop 1
  v_cndmask_b32_e64 v172, v25, 0, vcc
  v_cmp_le_i32 vcc, 9, v24
  s_nop 1
  v_cndmask_b32_e64 v173, v25, 0, vcc
  v_cmp_le_i32 vcc, 10, v24
  s_nop 1
  v_cndmask_b32_e64 v174, v25, 0, vcc
  v_cmp_le_i32 vcc, 11, v24
  s_nop 1
  v_cndmask_b32_e64 v175, v25, 0, vcc
  v_cmp_le_i32 vcc, 16, v24
  s_nop 1
  v_cndmask_b32_e64 v176, v25, 0, vcc
  v_cmp_le_i32 vcc, 17, v24
  s_nop 1
  v_cndmask_b32_e64 v177, v25, 0, vcc
  v_cmp_le_i32 vcc, 18, v24
  s_nop 1
  v_cndmask_b32_e64 v178, v25, 0, vcc
  v_cmp_le_i32 vcc, 19, v24
  s_nop 1
  v_cndmask_b32_e64 v179, v25, 0, vcc
  v_cmp_le_i32 vcc, 24, v24
  s_nop 1
  v_cndmask_b32_e64 v180, v25, 0, vcc
  v_cmp_le_i32 vcc, 25, v24
  s_nop 1
  v_cndmask_b32_e64 v181, v25, 0, vcc
  v_cmp_le_i32 vcc, 26, v24
  s_nop 1
  v_cndmask_b32_e64 v182, v25, 0, vcc
  v_cmp_le_i32 vcc, 27, v24
  s_nop 1
  v_cndmask_b32_e64 v183, v25, 0, vcc
  s_branch LFA0_fb_go
LFA0_fb_first:
  v_cmp_gt_i32 vcc, 0, v24
  s_nop 1
  v_cndmask_b32_e64 v168, v25, 0, vcc
  v_cmp_gt_i32 vcc, 1, v24
  s_nop 1
  v_cndmask_b32_e64 v169, v25, 0, vcc
  v_cmp_gt_i32 vcc, 2, v24
  s_nop 1
  v_cndmask_b32_e64 v170, v25, 0, vcc
  v_cmp_gt_i32 vcc, 3, v24
  s_nop 1
  v_cndmask_b32_e64 v171, v25, 0, vcc
  v_cmp_gt_i32 vcc, 8, v24
  s_nop 1
  v_cndmask_b32_e64 v172, v25, 0, vcc
  v_cmp_gt_i32 vcc, 9, v24
  s_nop 1
  v_cndmask_b32_e64 v173, v25, 0, vcc
  v_cmp_gt_i32 vcc, 10, v24
  s_nop 1
  v_cndmask_b32_e64 v174, v25, 0, vcc
  v_cmp_gt_i32 vcc, 11, v24
  s_nop 1
  v_cndmask_b32_e64 v175, v25, 0, vcc
  v_cmp_gt_i32 vcc, 16, v24
  s_nop 1
  v_cndmask_b32_e64 v176, v25, 0, vcc
  v_cmp_gt_i32 vcc, 17, v24
  s_nop 1
  v_cndmask_b32_e64 v177, v25, 0, vcc
  v_cmp_gt_i32 vcc, 18, v24
  s_nop 1
  v_cndmask_b32_e64 v178, v25, 0, vcc
  v_cmp_gt_i32 vcc, 19, v24
  s_nop 1
  v_cndmask_b32_e64 v179, v25, 0, vcc
  v_cmp_gt_i32 vcc, 24, v24
  s_nop 1
  v_cndmask_b32_e64 v180, v25, 0, vcc
  v_cmp_gt_i32 vcc, 25, v24
  s_nop 1
  v_cndmask_b32_e64 v181, v25, 0, vcc
  v_cmp_gt_i32 vcc, 26, v24
  s_nop 1
  v_cndmask_b32_e64 v182, v25, 0, vcc
  v_cmp_gt_i32 vcc, 27, v24
  s_nop 1
  v_cndmask_b32_e64 v183, v25, 0, vcc
LFA0_fb_go:
  s_waitcnt vmcnt(0)
  s_nop 1
  v_mfma_f32_32x32x16_bf16 v[168:183], v[184:187], v[208:211], v[168:183]
  v_mfma_f32_32x32x16_bf16 v[168:183], v[188:191], v[212:215], v[168:183]
  s_nop 15
  v_max3_f32 v217, v168, v169, v170
  v_max3_f32 v217, v217, v171, v172
  v_max3_f32 v217, v217, v173, v174
  v_max3_f32 v217, v217, v175, v176
  v_max3_f32 v217, v217, v177, v178
  v_max3_f32 v217, v217, v179, v180
  v_max3_f32 v217, v217, v181, v182
  v_max_f32 v217, v217, v183
  v_mov_b32 v218, v217
  s_nop 1
  v_permlane32_swap_b32 v217, v218
  s_nop 1
  v_max_f32 v217, v217, v218
  v_max_f32 v217, v217, v216
  v_sub_f32 v218, v216, v217
  v_exp_f32 v218, v218
  v_mov_b32 v216, v217
  v_sub_f32 v168, v168, v216
  v_sub_f32 v169, v169, v216
  v_sub_f32 v170, v170, v216
  v_sub_f32 v171, v171, v216
  v_sub_f32 v172, v172, v216
  v_sub_f32 v173, v173, v216
  v_sub_f32 v174, v174, v216
  v_sub_f32 v175, v175, v216
  v_sub_f32 v176, v176, v216
  v_sub_f32 v177, v177, v216
  v_sub_f32 v178, v178, v216
  v_sub_f32 v179, v179, v216
  v_sub_f32 v180, v180, v216
  v_sub_f32 v181, v181, v216
  v_sub_f32 v182, v182, v216
  v_sub_f32 v183, v183, v216
  v_exp_f32 v168, v168
  v_exp_f32 v169, v169
  v_exp_f32 v170, v170
  v_exp_f32 v171, v171
  v_exp_f32 v172, v172
  v_exp_f32 v173, v173
  v_exp_f32 v174, v174
  v_exp_f32 v175, v175
  v_exp_f32 v176, v176
  v_exp_f32 v177, v177
  v_exp_f32 v178, v178
  v_exp_f32 v179, v179
  v_exp_f32 v180, v180
  v_exp_f32 v181, v181
  v_exp_f32 v182, v182
  v_exp_f32 v183, v183
  v_mul_f32 v88, v88, v218
  v_mul_f32 v89, v89, v218
  v_mul_f32 v90, v90, v218
  v_mul_f32 v91, v91, v218
  v_mul_f32 v92, v92, v218
  v_mul_f32 v93, v93, v218
  v_mul_f32 v94, v94, v218
  v_mul_f32 v95, v95, v218
  v_mul_f32 v96, v96, v218
  v_mul_f32 v97, v97, v218
  v_mul_f32 v98, v98, v218
  v_mul_f32 v99, v99, v218
  v_mul_f32 v100, v100, v218
  v_mul_f32 v101, v101, v218
  v_mul_f32 v102, v102, v218
  v_mul_f32 v103, v103, v218
  v_cvt_pk_bf16_f32 v200, v168, v169
  v_cvt_pk_bf16_f32 v201, v170, v171
  v_cvt_pk_bf16_f32 v202, v172, v173
  v_cvt_pk_bf16_f32 v203, v174, v175
  v_cvt_pk_bf16_f32 v204, v176, v177
  v_cvt_pk_bf16_f32 v205, v178, v179
  v_cvt_pk_bf16_f32 v206, v180, v181
  v_cvt_pk_bf16_f32 v207, v182, v183
  s_nop 1
  v_mfma_f32_32x32x16_bf16 v[88:103], v[192:195], v[200:203], v[88:103]
  v_mfma_f32_32x32x16_bf16 v[88:103], v[196:199], v[204:207], v[88:103]
  s_nop 15
  s_sub_u32 s54, s54, 1
  s_cmp_lt_i32 s54, 0
  s_cbranch_scc1 LFA0_fb_end
  s_cmp_lt_i32 s54, s53
  s_cbranch_scc1 LFA0_fb_end
  s_branch LFA0_fb_loop
LFA0_fb_end:
  v_mov_b32 v136, v100
  v_mov_b32 v137, v100
  s_nop 1
  v_permlane32_swap_b32 v136, v137
  s_nop 1
LFA0_ok:
  v_rcp_f32 v137, v137
  s_lshl_b32 s47, s41, 2
  s_add_u32 s47, s47, s42
  v_mul_f32 v88, v88, v137
  v_mul_f32 v89, v89, v137
  v_mul_f32 v90, v90, v137
  v_mul_f32 v91, v91, v137
  v_mul_f32 v92, v92, v137
  v_mul_f32 v93, v93, v137
  v_mul_f32 v94, v94, v137
  v_mul_f32 v95, v95, v137
  s_add_u32 s47, s47, 0
  s_lshl_b32 s47, s47, 4
  s_add_u32 s47, s47, s40
  s_lshl_b32 s47, s47, 11
  v_cvt_pk_bf16_f32 v152, v88, v89
  v_cvt_pk_bf16_f32 v153, v90, v91
  v_cvt_pk_bf16_f32 v154, v92, v93
  v_cvt_pk_bf16_f32 v155, v94, v95
  s_nop 1
  buffer_store_dwordx4 v[152:155], v2, s[36:39], s47 offen offset:0 sc1
  s_nop 1
  s_waitcnt vmcnt(0)
  s_mov_b64 exec, 1
  v_mov_b32 v1, 1
  s_lshl_b32 s47, s41, 8
  s_add_u32 s47, s47, 8192
  v_mov_b32 v31, s47
  buffer_atomic_add v1, v31, s[64:67], 0 offen sc1
  s_mov_b64 exec, -1
  s_mov_b32 s56, s8
  s_mov_b32 s57, s9
  s_mov_b32 s58, 401408
  s_mov_b32 s59, 0x20000
  v_lshrrev_b32 v30, 3, v0
  v_and_b32 v29, 7, v0
  v_and_b32 v1, 2, v30
  v_lshlrev_b32 v1, 1, v1
  v_xor_b32 v29, v29, v1
  s_lshl_b32 s51, s3, 3
  v_add_u32 v30, s51, v30
  v_mul_u32_u24 v30, 896, v30
  v_lshl_add_u32 v30, v29, 4, v30
  s_lshr_b32 s51, s2, 5
  s_lshl_b32 s51, s51, 7
  s_cmp_ge_u32 s2, 224
  s_cselect_b32 s51, 0x40000000, s51
  v_add_u32 v30, s51, v30
  s_lshl_b32 s52, s3, 10
  s_add_u32 m0, s52, 0
  s_mov_b32 s51, 0
  buffer_load_dwordx4 v30, s[56:59], s51 offen lds
  s_add_u32 m0, s52, 8192
  s_mov_b32 s51, 57344
  buffer_load_dwordx4 v30, s[56:59], s51 offen lds
  s_add_u32 m0, s52, 16384
  s_mov_b32 s51, 114688
  buffer_load_dwordx4 v30, s[56:59], s51 offen lds
  s_add_u32 m0, s52, 24576
  s_mov_b32 s51, 172032
  buffer_load_dwordx4 v30, s[56:59], s51 offen lds
  s_add_u32 m0, s52, 32768
  s_mov_b32 s51, 229376
  buffer_load_dwordx4 v30, s[56:59], s51 offen lds
  s_add_u32 m0, s52, 40960
  s_mov_b32 s51, 286720
  buffer_load_dwordx4 v30, s[56:59], s51 offen lds
  s_add_u32 m0, s52, 49152
  s_mov_b32 s51, 344064
  buffer_load_dwordx4 v30, s[56:59], s51 offen lds
  s_cmp_lg_u32 s3, 0
  s_cbranch_scc1 LwoA_44
  s_add_u32 m0, s52, 57344
  v_add_u32 v29, 401408, v30
  buffer_load_dwordx4 v29, s[56:59], 0 offen lds
LwoA_44:
  s_cmp_ge_u32 s2, 224
  s_cbranch_scc1 LidleA_45
  s_mov_b32 s40, 0
  s_and_b32 s41, s2, 7
  s_lshl_b32 s41, s41, 2
  s_bfe_u32 s42, s2, 0x20003
  s_add_u32 s41, s41, s42
  s_lshr_b32 s42, s2, 5
  s_and_b32 s43, s3, 1
  s_bfe_u32 s44, s3, 0x10001
  s_mov_b32 s24, s16
  s_mov_b32 s25, s17
  s_mov_b32 s26, 3670016
  s_mov_b32 s27, 0x20000
  s_lshl_b32 s45, s41, 1
  s_add_u32 s45, s45, s43
  s_add_u32 s45, s45, 0
  s_lshl_b32 s45, s45, 15
  s_lshl_b32 s46, s44, 14
  s_add_u32 s45, s45, s46
  v_bfe_u32 v4, v0, 2, 2
  v_and_b32 v5, 3, v0
  v_bfe_u32 v7, v0, 4, 1
  v_lshrrev_b32 v6, 5, v0
  v_lshlrev_b32 v7, 5, v7
  v_lshl_add_u32 v7, v5, 3, v7
  v_lshrrev_b32 v11, 4, v7
  v_and_b32 v8, 2, v4
  v_lshlrev_b32 v8, 1, v8
  v_xor_b32 v11, v11, v8
  v_and_b32 v7, 15, v7
  v_lshl_add_u32 v7, v11, 4, v7
  v_lshl_add_u32 v4, v6, 2, v4
  v_lshl_add_u32 v9, v4, 7, v7
  s_mul_i32 s46, s44, 28672
  v_add_u32 v9, s46, v9
  v_xor_b32 v10, 64, v9
  s_lshl_b32 s46, s43, 1
  s_add_u32 s46, s46, s44
  s_add_u32 s46, s46, 0
  s_lshl_b32 s46, s46, 12
  s_add_u32 s46, s46, 131072
  v_add_u32 v12, s46, v2
  v_xor_b32 v13, 4096, v12
  s_lshr_b32 s46, s41, 1
  s_lshl_b32 s46, s46, 8
  s_add_u32 s46, s46, 8192
  v_mov_b32 v30, s46
  s_waitcnt vmcnt(0)
  s_barrier
  v_mov_b32 v204, 65472
  s_cmp_lg_u32 s3, 0
  s_cbranch_scc1 Lfollow_46
  s_mov_b32 s68, 200000
Lpoll_49:
  buffer_load_dword v1, v30, s[64:67], 0 offen sc1
  s_waitcnt vmcnt(0)
  v_cmp_ne_u32 vcc, 128, v1
  s_nop 4
  s_cbranch_vccz Lpdone_50
  s_sleep 1
  s_sub_u32 s68, s68, 1
  s_cmp_lg_u32 s68, 0
  s_cbranch_scc1 Lpoll_49
Lpdone_50:
  v_mov_b32 v205, 1
  ds_write_b32 v204, v205
  s_waitcnt lgkmcnt(0)
  s_branch Lgdone_47
Lfollow_46:
  s_mov_b32 s68, 3200000
Llspin_48:
  ds_read_b32 v205, v204
  s_waitcnt lgkmcnt(0)
  v_readfirstlane_b32 s47, v205
  s_cmp_lg_u32 s47, 0
  s_cbranch_scc1 Lgdone_47
  s_sleep 1
  s_sub_u32 s68, s68, 1
  s_cmp_lg_u32 s68, 0
  s_cbranch_scc1 Llspin_48
Lgdone_47:
  buffer_load_dwordx4 v[64:67], v2, s[36:39], s45 offen offset:0
  buffer_load_dwordx4 v[68:71], v2, s[36:39], s45 offen offset:1024
  buffer_load_dwordx4 v[72:75], v2, s[36:39], s45 offen offset:2048
  buffer_load_dwordx4 v[76:79], v2, s[36:39], s45 offen offset:3072
  s_add_u32 s45, s45, 4096
  buffer_load_dwordx4 v[80:83], v2, s[36:39], s45 offen offset:0
  buffer_load_dwordx4 v[84:87], v2, s[36:39], s45 offen offset:1024
  buffer_load_dwordx4 v[88:91], v2, s[36:39], s45 offen offset:2048
  buffer_load_dwordx4 v[92:95], v2, s[36:39], s45 offen offset:3072
  s_add_u32 s45, s45, 4096
  buffer_load_dwordx4 v[96:99], v2, s[36:39], s45 offen offset:0
  buffer_load_dwordx4 v[100:103], v2, s[36:39], s45 offen offset:1024
  buffer_load_dwordx4 v[104:107], v2, s[36:39], s45 offen offset:2048
  buffer_load_dwordx4 v[108:111], v2, s[36:39], s45 offen offset:3072
  s_add_u32 s45, s45, 4096
  buffer_load_dwordx4 v[112:115], v2, s[36:39], s45 offen offset:0
  buffer_load_dwordx4 v[116:119], v2, s[36:39], s45 offen offset:1024
  buffer_load_dwordx4 v[120:123], v2, s[36:39], s45 offen offset:2048
  buffer_load_dwordx4 v[124:127], v2, s[36:39], s45 offen offset:3072
  s_branch Lproj_common
LidleA_45:
  s_barrier
  s_branch Lend
Lattn_kh1:
  ds_read_b128 v[120:123], v4 offset:0
  ds_read_b128 v[124:127], v4 offset:1024
  s_waitcnt lgkmcnt(0)
  v_mfma_f32_32x32x16_bf16 v[48:63], v[120:123], v[16:19], 0
  v_mfma_f32_32x32x16_bf16 v[48:63], v[124:127], v[20:23], v[48:63]
  s_nop 15
  v_max3_f32 v136, v48, v49, v50
  v_max3_f32 v136, v136, v51, v52
  v_max3_f32 v136, v136, v53, v54
  v_max3_f32 v136, v136, v55, v56
  v_max3_f32 v136, v136, v57, v58
  v_max3_f32 v136, v136, v59, v60
  v_max3_f32 v136, v136, v61, v62
  v_max_f32 v136, v136, v63
  v_mov_b32 v137, v136
  s_nop 1
  v_permlane32_swap_b32 v136, v137
  s_nop 1
  v_max_f32 v136, v136, v137
  v_sub_f32 v136, 0, v136
  v_cvt_pk_bf16_f32 v136, v136, 0
  v_lshlrev_b32 v27, 16, v136
  s_mov_b64 exec, s[60:61]
  v_mov_b32 v22, v136
  s_mov_b64 exec, -1
  s_nop 1
  v_mfma_f32_32x32x16_bf16 v[48:63], v[120:123], v[16:19], 0
  v_mfma_f32_32x32x16_bf16 v[48:63], v[124:127], v[20:23], v[48:63]
  ds_read_b128 v[120:123], v4 offset:4096
  ds_read_b128 v[124:127], v4 offset:5120
  ds_read_b128 v[128:131], v4 offset:2048
  s_nop 15
  s_waitcnt lgkmcnt(0)
  s_setprio 1
  v_exp_f32 v48, v48
  ds_read_b128 v[132:135], v4 offset:3072
  v_exp_f32 v49, v49
  v_exp_f32 v50, v50
  v_exp_f32 v51, v51
  v_cvt_pk_bf16_f32 v80, v48, v49
  v_mfma_f32_32x32x16_bf16 v[64:79], v[120:123], v[16:19], 0
  v_exp_f32 v52, v52
  v_exp_f32 v53, v53
  v_cvt_pk_bf16_f32 v81, v50, v51
  v_exp_f32 v54, v54
  v_exp_f32 v55, v55
  v_cvt_pk_bf16_f32 v82, v52, v53
  v_mfma_f32_32x32x16_bf16 v[64:79], v[124:127], v[20:23], v[64:79]
  ds_read_b128 v[120:123], v4 offset:8192
  ds_read_b128 v[124:127], v4 offset:9216
  v_exp_f32 v56, v56
  v_cvt_pk_bf16_f32 v83, v54, v55
  v_exp_f32 v57, v57
  v_exp_f32 v58, v58
  s_add_u32 s54, s55, 65536
  s_add_u32 m0, s55, 65536
  s_nop 0
  buffer_load_dwordx4 v2, s[32:35], s54 offen offset:0 lds
  buffer_load_dwordx4 v2, s[32:35], s54 offen offset:1024 lds
  buffer_load_dwordx4 v2, s[32:35], s54 offen offset:2048 lds
  buffer_load_dwordx4 v2, s[32:35], s54 offen offset:3072 lds
  v_exp_f32 v59, v59
  v_mfma_f32_32x32x16_bf16 v[104:119], v[128:131], v[80:83], 0
  ds_read_b128 v[128:131], v4 offset:6144
  v_exp_f32 v60, v60
  v_exp_f32 v61, v61
  v_exp_f32 v62, v62
  v_exp_f32 v63, v63
  v_cvt_pk_bf16_f32 v84, v56, v57
  v_cvt_pk_bf16_f32 v85, v58, v59
  v_cvt_pk_bf16_f32 v86, v60, v61
  v_cvt_pk_bf16_f32 v87, v62, v63
  s_waitcnt lgkmcnt(0)
  s_setprio 0
  v_exp_f32 v64, v64
  v_mfma_f32_32x32x16_bf16 v[104:119], v[132:135], v[84:87], v[104:119]
  ds_read_b128 v[132:135], v4 offset:7168
  v_exp_f32 v65, v65
  v_exp_f32 v66, v66
  v_exp_f32 v67, v67
  v_cvt_pk_bf16_f32 v80, v64, v65
  v_mfma_f32_32x32x16_bf16 v[48:63], v[120:123], v[16:19], 0
  v_exp_f32 v68, v68
  v_exp_f32 v69, v69
  v_cvt_pk_bf16_f32 v81, v66, v67
  v_exp_f32 v70, v70
  v_exp_f32 v71, v71
  v_cvt_pk_bf16_f32 v82, v68, v69
  v_mfma_f32_32x32x16_bf16 v[48:63], v[124:127], v[20:23], v[48:63]
  ds_read_b128 v[120:123], v4 offset:12288
  ds_read_b128 v[124:127], v4 offset:13312
  v_exp_f32 v72, v72
  v_cvt_pk_bf16_f32 v83, v70, v71
  v_exp_f32 v73, v73
  v_exp_f32 v74, v74
  s_add_u32 s54, s55, 98304
  s_add_u32 m0, s55, 98304
  s_nop 0
  buffer_load_dwordx4 v2, s[32:35], s54 offen offset:0 lds
  buffer_load_dwordx4 v2, s[32:35], s54 offen offset:1024 lds
  buffer_load_dwordx4 v2, s[32:35], s54 offen offset:2048 lds
  buffer_load_dwordx4 v2, s[32:35], s54 offen offset:3072 lds
  v_exp_f32 v75, v75
  v_mfma_f32_32x32x16_bf16 v[104:119], v[128:131], v[80:83], v[104:119]
  ds_read_b128 v[128:131], v4 offset:10240
  v_exp_f32 v76, v76
  v_exp_f32 v77, v77
  v_exp_f32 v78, v78
  v_exp_f32 v79, v79
  v_cvt_pk_bf16_f32 v84, v72, v73
  v_cvt_pk_bf16_f32 v85, v74, v75
  v_cvt_pk_bf16_f32 v86, v76, v77
  v_cvt_pk_bf16_f32 v87, v78, v79
  s_waitcnt vmcnt(8) lgkmcnt(0)
  s_barrier
  s_setprio 3
  v_exp_f32 v48, v48
  v_mfma_f32_32x32x16_bf16 v[104:119], v[132:135], v[84:87], v[104:119]
  ds_read_b128 v[132:135], v4 offset:11264
  v_exp_f32 v49, v49
  v_exp_f32 v50, v50
  v_exp_f32 v51, v51
  v_cvt_pk_bf16_f32 v80, v48, v49
  v_mfma_f32_32x32x16_bf16 v[64:79], v[120:123], v[16:19], 0
  v_exp_f32 v52, v52
  v_exp_f32 v53, v53
  v_cvt_pk_bf16_f32 v81, v50, v51
  v_exp_f32 v54, v54
  v_exp_f32 v55, v55
  v_cvt_pk_bf16_f32 v82, v52, v53
  v_mfma_f32_32x32x16_bf16 v[64:79], v[124:127], v[20:23], v[64:79]
  ds_read_b128 v[120:123], v5 offset:0
  ds_read_b128 v[124:127], v5 offset:1024
  v_exp_f32 v56, v56
  v_cvt_pk_bf16_f32 v83, v54, v55
  v_exp_f32 v57, v57
  v_exp_f32 v58, v58
  v_exp_f32 v59, v59
  v_mfma_f32_32x32x16_bf16 v[104:119], v[128:131], v[80:83], v[104:119]
  ds_read_b128 v[128:131], v4 offset:14336
  v_exp_f32 v60, v60
  v_exp_f32 v61, v61
  v_exp_f32 v62, v62
  v_exp_f32 v63, v63
  v_cvt_pk_bf16_f32 v84, v56, v57
  v_cvt_pk_bf16_f32 v85, v58, v59
  v_cvt_pk_bf16_f32 v86, v60, v61
  v_cvt_pk_bf16_f32 v87, v62, v63
  s_waitcnt lgkmcnt(0)
  s_setprio 2
  v_exp_f32 v64, v64
  v_mfma_f32_32x32x16_bf16 v[104:119], v[132:135], v[84:87], v[104:119]
  ds_read_b128 v[132:135], v4 offset:15360
  v_exp_f32 v65, v65
  v_exp_f32 v66, v66
  v_exp_f32 v67, v67
  v_cvt_pk_bf16_f32 v80, v64, v65
  v_mfma_f32_32x32x16_bf16 v[48:63], v[120:123], v[16:19], 0
  v_exp_f32 v68, v68
  v_exp_f32 v69, v69
  v_cvt_pk_bf16_f32 v81, v66, v67
  v_exp_f32 v70, v70
  v_exp_f32 v71, v71
  v_cvt_pk_bf16_f32 v82, v68, v69
  v_mfma_f32_32x32x16_bf16 v[48:63], v[124:127], v[20:23], v[48:63]
  ds_read_b128 v[120:123], v5 offset:4096
  ds_read_b128 v[124:127], v5 offset:5120
  v_exp_f32 v72, v72
  v_cvt_pk_bf16_f32 v83, v70, v71
  v_exp_f32 v73, v73
  v_exp_f32 v74, v74
  v_exp_f32 v75, v75
  v_mfma_f32_32x32x16_bf16 v[104:119], v[128:131], v[80:83], v[104:119]
  ds_read_b128 v[128:131], v5 offset:2048
  v_exp_f32 v76, v76
  v_exp_f32 v77, v77
  v_exp_f32 v78, v78
  v_exp_f32 v79, v79
  v_cvt_pk_bf16_f32 v84, v72, v73
  v_cvt_pk_bf16_f32 v85, v74, v75
  v_cvt_pk_bf16_f32 v86, v76, v77
  v_cvt_pk_bf16_f32 v87, v78, v79
  v_mov_b32 v4, v5
  v_add_u32 v5, 32768, v5
  v_and_b32 v5, 0x1ffff, v5
  s_waitcnt lgkmcnt(0)
  s_setprio 1
  v_exp_f32 v48, v48
  v_mfma_f32_32x32x16_bf16 v[104:119], v[132:135], v[84:87], v[104:119]
  ds_read_b128 v[132:135], v4 offset:3072
  v_exp_f32 v49, v49
  v_exp_f32 v50, v50
  v_exp_f32 v51, v51
  v_cvt_pk_bf16_f32 v80, v48, v49
  v_mfma_f32_32x32x16_bf16 v[64:79], v[120:123], v[16:19], 0
  v_exp_f32 v52, v52
  v_exp_f32 v53, v53
  v_cvt_pk_bf16_f32 v81, v50, v51
  v_exp_f32 v54, v54
  v_exp_f32 v55, v55
  v_cvt_pk_bf16_f32 v82, v52, v53
  v_mfma_f32_32x32x16_bf16 v[64:79], v[124:127], v[20:23], v[64:79]
  ds_read_b128 v[120:123], v4 offset:8192
  ds_read_b128 v[124:127], v4 offset:9216
  v_exp_f32 v56, v56
  v_cvt_pk_bf16_f32 v83, v54, v55
  v_exp_f32 v57, v57
  v_exp_f32 v58, v58
  v_exp_f32 v59, v59
  v_mfma_f32_32x32x16_bf16 v[104:119], v[128:131], v[80:83], v[104:119]
  ds_read_b128 v[128:131], v4 offset:6144
  v_exp_f32 v60, v60
  v_exp_f32 v61, v61
  v_exp_f32 v62, v62
  v_exp_f32 v63, v63
  v_cvt_pk_bf16_f32 v84, v56, v57
  v_cvt_pk_bf16_f32 v85, v58, v59
  v_cvt_pk_bf16_f32 v86, v60, v61
  v_cvt_pk_bf16_f32 v87, v62, v63
  s_waitcnt lgkmcnt(0)
  s_setprio 0
  v_exp_f32 v64, v64
  v_mfma_f32_32x32x16_bf16 v[104:119], v[132:135], v[84:87], v[104:119]
  ds_read_b128 v[132:135], v4 offset:7168
  v_exp_f32 v65, v65
  v_exp_f32 v66, v66
  v_exp_f32 v67, v67
  v_cvt_pk_bf16_f32 v80, v64, v65
  v_mfma_f32_32x32x16_bf16 v[48:63], v[120:123], v[16:19], 0
  v_exp_f32 v68, v68
  v_exp_f32 v69, v69
  v_cvt_pk_bf16_f32 v81, v66, v67
  v_exp_f32 v70, v70
  v_exp_f32 v71, v71
  v_cvt_pk_bf16_f32 v82, v68, v69
  v_mfma_f32_32x32x16_bf16 v[48:63], v[124:127], v[20:23], v[48:63]
  ds_read_b128 v[120:123], v4 offset:12288
  ds_read_b128 v[124:127], v4 offset:13312
  v_exp_f32 v72, v72
  v_cvt_pk_bf16_f32 v83, v70, v71
  v_exp_f32 v73, v73
  v_exp_f32 v74, v74
  v_exp_f32 v75, v75
  v_mfma_f32_32x32x16_bf16 v[104:119], v[128:131], v[80:83], v[104:119]
  ds_read_b128 v[128:131], v4 offset:10240
  v_exp_f32 v76, v76
  v_exp_f32 v77, v77
  v_exp_f32 v78, v78
  v_exp_f32 v79, v79
  v_cvt_pk_bf16_f32 v84, v72, v73
  v_cvt_pk_bf16_f32 v85, v74, v75
  v_cvt_pk_bf16_f32 v86, v76, v77
  v_cvt_pk_bf16_f32 v87, v78, v79
  s_waitcnt vmcnt(4) lgkmcnt(0)
  s_barrier
  s_setprio 3
  v_exp_f32 v48, v48
  v_mfma_f32_32x32x16_bf16 v[104:119], v[132:135], v[84:87], v[104:119]
  ds_read_b128 v[132:135], v4 offset:11264
  v_exp_f32 v49, v49
  v_exp_f32 v50, v50
  v_exp_f32 v51, v51
  v_cvt_pk_bf16_f32 v80, v48, v49
  v_mfma_f32_32x32x16_bf16 v[64:79], v[120:123], v[16:19], 0
  v_exp_f32 v52, v52
  v_exp_f32 v53, v53
  v_cvt_pk_bf16_f32 v81, v50, v51
  v_exp_f32 v54, v54
  v_exp_f32 v55, v55
  v_cvt_pk_bf16_f32 v82, v52, v53
  v_mfma_f32_32x32x16_bf16 v[64:79], v[124:127], v[20:23], v[64:79]
  ds_read_b128 v[120:123], v5 offset:0
  ds_read_b128 v[124:127], v5 offset:1024
  v_exp_f32 v56, v56
  v_cvt_pk_bf16_f32 v83, v54, v55
  v_exp_f32 v57, v57
  v_exp_f32 v58, v58
  s_add_u32 s54, s55, 131072
  s_add_u32 m0, s55, 0
  s_nop 0
  buffer_load_dwordx4 v2, s[32:35], s54 offen offset:0 lds
  v_exp_f32 v59, v59
  v_mfma_f32_32x32x16_bf16 v[104:119], v[128:131], v[80:83], v[104:119]
  ds_read_b128 v[128:131], v4 offset:14336
  v_exp_f32 v60, v60
  v_exp_f32 v61, v61
  v_exp_f32 v62, v62
  v_exp_f32 v63, v63
  v_cvt_pk_bf16_f32 v84, v56, v57
  v_cvt_pk_bf16_f32 v85, v58, v59
  v_cvt_pk_bf16_f32 v86, v60, v61
  v_cvt_pk_bf16_f32 v87, v62, v63
  s_waitcnt lgkmcnt(0)
  s_setprio 2
  v_exp_f32 v64, v64
  v_mfma_f32_32x32x16_bf16 v[104:119], v[132:135], v[84:87], v[104:119]
  ds_read_b128 v[132:135], v4 offset:15360
  v_exp_f32 v65, v65
  v_exp_f32 v66, v66
  v_exp_f32 v67, v67
  v_cvt_pk_bf16_f32 v80, v64, v65
  v_mfma_f32_32x32x16_bf16 v[48:63], v[120:123], v[16:19], 0
  v_exp_f32 v68, v68
  v_exp_f32 v69, v69
  v_cvt_pk_bf16_f32 v81, v66, v67
  v_exp_f32 v70, v70
  v_exp_f32 v71, v71
  v_cvt_pk_bf16_f32 v82, v68, v69
  v_mfma_f32_32x32x16_bf16 v[48:63], v[124:127], v[20:23], v[48:63]
  ds_read_b128 v[120:123], v5 offset:4096
  ds_read_b128 v[124:127], v5 offset:5120
  v_exp_f32 v72, v72
  v_cvt_pk_bf16_f32 v83, v70, v71
  v_exp_f32 v73, v73
  v_exp_f32 v74, v74
  buffer_load_dwordx4 v2, s[32:35], s54 offen offset:1024 lds
  v_exp_f32 v75, v75
  v_mfma_f32_32x32x16_bf16 v[104:119], v[128:131], v[80:83], v[104:119]
  ds_read_b128 v[128:131], v5 offset:2048
  v_exp_f32 v76, v76
  v_exp_f32 v77, v77
  v_exp_f32 v78, v78
  v_exp_f32 v79, v79
  v_cvt_pk_bf16_f32 v84, v72, v73
  v_cvt_pk_bf16_f32 v85, v74, v75
  v_cvt_pk_bf16_f32 v86, v76, v77
  v_cvt_pk_bf16_f32 v87, v78, v79
  v_mov_b32 v4, v5
  v_add_u32 v5, 32768, v5
  v_and_b32 v5, 0x1ffff, v5
  s_waitcnt lgkmcnt(0)
  s_setprio 1
  v_exp_f32 v48, v48
  v_mfma_f32_32x32x16_bf16 v[104:119], v[132:135], v[84:87], v[104:119]
  ds_read_b128 v[132:135], v4 offset:3072
  v_exp_f32 v49, v49
  v_exp_f32 v50, v50
  v_exp_f32 v51, v51
  v_cvt_pk_bf16_f32 v80, v48, v49
  v_mfma_f32_32x32x16_bf16 v[64:79], v[120:123], v[16:19], 0
  v_exp_f32 v52, v52
  v_exp_f32 v53, v53
  v_cvt_pk_bf16_f32 v81, v50, v51
  v_exp_f32 v54, v54
  v_exp_f32 v55, v55
  v_cvt_pk_bf16_f32 v82, v52, v53
  v_mfma_f32_32x32x16_bf16 v[64:79], v[124:127], v[20:23], v[64:79]
  ds_read_b128 v[120:123], v4 offset:8192
  ds_read_b128 v[124:127], v4 offset:9216
  v_exp_f32 v56, v56
  v_cvt_pk_bf16_f32 v83, v54, v55
  v_exp_f32 v57, v57
  v_exp_f32 v58, v58
  buffer_load_dwordx4 v2, s[32:35], s54 offen offset:2048 lds
  v_exp_f32 v59, v59
  v_mfma_f32_32x32x16_bf16 v[104:119], v[128:131], v[80:83], v[104:119]
  ds_read_b128 v[128:131], v4 offset:6144
  v_exp_f32 v60, v60
  v_exp_f32 v61, v61
  v_exp_f32 v62, v62
  v_exp_f32 v63, v63
  v_cvt_pk_bf16_f32 v84, v56, v57
  v_cvt_pk_bf16_f32 v85, v58, v59
  v_cvt_pk_bf16_f32 v86, v60, v61
  v_cvt_pk_bf16_f32 v87, v62, v63
  s_waitcnt lgkmcnt(0)
  s_setprio 0
  v_exp_f32 v64, v64
  v_mfma_f32_32x32x16_bf16 v[104:119], v[132:135], v[84:87], v[104:119]
  ds_read_b128 v[132:135], v4 offset:7168
  v_exp_f32 v65, v65
  v_exp_f32 v66, v66
  v_exp_f32 v67, v67
  v_cvt_pk_bf16_f32 v80, v64, v65
  v_mfma_f32_32x32x16_bf16 v[48:63], v[120:123], v[16:19], 0
  v_exp_f32 v68, v68
  v_exp_f32 v69, v69
  v_cvt_pk_bf16_f32 v81, v66, v67
  v_exp_f32 v70, v70
  v_exp_f32 v71, v71
  v_cvt_pk_bf16_f32 v82, v68, v69
  v_mfma_f32_32x32x16_bf16 v[48:63], v[124:127], v[20:23], v[48:63]
  ds_read_b128 v[120:123], v4 offset:12288
  ds_read_b128 v[124:127], v4 offset:13312
  v_exp_f32 v72, v72
  v_cvt_pk_bf16_f32 v83, v70, v71
  v_exp_f32 v73, v73
  v_exp_f32 v74, v74
  buffer_load_dwordx4 v2, s[32:35], s54 offen offset:3072 lds
  v_exp_f32 v75, v75
  v_mfma_f32_32x32x16_bf16 v[104:119], v[128:131], v[80:83], v[104:119]
  ds_read_b128 v[128:131], v4 offset:10240
  v_exp_f32 v76, v76
  v_exp_f32 v77, v77
  v_exp_f32 v78, v78
  v_exp_f32 v79, v79
  v_cvt_pk_bf16_f32 v84, v72, v73
  v_cvt_pk_bf16_f32 v85, v74, v75
  v_cvt_pk_bf16_f32 v86, v76, v77
  v_cvt_pk_bf16_f32 v87, v78, v79
  s_waitcnt vmcnt(4) lgkmcnt(0)
  s_barrier
  s_cmp_lg_u32 s3, 4
  s_cbranch_scc1 LsigA_51
  s_mov_b64 exec, 1
  v_mov_b32 v1, 1
  s_lshl_b32 s47, s69, 8
  v_mov_b32 v202, s47
  buffer_atomic_add v1, v202, s[64:67], 0 offen sc1
  s_mov_b64 exec, -1
LsigA_51:
  s_setprio 3
  v_exp_f32 v48, v48
  v_mfma_f32_32x32x16_bf16 v[104:119], v[132:135], v[84:87], v[104:119]
  ds_read_b128 v[132:135], v4 offset:11264
  v_exp_f32 v49, v49
  v_exp_f32 v50, v50
  v_exp_f32 v51, v51
  v_cvt_pk_bf16_f32 v80, v48, v49
  v_mfma_f32_32x32x16_bf16 v[64:79], v[120:123], v[16:19], 0
  v_exp_f32 v52, v52
  v_exp_f32 v53, v53
  v_cvt_pk_bf16_f32 v81, v50, v51
  v_exp_f32 v54, v54
  v_exp_f32 v55, v55
  v_cvt_pk_bf16_f32 v82, v52, v53
  v_mfma_f32_32x32x16_bf16 v[64:79], v[124:127], v[20:23], v[64:79]
  ds_read_b128 v[120:123], v5 offset:0
  ds_read_b128 v[124:127], v5 offset:1024
  v_exp_f32 v56, v56
  v_cvt_pk_bf16_f32 v83, v54, v55
  v_exp_f32 v57, v57
  v_exp_f32 v58, v58
  s_add_u32 s54, s55, 163840
  s_add_u32 m0, s55, 32768
  s_nop 0
  buffer_load_dwordx4 v2, s[32:35], s54 offen offset:0 lds
  v_exp_f32 v59, v59
  v_mfma_f32_32x32x16_bf16 v[104:119], v[128:131], v[80:83], v[104:119]
  ds_read_b128 v[128:131], v4 offset:14336
  v_exp_f32 v60, v60
  v_exp_f32 v61, v61
  v_exp_f32 v62, v62
  v_exp_f32 v63, v63
  v_cvt_pk_bf16_f32 v84, v56, v57
  v_cvt_pk_bf16_f32 v85, v58, v59
  v_cvt_pk_bf16_f32 v86, v60, v61
  v_cvt_pk_bf16_f32 v87, v62, v63
  s_waitcnt lgkmcnt(0)
  s_setprio 2
  v_exp_f32 v64, v64
  v_mfma_f32_32x32x16_bf16 v[104:119], v[132:135], v[84:87], v[104:119]
  ds_read_b128 v[132:135], v4 offset:15360
  v_exp_f32 v65, v65
  v_exp_f32 v66, v66
  v_exp_f32 v67, v67
  v_cvt_pk_bf16_f32 v80, v64, v65
  v_mfma_f32_32x32x16_bf16 v[48:63], v[120:123], v[16:19], 0
  v_exp_f32 v68, v68
  v_exp_f32 v69, v69
  v_cvt_pk_bf16_f32 v81, v66, v67
  v_exp_f32 v70, v70
  v_exp_f32 v71, v71
  v_cvt_pk_bf16_f32 v82, v68, v69
  v_mfma_f32_32x32x16_bf16 v[48:63], v[124:127], v[20:23], v[48:63]
  ds_read_b128 v[120:123], v5 offset:4096
  ds_read_b128 v[124:127], v5 offset:5120
  v_exp_f32 v72, v72
  v_cvt_pk_bf16_f32 v83, v70, v71
  v_exp_f32 v73, v73
  v_exp_f32 v74, v74
  buffer_load_dwordx4 v2, s[32:35], s54 offen offset:1024 lds
  v_exp_f32 v75, v75
  v_mfma_f32_32x32x16_bf16 v[104:119], v[128:131], v[80:83], v[104:119]
  ds_read_b128 v[128:131], v5 offset:2048
  v_exp_f32 v76, v76
  v_exp_f32 v77, v77
  v_exp_f32 v78, v78
  v_exp_f32 v79, v79
  v_cvt_pk_bf16_f32 v84, v72, v73
  v_cvt_pk_bf16_f32 v85, v74, v75
  v_cvt_pk_bf16_f32 v86, v76, v77
  v_cvt_pk_bf16_f32 v87, v78, v79
  v_mov_b32 v4, v5
  v_add_u32 v5, 32768, v5
  v_and_b32 v5, 0x1ffff, v5
  s_waitcnt lgkmcnt(0)
  s_setprio 1
  v_exp_f32 v48, v48
  v_mfma_f32_32x32x16_bf16 v[104:119], v[132:135], v[84:87], v[104:119]
  ds_read_b128 v[132:135], v4 offset:3072
  v_exp_f32 v49, v49
  v_exp_f32 v50, v50
  v_exp_f32 v51, v51
  v_cvt_pk_bf16_f32 v80, v48, v49
  v_mfma_f32_32x32x16_bf16 v[64:79], v[120:123], v[16:19], 0
  v_exp_f32 v52, v52
  v_exp_f32 v53, v53
  v_cvt_pk_bf16_f32 v81, v50, v51
  v_exp_f32 v54, v54
  v_exp_f32 v55, v55
  v_cvt_pk_bf16_f32 v82, v52, v53
  v_mfma_f32_32x32x16_bf16 v[64:79], v[124:127], v[20:23], v[64:79]
  ds_read_b128 v[120:123], v4 offset:8192
  ds_read_b128 v[124:127], v4 offset:9216
  v_exp_f32 v56, v56
  v_cvt_pk_bf16_f32 v83, v54, v55
  v_exp_f32 v57, v57
  v_exp_f32 v58, v58
  s_cmp_gt_u32 s3, 5
  s_cbranch_scc1 Lwol2_52
  s_mov_b32 s56, s8
  s_mov_b32 s57, s9
  s_mov_b32 s58, 401408
  s_mov_b32 s59, 0x20000
  s_lshr_b32 s47, s2, 3
  s_mul_i32 s47, s47, 98
  s_sub_u32 s48, s3, 4
  s_lshl_b32 s48, s48, 6
  s_add_u32 s47, s47, s48
  v_add_u32 v204, s47, v0
  v_lshlrev_b32 v204, 7, v204
  buffer_load_dword v205, v204, s[56:59], 0 offen
Lwol2_52:
  buffer_load_dwordx4 v2, s[32:35], s54 offen offset:2048 lds
  v_exp_f32 v59, v59
  v_mfma_f32_32x32x16_bf16 v[104:119], v[128:131], v[80:83], v[104:119]
  ds_read_b128 v[128:131], v4 offset:6144
  v_exp_f32 v60, v60
  v_exp_f32 v61, v61
  v_exp_f32 v62, v62
  v_exp_f32 v63, v63
  v_cvt_pk_bf16_f32 v84, v56, v57
  v_cvt_pk_bf16_f32 v85, v58, v59
  v_cvt_pk_bf16_f32 v86, v60, v61
  v_cvt_pk_bf16_f32 v87, v62, v63
  s_waitcnt lgkmcnt(0)
  s_setprio 0
  v_exp_f32 v64, v64
  v_mfma_f32_32x32x16_bf16 v[104:119], v[132:135], v[84:87], v[104:119]
  ds_read_b128 v[132:135], v4 offset:7168
  v_exp_f32 v65, v65
  v_exp_f32 v66, v66
  v_exp_f32 v67, v67
  v_cvt_pk_bf16_f32 v80, v64, v65
  v_mfma_f32_32x32x16_bf16 v[48:63], v[120:123], v[16:19], 0
  v_exp_f32 v68, v68
  v_exp_f32 v69, v69
  v_cvt_pk_bf16_f32 v81, v66, v67
  v_exp_f32 v70, v70
  v_exp_f32 v71, v71
  v_cvt_pk_bf16_f32 v82, v68, v69
  v_mfma_f32_32x32x16_bf16 v[48:63], v[124:127], v[20:23], v[48:63]
  ds_read_b128 v[120:123], v4 offset:12288
  ds_read_b128 v[124:127], v4 offset:13312
  v_exp_f32 v72, v72
  v_cvt_pk_bf16_f32 v83, v70, v71
  v_exp_f32 v73, v73
  v_exp_f32 v74, v74
  buffer_load_dwordx4 v2, s[32:35], s54 offen offset:3072 lds
  v_exp_f32 v75, v75
  v_mfma_f32_32x32x16_bf16 v[104:119], v[128:131], v[80:83], v[104:119]
  ds_read_b128 v[128:131], v4 offset:10240
  v_exp_f32 v76, v76
  v_exp_f32 v77, v77
  v_exp_f32 v78, v78
  v_exp_f32 v79, v79
  v_cvt_pk_bf16_f32 v84, v72, v73
  v_cvt_pk_bf16_f32 v85, v74, v75
  v_cvt_pk_bf16_f32 v86, v76, v77
  v_cvt_pk_bf16_f32 v87, v78, v79
  s_waitcnt vmcnt(4) lgkmcnt(0)
  s_barrier
  s_setprio 3
  v_exp_f32 v48, v48
  v_mfma_f32_32x32x16_bf16 v[104:119], v[132:135], v[84:87], v[104:119]
  ds_read_b128 v[132:135], v4 offset:11264
  v_exp_f32 v49, v49
  v_exp_f32 v50, v50
  v_exp_f32 v51, v51
  v_cvt_pk_bf16_f32 v80, v48, v49
  v_mfma_f32_32x32x16_bf16 v[64:79], v[120:123], v[16:19], 0
  v_exp_f32 v52, v52
  v_exp_f32 v53, v53
  v_cvt_pk_bf16_f32 v81, v50, v51
  v_exp_f32 v54, v54
  v_exp_f32 v55, v55
  v_cvt_pk_bf16_f32 v82, v52, v53
  v_mfma_f32_32x32x16_bf16 v[64:79], v[124:127], v[20:23], v[64:79]
  ds_read_b128 v[120:123], v5 offset:0
  ds_read_b128 v[124:127], v5 offset:1024
  v_exp_f32 v56, v56
  v_cvt_pk_bf16_f32 v83, v54, v55
  v_exp_f32 v57, v57
  v_exp_f32 v58, v58
  s_add_u32 s54, s55, 196608
  s_add_u32 m0, s55, 65536
  s_nop 0
  buffer_load_dwordx4 v2, s[32:35], s54 offen offset:0 lds
  v_exp_f32 v59, v59
  v_mfma_f32_32x32x16_bf16 v[104:119], v[128:131], v[80:83], v[104:119]
  ds_read_b128 v[128:131], v4 offset:14336
  v_exp_f32 v60, v60
  v_exp_f32 v61, v61
  v_exp_f32 v62, v62
  v_exp_f32 v63, v63
  v_cvt_pk_bf16_f32 v84, v56, v57
  v_cvt_pk_bf16_f32 v85, v58, v59
  v_cvt_pk_bf16_f32 v86, v60, v61
  v_cvt_pk_bf16_f32 v87, v62, v63
  s_waitcnt lgkmcnt(0)
  s_setprio 2
  v_exp_f32 v64, v64
  v_mfma_f32_32x32x16_bf16 v[104:119], v[132:135], v[84:87], v[104:119]
  ds_read_b128 v[132:135], v4 offset:15360
  v_exp_f32 v65, v65
  v_exp_f32 v66, v66
  v_exp_f32 v67, v67
  v_cvt_pk_bf16_f32 v80, v64, v65
  v_mfma_f32_32x32x16_bf16 v[48:63], v[120:123], v[16:19], 0
  v_exp_f32 v68, v68
  v_exp_f32 v69, v69
  v_cvt_pk_bf16_f32 v81, v66, v67
  v_exp_f32 v70, v70
  v_exp_f32 v71, v71
  v_cvt_pk_bf16_f32 v82, v68, v69
  v_mfma_f32_32x32x16_bf16 v[48:63], v[124:127], v[20:23], v[48:63]
  ds_read_b128 v[120:123], v5 offset:4096
  ds_read_b128 v[124:127], v5 offset:5120
  v_exp_f32 v72, v72
  v_cvt_pk_bf16_f32 v83, v70, v71
  v_exp_f32 v73, v73
  v_exp_f32 v74, v74
  buffer_load_dwordx4 v2, s[32:35], s54 offen offset:1024 lds
  v_exp_f32 v75, v75
  v_mfma_f32_32x32x16_bf16 v[104:119], v[128:131], v[80:83], v[104:119]
  ds_read_b128 v[128:131], v5 offset:2048
  v_exp_f32 v76, v76
  v_exp_f32 v77, v77
  v_exp_f32 v78, v78
  v_exp_f32 v79, v79
  v_cvt_pk_bf16_f32 v84, v72, v73
  v_cvt_pk_bf16_f32 v85, v74, v75
  v_cvt_pk_bf16_f32 v86, v76, v77
  v_cvt_pk_bf16_f32 v87, v78, v79
  v_mov_b32 v4, v5
  v_add_u32 v5, 32768, v5
  v_and_b32 v5, 0x1ffff, v5
  s_waitcnt lgkmcnt(0)
  s_setprio 1
  v_exp_f32 v48, v48
  v_mfma_f32_32x32x16_bf16 v[104:119], v[132:135], v[84:87], v[104:119]
  ds_read_b128 v[132:135], v4 offset:3072
  v_exp_f32 v49, v49
  v_exp_f32 v50, v50
  v_exp_f32 v51, v51
  v_cvt_pk_bf16_f32 v80, v48, v49
  v_mfma_f32_32x32x16_bf16 v[64:79], v[120:123], v[16:19], 0
  v_exp_f32 v52, v52
  v_exp_f32 v53, v53
  v_cvt_pk_bf16_f32 v81, v50, v51
  v_exp_f32 v54, v54
  v_exp_f32 v55, v55
  v_cvt_pk_bf16_f32 v82, v52, v53
  v_mfma_f32_32x32x16_bf16 v[64:79], v[124:127], v[20:23], v[64:79]
  ds_read_b128 v[120:123], v4 offset:8192
  ds_read_b128 v[124:127], v4 offset:9216
  v_exp_f32 v56, v56
  v_cvt_pk_bf16_f32 v83, v54, v55
  v_exp_f32 v57, v57
  v_exp_f32 v58, v58
  buffer_load_dwordx4 v2, s[32:35], s54 offen offset:2048 lds
  v_exp_f32 v59, v59
  v_mfma_f32_32x32x16_bf16 v[104:119], v[128:131], v[80:83], v[104:119]
  ds_read_b128 v[128:131], v4 offset:6144
  v_exp_f32 v60, v60
  v_exp_f32 v61, v61
  v_exp_f32 v62, v62
  v_exp_f32 v63, v63
  v_cvt_pk_bf16_f32 v84, v56, v57
  v_cvt_pk_bf16_f32 v85, v58, v59
  v_cvt_pk_bf16_f32 v86, v60, v61
  v_cvt_pk_bf16_f32 v87, v62, v63
  s_waitcnt lgkmcnt(0)
  s_setprio 0
  v_exp_f32 v64, v64
  v_mfma_f32_32x32x16_bf16 v[104:119], v[132:135], v[84:87], v[104:119]
  ds_read_b128 v[132:135], v4 offset:7168
  v_exp_f32 v65, v65
  v_exp_f32 v66, v66
  v_exp_f32 v67, v67
  v_cvt_pk_bf16_f32 v80, v64, v65
  v_mfma_f32_32x32x16_bf16 v[48:63], v[120:123], v[16:19], 0
  v_exp_f32 v68, v68
  v_exp_f32 v69, v69
  v_cvt_pk_bf16_f32 v81, v66, v67
  v_exp_f32 v70, v70
  v_exp_f32 v71, v71
  v_cvt_pk_bf16_f32 v82, v68, v69
  v_mfma_f32_32x32x16_bf16 v[48:63], v[124:127], v[20:23], v[48:63]
  ds_read_b128 v[120:123], v4 offset:12288
  ds_read_b128 v[124:127], v4 offset:13312
  v_exp_f32 v72, v72
  v_cvt_pk_bf16_f32 v83, v70, v71
  v_exp_f32 v73, v73
  v_exp_f32 v74, v74
  buffer_load_dwordx4 v2, s[32:35], s54 offen offset:3072 lds
  v_exp_f32 v75, v75
  v_mfma_f32_32x32x16_bf16 v[104:119], v[128:131], v[80:83], v[104:119]
  ds_read_b128 v[128:131], v4 offset:10240
  v_exp_f32 v76, v76
  v_exp_f32 v77, v77
  v_exp_f32 v78, v78
  v_exp_f32 v79, v79
  v_cvt_pk_bf16_f32 v84, v72, v73
  v_cvt_pk_bf16_f32 v85, v74, v75
  v_cvt_pk_bf16_f32 v86, v76, v77
  v_cvt_pk_bf16_f32 v87, v78, v79
  s_waitcnt vmcnt(4) lgkmcnt(0)
  s_barrier
  s_setprio 3
  v_exp_f32 v48, v48
  v_mfma_f32_32x32x16_bf16 v[104:119], v[132:135], v[84:87], v[104:119]
  ds_read_b128 v[132:135], v4 offset:11264
  v_exp_f32 v49, v49
  v_exp_f32 v50, v50
  v_exp_f32 v51, v51
  v_cvt_pk_bf16_f32 v80, v48, v49
  v_mfma_f32_32x32x16_bf16 v[64:79], v[120:123], v[16:19], 0
  v_exp_f32 v52, v52
  v_exp_f32 v53, v53
  v_cvt_pk_bf16_f32 v81, v50, v51
  v_exp_f32 v54, v54
  v_exp_f32 v55, v55
  v_cvt_pk_bf16_f32 v82, v52, v53
  v_mfma_f32_32x32x16_bf16 v[64:79], v[124:127], v[20:23], v[64:79]
  ds_read_b128 v[120:123], v5 offset:0
  ds_read_b128 v[124:127], v5 offset:1024
  v_exp_f32 v56, v56
  v_cvt_pk_bf16_f32 v83, v54, v55
  v_exp_f32 v57, v57
  v_exp_f32 v58, v58
  buffer_load_dword v201, v31, s[64:67], 0 offen sc1
  s_add_u32 s54, s55, 229376
  s_add_u32 m0, s55, 98304
  s_nop 0
  buffer_load_dwordx4 v2, s[32:35], s54 offen offset:0 lds
  v_exp_f32 v59, v59
  v_mfma_f32_32x32x16_bf16 v[104:119], v[128:131], v[80:83], v[104:119]
  ds_read_b128 v[128:131], v4 offset:14336
  v_exp_f32 v60, v60
  v_exp_f32 v61, v61
  v_exp_f32 v62, v62
  v_exp_f32 v63, v63
  v_cvt_pk_bf16_f32 v84, v56, v57
  v_cvt_pk_bf16_f32 v85, v58, v59
  v_cvt_pk_bf16_f32 v86, v60, v61
  v_cvt_pk_bf16_f32 v87, v62, v63
  s_waitcnt lgkmcnt(0)
  s_setprio 2
  v_exp_f32 v64, v64
  v_mfma_f32_32x32x16_bf16 v[104:119], v[132:135], v[84:87], v[104:119]
  ds_read_b128 v[132:135], v4 offset:15360
  v_exp_f32 v65, v65
  v_exp_f32 v66, v66
  v_exp_f32 v67, v67
  v_cvt_pk_bf16_f32 v80, v64, v65
  v_mfma_f32_32x32x16_bf16 v[48:63], v[120:123], v[16:19], 0
  v_exp_f32 v68, v68
  v_exp_f32 v69, v69
  v_cvt_pk_bf16_f32 v81, v66, v67
  v_exp_f32 v70, v70
  v_exp_f32 v71, v71
  v_cvt_pk_bf16_f32 v82, v68, v69
  v_mfma_f32_32x32x16_bf16 v[48:63], v[124:127], v[20:23], v[48:63]
  ds_read_b128 v[120:123], v5 offset:4096
  ds_read_b128 v[124:127], v5 offset:5120
  v_exp_f32 v72, v72
  v_cvt_pk_bf16_f32 v83, v70, v71
  v_exp_f32 v73, v73
  v_exp_f32 v74, v74
  buffer_load_dwordx4 v2, s[32:35], s54 offen offset:1024 lds
  v_exp_f32 v75, v75
  v_mfma_f32_32x32x16_bf16 v[104:119], v[128:131], v[80:83], v[104:119]
  ds_read_b128 v[128:131], v5 offset:2048
  v_exp_f32 v76, v76
  v_exp_f32 v77, v77
  v_exp_f32 v78, v78
  v_exp_f32 v79, v79
  v_cvt_pk_bf16_f32 v84, v72, v73
  v_cvt_pk_bf16_f32 v85, v74, v75
  v_cvt_pk_bf16_f32 v86, v76, v77
  v_cvt_pk_bf16_f32 v87, v78, v79
  v_mov_b32 v4, v5
  v_add_u32 v5, 32768, v5
  v_and_b32 v5, 0x1ffff, v5
  s_waitcnt lgkmcnt(0)
  s_setprio 1
  v_exp_f32 v48, v48
  v_mfma_f32_32x32x16_bf16 v[104:119], v[132:135], v[84:87], v[104:119]
  ds_read_b128 v[132:135], v4 offset:3072
  v_exp_f32 v49, v49
  v_exp_f32 v50, v50
  v_exp_f32 v51, v51
  v_cvt_pk_bf16_f32 v80, v48, v49
  v_mfma_f32_32x32x16_bf16 v[64:79], v[120:123], v[16:19], 0
  v_exp_f32 v52, v52
  v_exp_f32 v53, v53
  v_cvt_pk_bf16_f32 v81, v50, v51
  v_exp_f32 v54, v54
  v_exp_f32 v55, v55
  v_cvt_pk_bf16_f32 v82, v52, v53
  v_mfma_f32_32x32x16_bf16 v[64:79], v[124:127], v[20:23], v[64:79]
  ds_read_b128 v[120:123], v4 offset:8192
  ds_read_b128 v[124:127], v4 offset:9216
  v_exp_f32 v56, v56
  v_cvt_pk_bf16_f32 v83, v54, v55
  v_exp_f32 v57, v57
  v_exp_f32 v58, v58
  buffer_load_dwordx4 v2, s[32:35], s54 offen offset:2048 lds
  v_exp_f32 v59, v59
  v_mfma_f32_32x32x16_bf16 v[104:119], v[128:131], v[80:83], v[104:119]
  ds_read_b128 v[128:131], v4 offset:6144
  v_exp_f32 v60, v60
  v_exp_f32 v61, v61
  v_exp_f32 v62, v62
  v_exp_f32 v63, v63
  v_cvt_pk_bf16_f32 v84, v56, v57
  v_cvt_pk_bf16_f32 v85, v58, v59
  v_cvt_pk_bf16_f32 v86, v60, v61
  v_cvt_pk_bf16_f32 v87, v62, v63
  s_waitcnt lgkmcnt(0)
  s_setprio 0
  v_exp_f32 v64, v64
  v_mfma_f32_32x32x16_bf16 v[104:119], v[132:135], v[84:87], v[104:119]
  ds_read_b128 v[132:135], v4 offset:7168
  v_exp_f32 v65, v65
  v_exp_f32 v66, v66
  v_exp_f32 v67, v67
  v_cvt_pk_bf16_f32 v80, v64, v65
  v_mfma_f32_32x32x16_bf16 v[48:63], v[120:123], v[16:19], 0
  v_exp_f32 v68, v68
  v_exp_f32 v69, v69
  v_cvt_pk_bf16_f32 v81, v66, v67
  v_exp_f32 v70, v70
  v_exp_f32 v71, v71
  v_cvt_pk_bf16_f32 v82, v68, v69
  v_mfma_f32_32x32x16_bf16 v[48:63], v[124:127], v[20:23], v[48:63]
  ds_read_b128 v[120:123], v4 offset:12288
  ds_read_b128 v[124:127], v4 offset:13312
  v_exp_f32 v72, v72
  v_cvt_pk_bf16_f32 v83, v70, v71
  v_exp_f32 v73, v73
  v_exp_f32 v74, v74
  buffer_load_dwordx4 v2, s[32:35], s54 offen offset:3072 lds
  v_exp_f32 v75, v75
  v_mfma_f32_32x32x16_bf16 v[104:119], v[128:131], v[80:83], v[104:119]
  ds_read_b128 v[128:131], v4 offset:10240
  v_exp_f32 v76, v76
  v_exp_f32 v77, v77
  v_exp_f32 v78, v78
  v_exp_f32 v79, v79
  v_cvt_pk_bf16_f32 v84, v72, v73
  v_cvt_pk_bf16_f32 v85, v74, v75
  v_cvt_pk_bf16_f32 v86, v76, v77
  v_cvt_pk_bf16_f32 v87, v78, v79
  s_waitcnt vmcnt(4) lgkmcnt(0)
  s_barrier
  s_setprio 3
  v_exp_f32 v48, v48
  v_mfma_f32_32x32x16_bf16 v[104:119], v[132:135], v[84:87], v[104:119]
  ds_read_b128 v[132:135], v4 offset:11264
  v_exp_f32 v49, v49
  v_exp_f32 v50, v50
  v_exp_f32 v51, v51
  v_cvt_pk_bf16_f32 v80, v48, v49
  v_mfma_f32_32x32x16_bf16 v[64:79], v[120:123], v[16:19], 0
  v_exp_f32 v52, v52
  v_exp_f32 v53, v53
  v_cvt_pk_bf16_f32 v81, v50, v51
  v_exp_f32 v54, v54
  v_exp_f32 v55, v55
  v_cvt_pk_bf16_f32 v82, v52, v53
  v_mfma_f32_32x32x16_bf16 v[64:79], v[124:127], v[20:23], v[64:79]
  ds_read_b128 v[120:123], v5 offset:0
  ds_read_b128 v[124:127], v5 offset:1024
  v_exp_f32 v56, v56
  v_cvt_pk_bf16_f32 v83, v54, v55
  v_exp_f32 v57, v57
  v_exp_f32 v58, v58
  v_cmp_ne_u32 vcc, 16, v201
  s_nop 4
  s_cbranch_vccz Laok_53
  s_mov_b32 s68, 200000
Lpoll_54:
  buffer_load_dword v201, v31, s[64:67], 0 offen sc1
  s_waitcnt vmcnt(0)
  v_cmp_ne_u32 vcc, 16, v201
  s_nop 4
  s_cbranch_vccz Lpdone_55
  s_sleep 1
  s_sub_u32 s68, s68, 1
  s_cmp_lg_u32 s68, 0
  s_cbranch_scc1 Lpoll_54
Lpdone_55:
Laok_53:
  s_add_u32 s47, s51, 8192
  s_mov_b32 m0, s47
  s_nop 0
  buffer_load_dwordx4 v2, s[24:27], s44 offen offset:0 lds
  buffer_load_dwordx4 v2, s[24:27], s44 offen offset:1024 lds
  s_mov_b32 m0, s55
  s_nop 0
  buffer_load_dwordx4 v28, s[28:31], 0 offen offset:0 lds
  v_exp_f32 v59, v59
  v_mfma_f32_32x32x16_bf16 v[104:119], v[128:131], v[80:83], v[104:119]
  ds_read_b128 v[128:131], v4 offset:14336
  v_exp_f32 v60, v60
  v_exp_f32 v61, v61
  v_exp_f32 v62, v62
  v_exp_f32 v63, v63
  v_cvt_pk_bf16_f32 v84, v56, v57
  v_cvt_pk_bf16_f32 v85, v58, v59
  v_cvt_pk_bf16_f32 v86, v60, v61
  v_cvt_pk_bf16_f32 v87, v62, v63
  s_waitcnt lgkmcnt(0)
  s_setprio 2
  v_exp_f32 v64, v64
  v_mfma_f32_32x32x16_bf16 v[104:119], v[132:135], v[84:87], v[104:119]
  ds_read_b128 v[132:135], v4 offset:15360
  v_exp_f32 v65, v65
  v_exp_f32 v66, v66
  v_exp_f32 v67, v67
  v_cvt_pk_bf16_f32 v80, v64, v65
  v_mfma_f32_32x32x16_bf16 v[48:63], v[120:123], v[16:19], 0
  v_exp_f32 v68, v68
  v_exp_f32 v69, v69
  v_cvt_pk_bf16_f32 v81, v66, v67
  v_exp_f32 v70, v70
  v_exp_f32 v71, v71
  v_cvt_pk_bf16_f32 v82, v68, v69
  v_mfma_f32_32x32x16_bf16 v[48:63], v[124:127], v[20:23], v[48:63]
  ds_read_b128 v[120:123], v5 offset:4096
  ds_read_b128 v[124:127], v5 offset:5120
  v_exp_f32 v72, v72
  v_cvt_pk_bf16_f32 v83, v70, v71
  v_exp_f32 v73, v73
  v_exp_f32 v74, v74
  buffer_load_dwordx4 v28, s[28:31], 0 offen offset:1024 lds
  v_exp_f32 v75, v75
  v_mfma_f32_32x32x16_bf16 v[104:119], v[128:131], v[80:83], v[104:119]
  ds_read_b128 v[128:131], v5 offset:2048
  v_exp_f32 v76, v76
  v_exp_f32 v77, v77
  v_exp_f32 v78, v78
  v_exp_f32 v79, v79
  v_cvt_pk_bf16_f32 v84, v72, v73
  v_cvt_pk_bf16_f32 v85, v74, v75
  v_cvt_pk_bf16_f32 v86, v76, v77
  v_cvt_pk_bf16_f32 v87, v78, v79
  v_mov_b32 v4, v5
  v_add_u32 v5, 32768, v5
  v_and_b32 v5, 0x1ffff, v5
  s_waitcnt lgkmcnt(0)
  s_setprio 1
  v_exp_f32 v48, v48
  v_mfma_f32_32x32x16_bf16 v[104:119], v[132:135], v[84:87], v[104:119]
  ds_read_b128 v[132:135], v4 offset:3072
  v_exp_f32 v49, v49
  v_exp_f32 v50, v50
  v_exp_f32 v51, v51
  v_cvt_pk_bf16_f32 v80, v48, v49
  v_mfma_f32_32x32x16_bf16 v[64:79], v[120:123], v[16:19], 0
  v_exp_f32 v52, v52
  v_exp_f32 v53, v53
  v_cvt_pk_bf16_f32 v81, v50, v51
  v_exp_f32 v54, v54
  v_exp_f32 v55, v55
  v_cvt_pk_bf16_f32 v82, v52, v53
  v_mfma_f32_32x32x16_bf16 v[64:79], v[124:127], v[20:23], v[64:79]
  ds_read_b128 v[120:123], v4 offset:8192
  ds_read_b128 v[124:127], v4 offset:9216
  v_exp_f32 v56, v56
  v_cvt_pk_bf16_f32 v83, v54, v55
  v_exp_f32 v57, v57
  v_exp_f32 v58, v58
  buffer_load_dwordx4 v28, s[28:31], 0 offen offset:2048 lds
  v_exp_f32 v59, v59
  v_mfma_f32_32x32x16_bf16 v[104:119], v[128:131], v[80:83], v[104:119]
  ds_read_b128 v[128:131], v4 offset:6144
  v_exp_f32 v60, v60
  v_exp_f32 v61, v61
  v_exp_f32 v62, v62
  v_exp_f32 v63, v63
  v_cvt_pk_bf16_f32 v84, v56, v57
  v_cvt_pk_bf16_f32 v85, v58, v59
  v_cvt_pk_bf16_f32 v86, v60, v61
  v_cvt_pk_bf16_f32 v87, v62, v63
  s_waitcnt lgkmcnt(0)
  s_setprio 0
  v_exp_f32 v64, v64
  v_mfma_f32_32x32x16_bf16 v[104:119], v[132:135], v[84:87], v[104:119]
  ds_read_b128 v[132:135], v4 offset:7168
  v_exp_f32 v65, v65
  v_exp_f32 v66, v66
  v_exp_f32 v67, v67
  v_cvt_pk_bf16_f32 v80, v64, v65
  v_mfma_f32_32x32x16_bf16 v[48:63], v[120:123], v[16:19], 0
  v_exp_f32 v68, v68
  v_exp_f32 v69, v69
  v_cvt_pk_bf16_f32 v81, v66, v67
  v_exp_f32 v70, v70
  v_exp_f32 v71, v71
  v_cvt_pk_bf16_f32 v82, v68, v69
  v_mfma_f32_32x32x16_bf16 v[48:63], v[124:127], v[20:23], v[48:63]
  ds_read_b128 v[120:123], v4 offset:12288
  ds_read_b128 v[124:127], v4 offset:13312
  v_exp_f32 v72, v72
  v_cvt_pk_bf16_f32 v83, v70, v71
  v_exp_f32 v73, v73
  v_exp_f32 v74, v74
  buffer_load_dwordx4 v28, s[28:31], 0 offen offset:3072 lds
  v_exp_f32 v75, v75
  v_mfma_f32_32x32x16_bf16 v[104:119], v[128:131], v[80:83], v[104:119]
  ds_read_b128 v[128:131], v4 offset:10240
  v_exp_f32 v76, v76
  v_exp_f32 v77, v77
  v_exp_f32 v78, v78
  v_exp_f32 v79, v79
  v_cvt_pk_bf16_f32 v84, v72, v73
  v_cvt_pk_bf16_f32 v85, v74, v75
  v_cvt_pk_bf16_f32 v86, v76, v77
  v_cvt_pk_bf16_f32 v87, v78, v79
  s_waitcnt vmcnt(4) lgkmcnt(0)
  s_barrier
  ds_read_b128 v[8:11], v200 offset:8192
  ds_read_b128 v[12:15], v200 offset:9216
  s_setprio 3
  v_exp_f32 v48, v48
  v_mfma_f32_32x32x16_bf16 v[104:119], v[132:135], v[84:87], v[104:119]
  ds_read_b128 v[132:135], v4 offset:11264
  v_exp_f32 v49, v49
  v_exp_f32 v50, v50
  v_exp_f32 v51, v51
  v_cvt_pk_bf16_f32 v80, v48, v49
  v_mfma_f32_32x32x16_bf16 v[64:79], v[120:123], v[16:19], 0
  v_exp_f32 v52, v52
  v_exp_f32 v53, v53
  v_cvt_pk_bf16_f32 v81, v50, v51
  v_exp_f32 v54, v54
  v_exp_f32 v55, v55
  v_cvt_pk_bf16_f32 v82, v52, v53
  v_mfma_f32_32x32x16_bf16 v[64:79], v[124:127], v[20:23], v[64:79]
  ds_read_b128 v[120:123], v5 offset:0
  ds_read_b128 v[124:127], v5 offset:1024
  v_exp_f32 v56, v56
  v_cvt_pk_bf16_f32 v83, v54, v55
  v_exp_f32 v57, v57
  v_exp_f32 v58, v58
  v_exp_f32 v59, v59
  v_mfma_f32_32x32x16_bf16 v[104:119], v[128:131], v[80:83], v[104:119]
  ds_read_b128 v[128:131], v4 offset:14336
  v_exp_f32 v60, v60
  v_exp_f32 v61, v61
  v_exp_f32 v62, v62
  v_exp_f32 v63, v63
  v_cvt_pk_bf16_f32 v84, v56, v57
  v_cvt_pk_bf16_f32 v85, v58, v59
  v_cvt_pk_bf16_f32 v86, v60, v61
  v_cvt_pk_bf16_f32 v87, v62, v63
  s_waitcnt lgkmcnt(0)
  s_setprio 2
  v_exp_f32 v64, v64
  v_mfma_f32_32x32x16_bf16 v[104:119], v[132:135], v[84:87], v[104:119]
  ds_read_b128 v[132:135], v4 offset:15360
  v_exp_f32 v65, v65
  v_exp_f32 v66, v66
  v_exp_f32 v67, v67
  v_cvt_pk_bf16_f32 v80, v64, v65
  v_mfma_f32_32x32x16_bf16 v[48:63], v[120:123], v[16:19], 0
  v_exp_f32 v68, v68
  v_exp_f32 v69, v69
  v_cvt_pk_bf16_f32 v81, v66, v67
  v_exp_f32 v70, v70
  v_exp_f32 v71, v71
  v_cvt_pk_bf16_f32 v82, v68, v69
  v_mfma_f32_32x32x16_bf16 v[48:63], v[124:127], v[20:23], v[48:63]
  ds_read_b128 v[120:123], v5 offset:4096
  ds_read_b128 v[124:127], v5 offset:5120
  v_exp_f32 v72, v72
  v_cvt_pk_bf16_f32 v83, v70, v71
  v_exp_f32 v73, v73
  v_exp_f32 v74, v74
  v_exp_f32 v75, v75
  v_mfma_f32_32x32x16_bf16 v[104:119], v[128:131], v[80:83], v[104:119]
  ds_read_b128 v[128:131], v5 offset:2048
  v_exp_f32 v76, v76
  v_exp_f32 v77, v77
  v_exp_f32 v78, v78
  v_exp_f32 v79, v79
  v_cvt_pk_bf16_f32 v84, v72, v73
  v_cvt_pk_bf16_f32 v85, v74, v75
  v_cvt_pk_bf16_f32 v86, v76, v77
  v_cvt_pk_bf16_f32 v87, v78, v79
  v_mov_b32 v4, v5
  v_add_u32 v5, 32768, v5
  v_and_b32 v5, 0x1ffff, v5
  s_waitcnt lgkmcnt(0)
  s_setprio 1
  v_exp_f32 v48, v48
  v_mfma_f32_32x32x16_bf16 v[104:119], v[132:135], v[84:87], v[104:119]
  ds_read_b128 v[132:135], v4 offset:3072
  v_exp_f32 v49, v49
  v_exp_f32 v50, v50
  v_exp_f32 v51, v51
  v_cvt_pk_bf16_f32 v80, v48, v49
  v_mfma_f32_32x32x16_bf16 v[64:79], v[120:123], v[16:19], 0
  v_exp_f32 v52, v52
  v_exp_f32 v53, v53
  v_cvt_pk_bf16_f32 v81, v50, v51
  v_exp_f32 v54, v54
  v_exp_f32 v55, v55
  v_cvt_pk_bf16_f32 v82, v52, v53
  v_mfma_f32_32x32x16_bf16 v[64:79], v[124:127], v[20:23], v[64:79]
  ds_read_b128 v[120:123], v4 offset:8192
  ds_read_b128 v[124:127], v4 offset:9216
  v_exp_f32 v56, v56
  v_cvt_pk_bf16_f32 v83, v54, v55
  v_exp_f32 v57, v57
  v_exp_f32 v58, v58
  v_exp_f32 v59, v59
  v_mfma_f32_32x32x16_bf16 v[104:119], v[128:131], v[80:83], v[104:119]
  ds_read_b128 v[128:131], v4 offset:6144
  v_exp_f32 v60, v60
  v_exp_f32 v61, v61
  v_exp_f32 v62, v62
  v_exp_f32 v63, v63
  v_cvt_pk_bf16_f32 v84, v56, v57
  v_cvt_pk_bf16_f32 v85, v58, v59
  v_cvt_pk_bf16_f32 v86, v60, v61
  v_cvt_pk_bf16_f32 v87, v62, v63
  s_waitcnt lgkmcnt(0)
  s_setprio 0
  v_exp_f32 v64, v64
  v_mfma_f32_32x32x16_bf16 v[104:119], v[132:135], v[84:87], v[104:119]
  ds_read_b128 v[132:135], v4 offset:7168
  v_exp_f32 v65, v65
  v_exp_f32 v66, v66
  v_exp_f32 v67, v67
  v_cvt_pk_bf16_f32 v80, v64, v65
  v_mfma_f32_32x32x16_bf16 v[48:63], v[120:123], v[16:19], 0
  v_exp_f32 v68, v68
  v_exp_f32 v69, v69
  v_cvt_pk_bf16_f32 v81, v66, v67
  v_exp_f32 v70, v70
  v_exp_f32 v71, v71
  v_cvt_pk_bf16_f32 v82, v68, v69
  v_mfma_f32_32x32x16_bf16 v[48:63], v[124:127], v[20:23], v[48:63]
  ds_read_b128 v[120:123], v4 offset:12288
  ds_read_b128 v[124:127], v4 offset:13312
  v_exp_f32 v72, v72
  v_cvt_pk_bf16_f32 v83, v70, v71
  v_exp_f32 v73, v73
  v_exp_f32 v74, v74
  v_exp_f32 v75, v75
  v_mfma_f32_32x32x16_bf16 v[104:119], v[128:131], v[80:83], v[104:119]
  ds_read_b128 v[128:131], v4 offset:10240
  v_exp_f32 v76, v76
  v_exp_f32 v77, v77
  v_exp_f32 v78, v78
  v_exp_f32 v79, v79
  v_cvt_pk_bf16_f32 v84, v72, v73
  v_cvt_pk_bf16_f32 v85, v74, v75
  v_cvt_pk_bf16_f32 v86, v76, v77
  v_cvt_pk_bf16_f32 v87, v78, v79
  s_waitcnt vmcnt(0) lgkmcnt(0)
  s_barrier
  s_setprio 3
  v_exp_f32 v48, v48
  v_mfma_f32_32x32x16_bf16 v[104:119], v[132:135], v[84:87], v[104:119]
  ds_read_b128 v[132:135], v4 offset:11264
  v_exp_f32 v49, v49
  v_exp_f32 v50, v50
  v_exp_f32 v51, v51
  v_cvt_pk_bf16_f32 v80, v48, v49
  v_mfma_f32_32x32x16_bf16 v[64:79], v[120:123], v[16:19], 0
  v_exp_f32 v52, v52
  v_exp_f32 v53, v53
  v_cvt_pk_bf16_f32 v81, v50, v51
  v_exp_f32 v54, v54
  v_exp_f32 v55, v55
  v_cvt_pk_bf16_f32 v82, v52, v53
  v_mfma_f32_32x32x16_bf16 v[64:79], v[124:127], v[20:23], v[64:79]
  ds_read_b128 v[120:123], v3 offset:12288
  ds_read_b128 v[124:127], v3 offset:13312
  v_exp_f32 v56, v56
  v_cvt_pk_bf16_f32 v83, v54, v55
  v_exp_f32 v57, v57
  v_exp_f32 v58, v58
  s_mov_b32 s56, s14
  s_mov_b32 s57, s15
  s_mov_b32 s58, 401408
  s_mov_b32 s59, 0x20000
  v_lshrrev_b32 v30, 3, v0
  v_and_b32 v31, 7, v0
  v_and_b32 v1, 2, v30
  v_lshlrev_b32 v1, 1, v1
  v_xor_b32 v31, v31, v1
  s_lshl_b32 s50, s3, 3
  v_add_u32 v30, s50, v30
  v_mul_u32_u24 v30, 896, v30
  v_lshl_add_u32 v30, v31, 4, v30
  s_lshr_b32 s50, s2, 5
  s_lshl_b32 s50, s50, 7
  s_cmp_ge_u32 s2, 224
  s_cselect_b32 s50, 0x40000000, s50
  v_add_u32 v30, s50, v30
  s_lshl_b32 s45, s3, 10
  s_add_u32 m0, s45, 65536
  s_mov_b32 s50, 0
  buffer_load_dwordx4 v30, s[56:59], s50 offen lds
  v_exp_f32 v59, v59
  v_mfma_f32_32x32x16_bf16 v[104:119], v[128:131], v[80:83], v[104:119]
  ds_read_b128 v[128:131], v4 offset:14336
  v_exp_f32 v60, v60
  v_exp_f32 v61, v61
  v_exp_f32 v62, v62
  v_exp_f32 v63, v63
  v_cvt_pk_bf16_f32 v84, v56, v57
  v_cvt_pk_bf16_f32 v85, v58, v59
  v_cvt_pk_bf16_f32 v86, v60, v61
  v_cvt_pk_bf16_f32 v87, v62, v63
  s_waitcnt lgkmcnt(0)
  v_mfma_f32_32x32x16_bf16 v[152:167], v[120:123], v[8:11], 0
  v_mfma_f32_32x32x16_bf16 v[152:167], v[124:127], v[12:15], v[152:167]
  s_nop 15
  v_max3_f32 v136, v152, v153, v154
  v_max3_f32 v136, v136, v155, v156
  v_max3_f32 v136, v136, v157, v158
  v_max3_f32 v136, v136, v159, v160
  v_max3_f32 v136, v136, v161, v162
  v_max3_f32 v136, v136, v163, v164
  v_max3_f32 v136, v136, v165, v166
  v_max_f32 v136, v136, v167
  v_mov_b32 v137, v136
  s_nop 1
  v_permlane32_swap_b32 v136, v137
  s_nop 1
  v_max_f32 v136, v136, v137
  v_sub_f32 v136, 0, v136
  v_cvt_pk_bf16_f32 v136, v136, 0
  v_lshlrev_b32 v26, 16, v136
  s_mov_b64 exec, s[60:61]
  v_mov_b32 v14, v136
  s_mov_b64 exec, -1
  s_lshl_b32 s47, s41, 2
  s_add_u32 s47, s47, s42
  s_cmp_lt_u32 s47, 5
  s_cbranch_scc0 LK1_valid
  v_mov_b32 v26, 0x7149f2ca
LK1_valid:
  s_setprio 2
  v_exp_f32 v64, v64
  v_mfma_f32_32x32x16_bf16 v[104:119], v[132:135], v[84:87], v[104:119]
  ds_read_b128 v[132:135], v4 offset:15360
  v_exp_f32 v65, v65
  v_exp_f32 v66, v66
  v_exp_f32 v67, v67
  v_cvt_pk_bf16_f32 v80, v64, v65
  v_mfma_f32_32x32x16_bf16 v[48:63], v[120:123], v[8:11], 0
  v_exp_f32 v68, v68
  v_exp_f32 v69, v69
  v_cvt_pk_bf16_f32 v81, v66, v67
  v_exp_f32 v70, v70
  v_exp_f32 v71, v71
  v_cvt_pk_bf16_f32 v82, v68, v69
  v_mfma_f32_32x32x16_bf16 v[48:63], v[124:127], v[12:15], v[48:63]
  ds_read_b128 v[120:123], v3 offset:8192
  ds_read_b128 v[124:127], v3 offset:9216
  v_exp_f32 v72, v72
  v_cvt_pk_bf16_f32 v83, v70, v71
  v_exp_f32 v73, v73
  v_exp_f32 v74, v74
  s_add_u32 m0, s45, 73728
  s_mov_b32 s50, 57344
  buffer_load_dwordx4 v30, s[56:59], s50 offen lds
  v_exp_f32 v75, v75
  v_mfma_f32_32x32x16_bf16 v[104:119], v[128:131], v[80:83], v[104:119]
  ds_read_b128 v[128:131], v3 offset:14336
  v_exp_f32 v76, v76
  v_exp_f32 v77, v77
  v_exp_f32 v78, v78
  v_exp_f32 v79, v79
  v_cvt_pk_bf16_f32 v84, v72, v73
  v_cvt_pk_bf16_f32 v85, v74, v75
  v_cvt_pk_bf16_f32 v86, v76, v77
  v_cvt_pk_bf16_f32 v87, v78, v79
  s_waitcnt lgkmcnt(0)
  s_setprio 1
  v_exp_f32 v48, v48
  v_mfma_f32_32x32x16_bf16 v[104:119], v[132:135], v[84:87], v[104:119]
  ds_read_b128 v[132:135], v3 offset:15360
  v_exp_f32 v49, v49
  v_exp_f32 v50, v50
  v_exp_f32 v51, v51
  v_cvt_pk_bf16_f32 v80, v48, v49
  v_mfma_f32_32x32x16_bf16 v[64:79], v[120:123], v[8:11], 0
  v_exp_f32 v52, v52
  v_exp_f32 v53, v53
  v_cvt_pk_bf16_f32 v81, v50, v51
  v_exp_f32 v54, v54
  v_exp_f32 v55, v55
  v_cvt_pk_bf16_f32 v82, v52, v53
  v_mfma_f32_32x32x16_bf16 v[64:79], v[124:127], v[12:15], v[64:79]
  ds_read_b128 v[120:123], v3 offset:4096
  ds_read_b128 v[124:127], v3 offset:5120
  v_exp_f32 v56, v56
  v_cvt_pk_bf16_f32 v83, v54, v55
  v_exp_f32 v57, v57
  v_exp_f32 v58, v58
  s_add_u32 m0, s45, 81920
  s_mov_b32 s50, 114688
  buffer_load_dwordx4 v30, s[56:59], s50 offen lds
  v_exp_f32 v59, v59
  v_mfma_f32_32x32x16_bf16 v[88:103], v[128:131], v[80:83], 0
  ds_read_b128 v[128:131], v3 offset:10240
  v_exp_f32 v60, v60
  v_exp_f32 v61, v61
  v_exp_f32 v62, v62
  v_exp_f32 v63, v63
  v_cvt_pk_bf16_f32 v84, v56, v57
  v_cvt_pk_bf16_f32 v85, v58, v59
  v_cvt_pk_bf16_f32 v86, v60, v61
  v_cvt_pk_bf16_f32 v87, v62, v63
  s_waitcnt lgkmcnt(0)
  s_setprio 0
  v_exp_f32 v64, v64
  v_mfma_f32_32x32x16_bf16 v[88:103], v[132:135], v[84:87], v[88:103]
  ds_read_b128 v[132:135], v3 offset:11264
  v_exp_f32 v65, v65
  v_exp_f32 v66, v66
  v_exp_f32 v67, v67
  v_cvt_pk_bf16_f32 v80, v64, v65
  ds_write_b128 v6, v[104:107] offset:0
  ds_write_b128 v6, v[108:111] offset:1024
  ds_write_b32 v7, v27 offset:1024
  ds_write_b32 v7, v116 offset:2048
  v_mfma_f32_32x32x16_bf16 v[48:63], v[120:123], v[8:11], 0
  v_exp_f32 v68, v68
  v_exp_f32 v69, v69
  v_cvt_pk_bf16_f32 v81, v66, v67
  v_exp_f32 v70, v70
  v_exp_f32 v71, v71
  v_cvt_pk_bf16_f32 v82, v68, v69
  v_mfma_f32_32x32x16_bf16 v[48:63], v[124:127], v[12:15], v[48:63]
  ds_read_b128 v[120:123], v3 offset:0
  ds_read_b128 v[124:127], v3 offset:1024
  v_exp_f32 v72, v72
  v_cvt_pk_bf16_f32 v83, v70, v71
  v_exp_f32 v73, v73
  v_exp_f32 v74, v74
  s_add_u32 m0, s45, 90112
  s_mov_b32 s50, 172032
  buffer_load_dwordx4 v30, s[56:59], s50 offen lds
  v_exp_f32 v75, v75
  v_mfma_f32_32x32x16_bf16 v[88:103], v[128:131], v[80:83], v[88:103]
  ds_read_b128 v[128:131], v3 offset:6144
  v_exp_f32 v76, v76
  v_exp_f32 v77, v77
  v_exp_f32 v78, v78
  v_exp_f32 v79, v79
  v_cvt_pk_bf16_f32 v84, v72, v73
  v_cvt_pk_bf16_f32 v85, v74, v75
  v_cvt_pk_bf16_f32 v86, v76, v77
  v_cvt_pk_bf16_f32 v87, v78, v79
  s_waitcnt lgkmcnt(0)
  s_barrier
  ds_read_b128 v[152:155], v6 offset:2048
  ds_read_b128 v[156:159], v6 offset:3072
  ds_read_b32 v136, v7 offset:0
  s_waitcnt lgkmcnt(0)
  v_min_f32 v137, v27, v136
  v_sub_f32 v138, v137, v27
  v_sub_f32 v139, v137, v136
  v_exp_f32 v138, v138
  v_exp_f32 v139, v139
  s_nop 0
  v_mul_f32 v136, v116, v138
  v_fmac_f32 v136, v156, v139
  v_mul_f32 v112, v112, v138
  v_mul_f32 v113, v113, v138
  v_mul_f32 v114, v114, v138
  v_mul_f32 v115, v115, v138
  v_mul_f32 v116, v116, v138
  v_mul_f32 v117, v117, v138
  v_mul_f32 v118, v118, v138
  v_mul_f32 v119, v119, v138
  v_mov_b32 v137, v136
  v_fmac_f32 v112, v152, v139
  v_fmac_f32 v113, v153, v139
  v_fmac_f32 v114, v154, v139
  v_fmac_f32 v115, v155, v139
  v_fmac_f32 v116, v156, v139
  v_fmac_f32 v117, v157, v139
  v_fmac_f32 v118, v158, v139
  v_fmac_f32 v119, v159, v139
  v_permlane32_swap_b32 v136, v137
  v_mul_f32 v140, 0, v112
  v_fmac_f32 v140, 0, v113
  v_fmac_f32 v140, 0, v114
  v_fmac_f32 v140, 0, v115
  v_fmac_f32 v140, 0, v116
  v_fmac_f32 v140, 0, v117
  v_fmac_f32 v140, 0, v118
  v_fmac_f32 v140, 0, v119
  v_add_f32 v140, v140, v137
  v_subrev_u32 v140, 0x2b800000, v140
  v_cmp_le_u32 vcc, 0x46000000, v140
  s_nop 4
  s_cbranch_vccz LFB1_ok
  v_mov_b32 v208, v16
  v_mov_b32 v209, v17
  v_mov_b32 v210, v18
  v_mov_b32 v211, v19
  v_mov_b32 v212, v20
  v_mov_b32 v213, v21
  v_mov_b32 v214, v22
  v_mov_b32 v215, v23
  s_mov_b64 exec, s[60:61]
  v_mov_b32 v214, 0
  s_mov_b64 exec, -1
  v_mov_b32 v104, 0
  v_mov_b32 v105, 0
  v_mov_b32 v106, 0
  v_mov_b32 v107, 0
  v_mov_b32 v108, 0
  v_mov_b32 v109, 0
  v_mov_b32 v110, 0
  v_mov_b32 v111, 0
  v_mov_b32 v112, 0
  v_mov_b32 v113, 0
  v_mov_b32 v114, 0
  v_mov_b32 v115, 0
  v_mov_b32 v116, 0
  v_mov_b32 v117, 0
  v_mov_b32 v118, 0
  v_mov_b32 v119, 0
  v_mov_b32 v216, v25
  s_mov_b32 s54, 63
LFB1_fb_loop:
  s_lshl_b32 s55, s54, 12
  buffer_load_dwordx4 v[184:187], v2, s[32:35], s55 offen offset:0
  buffer_load_dwordx4 v[192:195], v2, s[32:35], s55 offen offset:2048
  buffer_load_dwordx4 v[188:191], v2, s[32:35], s55 offen offset:1024
  buffer_load_dwordx4 v[196:199], v2, s[32:35], s55 offen offset:3072
  v_mov_b32 v168, 0
  v_mov_b32 v169, 0
  v_mov_b32 v170, 0
  v_mov_b32 v171, 0
  v_mov_b32 v172, 0
  v_mov_b32 v173, 0
  v_mov_b32 v174, 0
  v_mov_b32 v175, 0
  v_mov_b32 v176, 0
  v_mov_b32 v177, 0
  v_mov_b32 v178, 0
  v_mov_b32 v179, 0
  v_mov_b32 v180, 0
  v_mov_b32 v181, 0
  v_mov_b32 v182, 0
  v_mov_b32 v183, 0
  s_waitcnt vmcnt(0)
  s_nop 1
  v_mfma_f32_32x32x16_bf16 v[168:183], v[184:187], v[208:211], v[168:183]
  v_mfma_f32_32x32x16_bf16 v[168:183], v[188:191], v[212:215], v[168:183]
  s_nop 15
  v_max3_f32 v217, v168, v169, v170
  v_max3_f32 v217, v217, v171, v172
  v_max3_f32 v217, v217, v173, v174
  v_max3_f32 v217, v217, v175, v176
  v_max3_f32 v217, v217, v177, v178
  v_max3_f32 v217, v217, v179, v180
  v_max3_f32 v217, v217, v181, v182
  v_max_f32 v217, v217, v183
  v_mov_b32 v218, v217
  s_nop 1
  v_permlane32_swap_b32 v217, v218
  s_nop 1
  v_max_f32 v217, v217, v218
  v_max_f32 v217, v217, v216
  v_sub_f32 v218, v216, v217
  v_exp_f32 v218, v218
  v_mov_b32 v216, v217
  v_sub_f32 v168, v168, v216
  v_sub_f32 v169, v169, v216
  v_sub_f32 v170, v170, v216
  v_sub_f32 v171, v171, v216
  v_sub_f32 v172, v172, v216
  v_sub_f32 v173, v173, v216
  v_sub_f32 v174, v174, v216
  v_sub_f32 v175, v175, v216
  v_sub_f32 v176, v176, v216
  v_sub_f32 v177, v177, v216
  v_sub_f32 v178, v178, v216
  v_sub_f32 v179, v179, v216
  v_sub_f32 v180, v180, v216
  v_sub_f32 v181, v181, v216
  v_sub_f32 v182, v182, v216
  v_sub_f32 v183, v183, v216
  v_exp_f32 v168, v168
  v_exp_f32 v169, v169
  v_exp_f32 v170, v170
  v_exp_f32 v171, v171
  v_exp_f32 v172, v172
  v_exp_f32 v173, v173
  v_exp_f32 v174, v174
  v_exp_f32 v175, v175
  v_exp_f32 v176, v176
  v_exp_f32 v177, v177
  v_exp_f32 v178, v178
  v_exp_f32 v179, v179
  v_exp_f32 v180, v180
  v_exp_f32 v181, v181
  v_exp_f32 v182, v182
  v_exp_f32 v183, v183
  v_mul_f32 v104, v104, v218
  v_mul_f32 v105, v105, v218
  v_mul_f32 v106, v106, v218
  v_mul_f32 v107, v107, v218
  v_mul_f32 v108, v108, v218
  v_mul_f32 v109, v109, v218
  v_mul_f32 v110, v110, v218
  v_mul_f32 v111, v111, v218
  v_mul_f32 v112, v112, v218
  v_mul_f32 v113, v113, v218
  v_mul_f32 v114, v114, v218
  v_mul_f32 v115, v115, v218
  v_mul_f32 v116, v116, v218
  v_mul_f32 v117, v117, v218
  v_mul_f32 v118, v118, v218
  v_mul_f32 v119, v119, v218
  v_cvt_pk_bf16_f32 v200, v168, v169
  v_cvt_pk_bf16_f32 v201, v170, v171
  v_cvt_pk_bf16_f32 v202, v172, v173
  v_cvt_pk_bf16_f32 v203, v174, v175
  v_cvt_pk_bf16_f32 v204, v176, v177
  v_cvt_pk_bf16_f32 v205, v178, v179
  v_cvt_pk_bf16_f32 v206, v180, v181
  v_cvt_pk_bf16_f32 v207, v182, v183
  s_nop 1
  v_mfma_f32_32x32x16_bf16 v[104:119], v[192:195], v[200:203], v[104:119]
  v_mfma_f32_32x32x16_bf16 v[104:119], v[196:199], v[204:207], v[104:119]
  s_nop 15
  s_sub_u32 s54, s54, 1
  s_cmp_lt_i32 s54, 0
  s_cbranch_scc1 LFB1_fb_end
  s_branch LFB1_fb_loop
LFB1_fb_end:
  v_mov_b32 v136, v116
  v_mov_b32 v137, v116
  s_nop 1
  v_permlane32_swap_b32 v136, v137
  s_nop 1
LFB1_ok:
  v_rcp_f32 v137, v137
  s_lshl_b32 s47, s41, 2
  s_add_u32 s47, s47, s42
  v_mul_f32 v112, v112, v137
  v_mul_f32 v113, v113, v137
  v_mul_f32 v114, v114, v137
  v_mul_f32 v115, v115, v137
  v_mul_f32 v116, v116, v137
  v_mul_f32 v117, v117, v137
  v_mul_f32 v118, v118, v137
  v_mul_f32 v119, v119, v137
  s_add_u32 s47, s47, 64
  s_lshl_b32 s47, s47, 4
  s_add_u32 s47, s47, s40
  s_lshl_b32 s47, s47, 11
  v_cvt_pk_bf16_f32 v152, v112, v113
  v_cvt_pk_bf16_f32 v153, v114, v115
  v_cvt_pk_bf16_f32 v154, v116, v117
  v_cvt_pk_bf16_f32 v155, v118, v119
  v_cndmask_b32_e64 v154, v154, 0, s[60:61]
  v_cndmask_b32_e64 v155, v155, 0, s[60:61]
  s_nop 1
  buffer_store_dwordx4 v[152:155], v2, s[36:39], s47 offen offset:1024 sc1
  s_nop 1
  s_setprio 3
  v_exp_f32 v48, v48
  v_mfma_f32_32x32x16_bf16 v[88:103], v[132:135], v[84:87], v[88:103]
  ds_read_b128 v[132:135], v3 offset:7168
  v_exp_f32 v49, v49
  v_exp_f32 v50, v50
  v_exp_f32 v51, v51
  v_cvt_pk_bf16_f32 v80, v48, v49
  v_mfma_f32_32x32x16_bf16 v[64:79], v[120:123], v[8:11], v[32:47]
  v_exp_f32 v52, v52
  v_exp_f32 v53, v53
  v_cvt_pk_bf16_f32 v81, v50, v51
  v_exp_f32 v54, v54
  v_exp_f32 v55, v55
  v_cvt_pk_bf16_f32 v82, v52, v53
  v_mfma_f32_32x32x16_bf16 v[64:79], v[124:127], v[12:15], v[64:79]
  v_exp_f32 v56, v56
  v_cvt_pk_bf16_f32 v83, v54, v55
  v_exp_f32 v57, v57
  v_exp_f32 v58, v58
  s_add_u32 m0, s45, 98304
  s_mov_b32 s50, 229376
  buffer_load_dwordx4 v30, s[56:59], s50 offen lds
  s_add_u32 m0, s45, 106496
  s_mov_b32 s50, 286720
  buffer_load_dwordx4 v30, s[56:59], s50 offen lds
  v_exp_f32 v59, v59
  v_mfma_f32_32x32x16_bf16 v[88:103], v[128:131], v[80:83], v[88:103]
  ds_read_b128 v[128:131], v3 offset:2048
  v_exp_f32 v60, v60
  v_exp_f32 v61, v61
  v_exp_f32 v62, v62
  v_exp_f32 v63, v63
  v_cvt_pk_bf16_f32 v84, v56, v57
  v_cvt_pk_bf16_f32 v85, v58, v59
  v_cvt_pk_bf16_f32 v86, v60, v61
  v_cvt_pk_bf16_f32 v87, v62, v63
  s_waitcnt lgkmcnt(0)
  s_setprio 2
  v_exp_f32 v64, v64
  v_mfma_f32_32x32x16_bf16 v[88:103], v[132:135], v[84:87], v[88:103]
  ds_read_b128 v[132:135], v3 offset:3072
  v_exp_f32 v65, v65
  v_exp_f32 v66, v66
  v_exp_f32 v67, v67
  v_cvt_pk_bf16_f32 v80, v64, v65
  v_exp_f32 v68, v68
  v_exp_f32 v69, v69
  v_cvt_pk_bf16_f32 v81, v66, v67
  v_exp_f32 v70, v70
  v_exp_f32 v71, v71
  v_cvt_pk_bf16_f32 v82, v68, v69
  v_exp_f32 v72, v72
  v_cvt_pk_bf16_f32 v83, v70, v71
  v_exp_f32 v73, v73
  v_exp_f32 v74, v74
  s_add_u32 m0, s45, 114688
  s_mov_b32 s50, 344064
  buffer_load_dwordx4 v30, s[56:59], s50 offen lds
  s_cmp_lg_u32 s3, 0
  s_cbranch_scc1 Lwo7_56
  s_add_u32 m0, s45, 122880
  v_add_u32 v31, 401408, v30
  buffer_load_dwordx4 v31, s[56:59], 0 offen lds
Lwo7_56:
  v_exp_f32 v75, v75
  v_mfma_f32_32x32x16_bf16 v[88:103], v[128:131], v[80:83], v[88:103]
  v_exp_f32 v76, v76
  v_exp_f32 v77, v77
  v_exp_f32 v78, v78
  v_exp_f32 v79, v79
  v_cvt_pk_bf16_f32 v84, v72, v73
  v_cvt_pk_bf16_f32 v85, v74, v75
  v_cvt_pk_bf16_f32 v86, v76, v77
  v_cvt_pk_bf16_f32 v87, v78, v79
  s_waitcnt lgkmcnt(0)
  s_nop 1
  v_mfma_f32_32x32x16_bf16 v[88:103], v[132:135], v[84:87], v[88:103]
  s_nop 15
  ds_write_b128 v6, v[88:91] offset:2048
  ds_write_b128 v6, v[92:95] offset:3072
  ds_write_b32 v7, v26 offset:0
  ds_write_b32 v7, v100 offset:3072
  s_waitcnt vmcnt(3) lgkmcnt(0)
  s_barrier
  s_cmp_lg_u32 s3, 4
  s_cbranch_scc1 LsigO_57
  s_mov_b64 exec, 1
  v_mov_b32 v1, 1
  s_lshl_b32 s47, s41, 8
  s_add_u32 s47, s47, 12288
  v_mov_b32 v31, s47
  buffer_atomic_add v1, v31, s[64:67], 0 offen sc1
  s_mov_b64 exec, -1
LsigO_57:
  ds_read_b128 v[152:155], v6 offset:0
  ds_read_b128 v[156:159], v6 offset:1024
  ds_read_b32 v136, v7 offset:1024
  s_waitcnt lgkmcnt(0)
  v_min_f32 v137, v26, v136
  v_sub_f32 v138, v137, v26
  v_sub_f32 v139, v137, v136
  v_exp_f32 v138, v138
  v_exp_f32 v139, v139
  s_nop 0
  v_mul_f32 v136, v100, v138
  v_fmac_f32 v136, v156, v139
  v_mul_f32 v96, v96, v138
  v_mul_f32 v97, v97, v138
  v_mul_f32 v98, v98, v138
  v_mul_f32 v99, v99, v138
  v_mul_f32 v100, v100, v138
  v_mul_f32 v101, v101, v138
  v_mul_f32 v102, v102, v138
  v_mul_f32 v103, v103, v138
  v_mov_b32 v137, v136
  v_fmac_f32 v96, v152, v139
  v_fmac_f32 v97, v153, v139
  v_fmac_f32 v98, v154, v139
  v_fmac_f32 v99, v155, v139
  v_fmac_f32 v100, v156, v139
  v_fmac_f32 v101, v157, v139
  v_fmac_f32 v102, v158, v139
  v_fmac_f32 v103, v159, v139
  v_permlane32_swap_b32 v136, v137
  v_mul_f32 v140, 0, v96
  v_fmac_f32 v140, 0, v97
  v_fmac_f32 v140, 0, v98
  v_fmac_f32 v140, 0, v99
  v_fmac_f32 v140, 0, v100
  v_fmac_f32 v140, 0, v101
  v_fmac_f32 v140, 0, v102
  v_fmac_f32 v140, 0, v103
  v_add_f32 v140, v140, v137
  v_subrev_u32 v140, 0x2b800000, v140
  v_cmp_le_u32 vcc, 0x46000000, v140
  s_nop 4
  s_cbranch_vccz LFA1_ok
  v_mov_b32 v208, v8
  v_mov_b32 v209, v9
  v_mov_b32 v210, v10
  v_mov_b32 v211, v11
  v_mov_b32 v212, v12
  v_mov_b32 v213, v13
  v_mov_b32 v214, v14
  v_mov_b32 v215, v15
  s_mov_b64 exec, s[60:61]
  v_mov_b32 v214, 0
  s_mov_b64 exec, -1
  v_mov_b32 v88, 0
  v_mov_b32 v89, 0
  v_mov_b32 v90, 0
  v_mov_b32 v91, 0
  v_mov_b32 v92, 0
  v_mov_b32 v93, 0
  v_mov_b32 v94, 0
  v_mov_b32 v95, 0
  v_mov_b32 v96, 0
  v_mov_b32 v97, 0
  v_mov_b32 v98, 0
  v_mov_b32 v99, 0
  v_mov_b32 v100, 0
  v_mov_b32 v101, 0
  v_mov_b32 v102, 0
  v_mov_b32 v103, 0
  v_mov_b32 v216, v25
  s_lshl_b32 s52, s41, 2
  s_add_u32 s52, s52, s42
  s_sub_u32 s53, s52, 8
  s_mov_b32 s54, s52
LFA1_fb_loop:
  s_lshl_b32 s55, s54, 12
  buffer_load_dwordx4 v[184:187], v2, s[28:31], s55 offen offset:0
  buffer_load_dwordx4 v[192:195], v2, s[28:31], s55 offen offset:2048
  buffer_load_dwordx4 v[188:191], v2, s[28:31], s55 offen offset:1024
  buffer_load_dwordx4 v[196:199], v2, s[28:31], s55 offen offset:3072
  s_cmp_eq_u32 s54, s52
  s_cbranch_scc1 LFA1_fb_diag
  s_cmp_eq_u32 s54, s53
  s_cbranch_scc1 LFA1_fb_first
  v_mov_b32 v168, 0
  v_mov_b32 v169, 0
  v_mov_b32 v170, 0
  v_mov_b32 v171, 0
  v_mov_b32 v172, 0
  v_mov_b32 v173, 0
  v_mov_b32 v174, 0
  v_mov_b32 v175, 0
  v_mov_b32 v176, 0
  v_mov_b32 v177, 0
  v_mov_b32 v178, 0
  v_mov_b32 v179, 0
  v_mov_b32 v180, 0
  v_mov_b32 v181, 0
  v_mov_b32 v182, 0
  v_mov_b32 v183, 0
  s_branch LFA1_fb_go
LFA1_fb_diag:
  v_cmp_le_i32 vcc, 0, v24
  s_nop 1
  v_cndmask_b32_e64 v168, v25, 0, vcc
  v_cmp_le_i32 vcc, 1, v24
  s_nop 1
  v_cndmask_b32_e64 v169, v25, 0, vcc
  v_cmp_le_i32 vcc, 2, v24
  s_nop 1
  v_cndmask_b32_e64 v170, v25, 0, vcc
  v_cmp_le_i32 vcc, 3, v24
  s_nop 1
  v_cndmask_b32_e64 v171, v25, 0, vcc
  v_cmp_le_i32 vcc, 8, v24
  s_nop 1
  v_cndmask_b32_e64 v172, v25, 0, vcc
  v_cmp_le_i32 vcc, 9, v24
  s_nop 1
  v_cndmask_b32_e64 v173, v25, 0, vcc
  v_cmp_le_i32 vcc, 10, v24
  s_nop 1
  v_cndmask_b32_e64 v174, v25, 0, vcc
  v_cmp_le_i32 vcc, 11, v24
  s_nop 1
  v_cndmask_b32_e64 v175, v25, 0, vcc
  v_cmp_le_i32 vcc, 16, v24
  s_nop 1
  v_cndmask_b32_e64 v176, v25, 0, vcc
  v_cmp_le_i32 vcc, 17, v24
  s_nop 1
  v_cndmask_b32_e64 v177, v25, 0, vcc
  v_cmp_le_i32 vcc, 18, v24
  s_nop 1
  v_cndmask_b32_e64 v178, v25, 0, vcc
  v_cmp_le_i32 vcc, 19, v24
  s_nop 1
  v_cndmask_b32_e64 v179, v25, 0, vcc
  v_cmp_le_i32 vcc, 24, v24
  s_nop 1
  v_cndmask_b32_e64 v180, v25, 0, vcc
  v_cmp_le_i32 vcc, 25, v24
  s_nop 1
  v_cndmask_b32_e64 v181, v25, 0, vcc
  v_cmp_le_i32 vcc, 26, v24
  s_nop 1
  v_cndmask_b32_e64 v182, v25, 0, vcc
  v_cmp_le_i32 vcc, 27, v24
  s_nop 1
  v_cndmask_b32_e64 v183, v25, 0, vcc
  s_branch LFA1_fb_go
LFA1_fb_first:
  v_cmp_gt_i32 vcc, 0, v24
  s_nop 1
  v_cndmask_b32_e64 v168, v25, 0, vcc
  v_cmp_gt_i32 vcc, 1, v24
  s_nop 1
  v_cndmask_b32_e64 v169, v25, 0, vcc
  v_cmp_gt_i32 vcc, 2, v24
  s_nop 1
  v_cndmask_b32_e64 v170, v25, 0, vcc
  v_cmp_gt_i32 vcc, 3, v24
  s_nop 1
  v_cndmask_b32_e64 v171, v25, 0, vcc
  v_cmp_gt_i32 vcc, 8, v24
  s_nop 1
  v_cndmask_b32_e64 v172, v25, 0, vcc
  v_cmp_gt_i32 vcc, 9, v24
  s_nop 1
  v_cndmask_b32_e64 v173, v25, 0, vcc
  v_cmp_gt_i32 vcc, 10, v24
  s_nop 1
  v_cndmask_b32_e64 v174, v25, 0, vcc
  v_cmp_gt_i32 vcc, 11, v24
  s_nop 1
  v_cndmask_b32_e64 v175, v25, 0, vcc
  v_cmp_gt_i32 vcc, 16, v24
  s_nop 1
  v_cndmask_b32_e64 v176, v25, 0, vcc
  v_cmp_gt_i32 vcc, 17, v24
  s_nop 1
  v_cndmask_b32_e64 v177, v25, 0, vcc
  v_cmp_gt_i32 vcc, 18, v24
  s_nop 1
  v_cndmask_b32_e64 v178, v25, 0, vcc
  v_cmp_gt_i32 vcc, 19, v24
  s_nop 1
  v_cndmask_b32_e64 v179, v25, 0, vcc
  v_cmp_gt_i32 vcc, 24, v24
  s_nop 1
  v_cndmask_b32_e64 v180, v25, 0, vcc
  v_cmp_gt_i32 vcc, 25, v24
  s_nop 1
  v_cndmask_b32_e64 v181, v25, 0, vcc
  v_cmp_gt_i32 vcc, 26, v24
  s_nop 1
  v_cndmask_b32_e64 v182, v25, 0, vcc
  v_cmp_gt_i32 vcc, 27, v24
  s_nop 1
  v_cndmask_b32_e64 v183, v25, 0, vcc
LFA1_fb_go:
  s_waitcnt vmcnt(0)
  s_nop 1
  v_mfma_f32_32x32x16_bf16 v[168:183], v[184:187], v[208:211], v[168:183]
  v_mfma_f32_32x32x16_bf16 v[168:183], v[188:191], v[212:215], v[168:183]
  s_nop 15
  v_max3_f32 v217, v168, v169, v170
  v_max3_f32 v217, v217, v171, v172
  v_max3_f32 v217, v217, v173, v174
  v_max3_f32 v217, v217, v175, v176
  v_max3_f32 v217, v217, v177, v178
  v_max3_f32 v217, v217, v179, v180
  v_max3_f32 v217, v217, v181, v182
  v_max_f32 v217, v217, v183
  v_mov_b32 v218, v217
  s_nop 1
  v_permlane32_swap_b32 v217, v218
  s_nop 1
  v_max_f32 v217, v217, v218
  v_max_f32 v217, v217, v216
  v_sub_f32 v218, v216, v217
  v_exp_f32 v218, v218
  v_mov_b32 v216, v217
  v_sub_f32 v168, v168, v216
  v_sub_f32 v169, v169, v216
  v_sub_f32 v170, v170, v216
  v_sub_f32 v171, v171, v216
  v_sub_f32 v172, v172, v216
  v_sub_f32 v173, v173, v216
  v_sub_f32 v174, v174, v216
  v_sub_f32 v175, v175, v216
  v_sub_f32 v176, v176, v216
  v_sub_f32 v177, v177, v216
  v_sub_f32 v178, v178, v216
  v_sub_f32 v179, v179, v216
  v_sub_f32 v180, v180, v216
  v_sub_f32 v181, v181, v216
  v_sub_f32 v182, v182, v216
  v_sub_f32 v183, v183, v216
  v_exp_f32 v168, v168
  v_exp_f32 v169, v169
  v_exp_f32 v170, v170
  v_exp_f32 v171, v171
  v_exp_f32 v172, v172
  v_exp_f32 v173, v173
  v_exp_f32 v174, v174
  v_exp_f32 v175, v175
  v_exp_f32 v176, v176
  v_exp_f32 v177, v177
  v_exp_f32 v178, v178
  v_exp_f32 v179, v179
  v_exp_f32 v180, v180
  v_exp_f32 v181, v181
  v_exp_f32 v182, v182
  v_exp_f32 v183, v183
  v_mul_f32 v88, v88, v218
  v_mul_f32 v89, v89, v218
  v_mul_f32 v90, v90, v218
  v_mul_f32 v91, v91, v218
  v_mul_f32 v92, v92, v218
  v_mul_f32 v93, v93, v218
  v_mul_f32 v94, v94, v218
  v_mul_f32 v95, v95, v218
  v_mul_f32 v96, v96, v218
  v_mul_f32 v97, v97, v218
  v_mul_f32 v98, v98, v218
  v_mul_f32 v99, v99, v218
  v_mul_f32 v100, v100, v218
  v_mul_f32 v101, v101, v218
  v_mul_f32 v102, v102, v218
  v_mul_f32 v103, v103, v218
  v_cvt_pk_bf16_f32 v200, v168, v169
  v_cvt_pk_bf16_f32 v201, v170, v171
  v_cvt_pk_bf16_f32 v202, v172, v173
  v_cvt_pk_bf16_f32 v203, v174, v175
  v_cvt_pk_bf16_f32 v204, v176, v177
  v_cvt_pk_bf16_f32 v205, v178, v179
  v_cvt_pk_bf16_f32 v206, v180, v181
  v_cvt_pk_bf16_f32 v207, v182, v183
  s_nop 1
  v_mfma_f32_32x32x16_bf16 v[88:103], v[192:195], v[200:203], v[88:103]
  v_mfma_f32_32x32x16_bf16 v[88:103], v[196:199], v[204:207], v[88:103]
  s_nop 15
  s_sub_u32 s54, s54, 1
  s_cmp_lt_i32 s54, 0
  s_cbranch_scc1 LFA1_fb_end
  s_cmp_lt_i32 s54, s53
  s_cbranch_scc1 LFA1_fb_end
  s_branch LFA1_fb_loop
LFA1_fb_end:
  v_mov_b32 v136, v100
  v_mov_b32 v137, v100
  s_nop 1
  v_permlane32_swap_b32 v136, v137
  s_nop 1
LFA1_ok:
  v_rcp_f32 v137, v137
  s_lshl_b32 s47, s41, 2
  s_add_u32 s47, s47, s42
  v_mul_f32 v96, v96, v137
  v_mul_f32 v97, v97, v137
  v_mul_f32 v98, v98, v137
  v_mul_f32 v99, v99, v137
  v_mul_f32 v100, v100, v137
  v_mul_f32 v101, v101, v137
  v_mul_f32 v102, v102, v137
  v_mul_f32 v103, v103, v137
  s_add_u32 s47, s47, 0
  s_lshl_b32 s47, s47, 4
  s_add_u32 s47, s47, s40
  s_lshl_b32 s47, s47, 11
  v_cvt_pk_bf16_f32 v152, v96, v97
  v_cvt_pk_bf16_f32 v153, v98, v99
  v_cvt_pk_bf16_f32 v154, v100, v101
  v_cvt_pk_bf16_f32 v155, v102, v103
  v_cndmask_b32_e64 v154, v154, 0, s[60:61]
  v_cndmask_b32_e64 v155, v155, 0, s[60:61]
  s_nop 1
  buffer_store_dwordx4 v[152:155], v2, s[36:39], s47 offen offset:1024 sc1
  s_nop 1
  s_waitcnt vmcnt(0)
  s_mov_b64 exec, 1
  v_mov_b32 v1, 1
  s_lshl_b32 s47, s41, 8
  s_add_u32 s47, s47, 8192
  v_mov_b32 v31, s47
  buffer_atomic_add v1, v31, s[64:67], 0 offen sc1
  s_mov_b64 exec, -1
  s_mov_b32 s56, s8
  s_mov_b32 s57, s9
  s_mov_b32 s58, 401408
  s_mov_b32 s59, 0x20000
  v_lshrrev_b32 v30, 3, v0
  v_and_b32 v29, 7, v0
  v_and_b32 v1, 2, v30
  v_lshlrev_b32 v1, 1, v1
  v_xor_b32 v29, v29, v1
  s_lshl_b32 s51, s3, 3
  v_add_u32 v30, s51, v30
  v_mul_u32_u24 v30, 896, v30
  v_lshl_add_u32 v30, v29, 4, v30
  s_lshr_b32 s51, s2, 5
  s_lshl_b32 s51, s51, 7
  s_cmp_ge_u32 s2, 224
  s_cselect_b32 s51, 0x40000000, s51
  v_add_u32 v30, s51, v30
  s_lshl_b32 s52, s3, 10
  s_add_u32 m0, s52, 0
  s_mov_b32 s51, 0
  buffer_load_dwordx4 v30, s[56:59], s51 offen lds
  s_add_u32 m0, s52, 8192
  s_mov_b32 s51, 57344
  buffer_load_dwordx4 v30, s[56:59], s51 offen lds
  s_add_u32 m0, s52, 16384
  s_mov_b32 s51, 114688
  buffer_load_dwordx4 v30, s[56:59], s51 offen lds
  s_add_u32 m0, s52, 24576
  s_mov_b32 s51, 172032
  buffer_load_dwordx4 v30, s[56:59], s51 offen lds
  s_add_u32 m0, s52, 32768
  s_mov_b32 s51, 229376
  buffer_load_dwordx4 v30, s[56:59], s51 offen lds
  s_add_u32 m0, s52, 40960
  s_mov_b32 s51, 286720
  buffer_load_dwordx4 v30, s[56:59], s51 offen lds
  s_add_u32 m0, s52, 49152
  s_mov_b32 s51, 344064
  buffer_load_dwordx4 v30, s[56:59], s51 offen lds
  s_cmp_lg_u32 s3, 0
  s_cbranch_scc1 LwoA_58
  s_add_u32 m0, s52, 57344
  v_add_u32 v29, 401408, v30
  buffer_load_dwordx4 v29, s[56:59], 0 offen lds
LwoA_58:
  s_cmp_ge_u32 s2, 224
  s_cbranch_scc1 Lpj_idleB
  s_mov_b32 s40, 1
  s_and_b32 s41, s2, 7
  s_lshl_b32 s41, s41, 2
  s_bfe_u32 s42, s2, 0x20003
  s_add_u32 s41, s41, s42
  s_lshr_b32 s42, s2, 5
  s_and_b32 s43, s3, 1
  s_bfe_u32 s44, s3, 0x10001
  s_mov_b32 s24, s16
  s_mov_b32 s25, s17
  s_mov_b32 s26, 3670016
  s_mov_b32 s27, 0x20000
  s_lshl_b32 s45, s41, 1
  s_add_u32 s45, s45, s43
  s_add_u32 s45, s45, 64
  s_lshl_b32 s45, s45, 15
  s_lshl_b32 s46, s44, 14
  s_add_u32 s45, s45, s46
  v_bfe_u32 v4, v0, 2, 2
  v_and_b32 v5, 3, v0
  v_bfe_u32 v7, v0, 4, 1
  v_lshrrev_b32 v6, 5, v0
  v_lshlrev_b32 v7, 5, v7
  v_lshl_add_u32 v7, v5, 3, v7
  v_lshrrev_b32 v11, 4, v7
  v_and_b32 v8, 2, v4
  v_lshlrev_b32 v8, 1, v8
  v_xor_b32 v11, v11, v8
  v_and_b32 v7, 15, v7
  v_lshl_add_u32 v7, v11, 4, v7
  v_lshl_add_u32 v4, v6, 2, v4
  v_lshl_add_u32 v9, v4, 7, v7
  s_mul_i32 s46, s44, 28672
  s_add_u32 s46, s46, 65536
  v_add_u32 v9, s46, v9
  v_xor_b32 v10, 64, v9
  s_lshl_b32 s46, s43, 1
  s_add_u32 s46, s46, s44
  s_add_u32 s46, s46, 4
  s_lshl_b32 s46, s46, 12
  s_add_u32 s46, s46, 131072
  v_add_u32 v12, s46, v2
  v_xor_b32 v13, 4096, v12
  s_lshr_b32 s46, s41, 1
  s_lshl_b32 s46, s46, 8
  s_add_u32 s46, s46, 12288
  v_mov_b32 v30, s46
  s_waitcnt vmcnt(0)
  s_barrier
  v_mov_b32 v204, 65476
  s_cmp_lg_u32 s3, 4
  s_cbranch_scc1 Lfollow_59
  s_mov_b32 s68, 200000
Lpoll_62:
  buffer_load_dword v1, v30, s[64:67], 0 offen sc1
  s_waitcnt vmcnt(0)
  v_cmp_ne_u32 vcc, 16, v1
  s_nop 4
  s_cbranch_vccz Lpdone_63
  s_sleep 1
  s_sub_u32 s68, s68, 1
  s_cmp_lg_u32 s68, 0
  s_cbranch_scc1 Lpoll_62
Lpdone_63:
  v_mov_b32 v205, 1
  ds_write_b32 v204, v205
  s_waitcnt lgkmcnt(0)
  s_branch Lgdone_60
Lfollow_59:
  s_mov_b32 s68, 3200000
Llspin_61:
  ds_read_b32 v205, v204
  s_waitcnt lgkmcnt(0)
  v_readfirstlane_b32 s47, v205
  s_cmp_lg_u32 s47, 0
  s_cbranch_scc1 Lgdone_60
  s_sleep 1
  s_sub_u32 s68, s68, 1
  s_cmp_lg_u32 s68, 0
  s_cbranch_scc1 Llspin_61
Lgdone_60:
  buffer_load_dwordx4 v[64:67], v2, s[36:39], s45 offen offset:0
  buffer_load_dwordx4 v[68:71], v2, s[36:39], s45 offen offset:1024
  buffer_load_dwordx4 v[72:75], v2, s[36:39], s45 offen offset:2048
  buffer_load_dwordx4 v[76:79], v2, s[36:39], s45 offen offset:3072
  s_add_u32 s45, s45, 4096
  buffer_load_dwordx4 v[80:83], v2, s[36:39], s45 offen offset:0
  buffer_load_dwordx4 v[84:87], v2, s[36:39], s45 offen offset:1024
  buffer_load_dwordx4 v[88:91], v2, s[36:39], s45 offen offset:2048
  buffer_load_dwordx4 v[92:95], v2, s[36:39], s45 offen offset:3072
  s_add_u32 s45, s45, 4096
  buffer_load_dwordx4 v[96:99], v2, s[36:39], s45 offen offset:0
  buffer_load_dwordx4 v[100:103], v2, s[36:39], s45 offen offset:1024
  buffer_load_dwordx4 v[104:107], v2, s[36:39], s45 offen offset:2048
  buffer_load_dwordx4 v[108:111], v2, s[36:39], s45 offen offset:3072
  s_add_u32 s45, s45, 4096
  buffer_load_dwordx4 v[112:115], v2, s[36:39], s45 offen offset:0
  buffer_load_dwordx4 v[116:119], v2, s[36:39], s45 offen offset:1024
  buffer_load_dwordx4 v[120:123], v2, s[36:39], s45 offen offset:2048
  buffer_load_dwordx4 v[124:127], v2, s[36:39], s45 offen offset:3072
  s_branch Lproj_common
Lpj_idleB:
  s_barrier
  s_branch Lend
Lproj_common:
  ds_read_b64_tr_b16 v[48:49], v9 offset:0
  ds_read_b64_tr_b16 v[50:51], v9 offset:1024
  ds_read_b64_tr_b16 v[52:53], v10 offset:0
  ds_read_b64_tr_b16 v[54:55], v10 offset:1024
  ds_read_b64_tr_b16 v[56:57], v9 offset:2048
  ds_read_b64_tr_b16 v[58:59], v9 offset:3072
  ds_read_b64_tr_b16 v[60:61], v10 offset:2048
  ds_read_b64_tr_b16 v[62:63], v10 offset:3072
  s_waitcnt vmcnt(15) lgkmcnt(4)
  v_mfma_f32_32x32x16_bf16 v[16:31], v[48:51], v[64:67], 0
  v_mfma_f32_32x32x16_bf16 v[32:47], v[52:55], v[64:67], 0
  ds_read_b64_tr_b16 v[48:49], v9 offset:3584
  ds_read_b64_tr_b16 v[50:51], v9 offset:4608
  ds_read_b64_tr_b16 v[52:53], v10 offset:3584
  ds_read_b64_tr_b16 v[54:55], v10 offset:4608
  s_waitcnt vmcnt(14) lgkmcnt(4)
  v_mfma_f32_32x32x16_bf16 v[16:31], v[56:59], v[68:71], v[16:31]
  v_mfma_f32_32x32x16_bf16 v[32:47], v[60:63], v[68:71], v[32:47]
  ds_read_b64_tr_b16 v[56:57], v9 offset:5632
  ds_read_b64_tr_b16 v[58:59], v9 offset:6656
  ds_read_b64_tr_b16 v[60:61], v10 offset:5632
  ds_read_b64_tr_b16 v[62:63], v10 offset:6656
  s_waitcnt vmcnt(13) lgkmcnt(4)
  v_mfma_f32_32x32x16_bf16 v[16:31], v[48:51], v[72:75], v[16:31]
  v_mfma_f32_32x32x16_bf16 v[32:47], v[52:55], v[72:75], v[32:47]
  ds_read_b64_tr_b16 v[48:49], v9 offset:7168
  ds_read_b64_tr_b16 v[50:51], v9 offset:8192
  ds_read_b64_tr_b16 v[52:53], v10 offset:7168
  ds_read_b64_tr_b16 v[54:55], v10 offset:8192
  s_waitcnt vmcnt(12) lgkmcnt(4)
  v_mfma_f32_32x32x16_bf16 v[16:31], v[56:59], v[76:79], v[16:31]
  v_mfma_f32_32x32x16_bf16 v[32:47], v[60:63], v[76:79], v[32:47]
  ds_read_b64_tr_b16 v[56:57], v9 offset:9216
  ds_read_b64_tr_b16 v[58:59], v9 offset:10240
  ds_read_b64_tr_b16 v[60:61], v10 offset:9216
  ds_read_b64_tr_b16 v[62:63], v10 offset:10240
  s_waitcnt vmcnt(11) lgkmcnt(4)
  v_mfma_f32_32x32x16_bf16 v[16:31], v[48:51], v[80:83], v[16:31]
  v_mfma_f32_32x32x16_bf16 v[32:47], v[52:55], v[80:83], v[32:47]
  ds_read_b64_tr_b16 v[48:49], v9 offset:10752
  ds_read_b64_tr_b16 v[50:51], v9 offset:11776
  ds_read_b64_tr_b16 v[52:53], v10 offset:10752
  ds_read_b64_tr_b16 v[54:55], v10 offset:11776
  s_waitcnt vmcnt(10) lgkmcnt(4)
  v_mfma_f32_32x32x16_bf16 v[16:31], v[56:59], v[84:87], v[16:31]
  v_mfma_f32_32x32x16_bf16 v[32:47], v[60:63], v[84:87], v[32:47]
  ds_read_b64_tr_b16 v[56:57], v9 offset:12800
  ds_read_b64_tr_b16 v[58:59], v9 offset:13824
  ds_read_b64_tr_b16 v[60:61], v10 offset:12800
  ds_read_b64_tr_b16 v[62:63], v10 offset:13824
  s_waitcnt vmcnt(9) lgkmcnt(4)
  v_mfma_f32_32x32x16_bf16 v[16:31], v[48:51], v[88:91], v[16:31]
  v_mfma_f32_32x32x16_bf16 v[32:47], v[52:55], v[88:91], v[32:47]
  ds_read_b64_tr_b16 v[48:49], v9 offset:14336
  ds_read_b64_tr_b16 v[50:51], v9 offset:15360
  ds_read_b64_tr_b16 v[52:53], v10 offset:14336
  ds_read_b64_tr_b16 v[54:55], v10 offset:15360
  s_waitcnt vmcnt(8) lgkmcnt(4)
  v_mfma_f32_32x32x16_bf16 v[16:31], v[56:59], v[92:95], v[16:31]
  v_mfma_f32_32x32x16_bf16 v[32:47], v[60:63], v[92:95], v[32:47]
  ds_read_b64_tr_b16 v[56:57], v9 offset:16384
  ds_read_b64_tr_b16 v[58:59], v9 offset:17408
  ds_read_b64_tr_b16 v[60:61], v10 offset:16384
  ds_read_b64_tr_b16 v[62:63], v10 offset:17408
  s_waitcnt vmcnt(7) lgkmcnt(4)
  v_mfma_f32_32x32x16_bf16 v[16:31], v[48:51], v[96:99], v[16:31]
  v_mfma_f32_32x32x16_bf16 v[32:47], v[52:55], v[96:99], v[32:47]
  ds_read_b64_tr_b16 v[48:49], v9 offset:17920
  ds_read_b64_tr_b16 v[50:51], v9 offset:18944
  ds_read_b64_tr_b16 v[52:53], v10 offset:17920
  ds_read_b64_tr_b16 v[54:55], v10 offset:18944
  s_waitcnt vmcnt(6) lgkmcnt(4)
  v_mfma_f32_32x32x16_bf16 v[16:31], v[56:59], v[100:103], v[16:31]
  v_mfma_f32_32x32x16_bf16 v[32:47], v[60:63], v[100:103], v[32:47]
  ds_read_b64_tr_b16 v[56:57], v9 offset:19968
  ds_read_b64_tr_b16 v[58:59], v9 offset:20992
  ds_read_b64_tr_b16 v[60:61], v10 offset:19968
  ds_read_b64_tr_b16 v[62:63], v10 offset:20992
  s_waitcnt vmcnt(5) lgkmcnt(4)
  v_mfma_f32_32x32x16_bf16 v[16:31], v[48:51], v[104:107], v[16:31]
  v_mfma_f32_32x32x16_bf16 v[32:47], v[52:55], v[104:107], v[32:47]
  ds_read_b64_tr_b16 v[48:49], v9 offset:21504
  ds_read_b64_tr_b16 v[50:51], v9 offset:22528
  ds_read_b64_tr_b16 v[52:53], v10 offset:21504
  ds_read_b64_tr_b16 v[54:55], v10 offset:22528
  s_waitcnt vmcnt(4) lgkmcnt(4)
  v_mfma_f32_32x32x16_bf16 v[16:31], v[56:59], v[108:111], v[16:31]
  v_mfma_f32_32x32x16_bf16 v[32:47], v[60:63], v[108:111], v[32:47]
  ds_read_b64_tr_b16 v[56:57], v9 offset:23552
  ds_read_b64_tr_b16 v[58:59], v9 offset:24576
  ds_read_b64_tr_b16 v[60:61], v10 offset:23552
  ds_read_b64_tr_b16 v[62:63], v10 offset:24576
  s_waitcnt vmcnt(3) lgkmcnt(4)
  v_mfma_f32_32x32x16_bf16 v[16:31], v[48:51], v[112:115], v[16:31]
  v_mfma_f32_32x32x16_bf16 v[32:47], v[52:55], v[112:115], v[32:47]
  ds_read_b64_tr_b16 v[48:49], v9 offset:25088
  ds_read_b64_tr_b16 v[50:51], v9 offset:26112
  ds_read_b64_tr_b16 v[52:53], v10 offset:25088
  ds_read_b64_tr_b16 v[54:55], v10 offset:26112
  s_waitcnt vmcnt(2) lgkmcnt(4)
  v_mfma_f32_32x32x16_bf16 v[16:31], v[56:59], v[116:119], v[16:31]
  v_mfma_f32_32x32x16_bf16 v[32:47], v[60:63], v[116:119], v[32:47]
  ds_read_b64_tr_b16 v[56:57], v9 offset:27136
  ds_read_b64_tr_b16 v[58:59], v9 offset:28160
  ds_read_b64_tr_b16 v[60:61], v10 offset:27136
  ds_read_b64_tr_b16 v[62:63], v10 offset:28160
  s_waitcnt vmcnt(1) lgkmcnt(4)
  v_mfma_f32_32x32x16_bf16 v[16:31], v[48:51], v[120:123], v[16:31]
  v_mfma_f32_32x32x16_bf16 v[32:47], v[52:55], v[120:123], v[32:47]
  s_waitcnt vmcnt(0) lgkmcnt(0)
  v_mfma_f32_32x32x16_bf16 v[16:31], v[56:59], v[124:127], v[16:31]
  v_mfma_f32_32x32x16_bf16 v[32:47], v[60:63], v[124:127], v[32:47]
  s_nop 15
  s_cmp_eq_u32 s44, 0
  s_cbranch_scc0 Lpj_k1
  ds_write_b128 v12, v[32:35] offset:0
  ds_write_b128 v12, v[36:39] offset:1024
  ds_write_b128 v12, v[40:43] offset:2048
  ds_write_b128 v12, v[44:47] offset:3072
  s_branch Lpj_k2
Lpj_k1:
  ds_write_b128 v12, v[16:19] offset:0
  ds_write_b128 v12, v[20:23] offset:1024
  ds_write_b128 v12, v[24:27] offset:2048
  ds_write_b128 v12, v[28:31] offset:3072
  v_mov_b32 v16, v32
  v_mov_b32 v17, v33
  v_mov_b32 v18, v34
  v_mov_b32 v19, v35
  v_mov_b32 v20, v36
  v_mov_b32 v21, v37
  v_mov_b32 v22, v38
  v_mov_b32 v23, v39
  v_mov_b32 v24, v40
  v_mov_b32 v25, v41
  v_mov_b32 v26, v42
  v_mov_b32 v27, v43
  v_mov_b32 v28, v44
  v_mov_b32 v29, v45
  v_mov_b32 v30, v46
  v_mov_b32 v31, v47
Lpj_k2:
  s_waitcnt lgkmcnt(0)
  s_barrier
  ds_read_b128 v[64:67], v13 offset:0
  ds_read_b128 v[68:71], v13 offset:1024
  ds_read_b128 v[72:75], v13 offset:2048
  ds_read_b128 v[76:79], v13 offset:3072
  v_and_b32 v4, 31, v0
  s_lshl_b32 s46, s41, 6
  s_lshl_b32 s47, s43, 5
  s_add_u32 s46, s46, s47
  v_add_u32 v4, s46, v4
  v_mul_u32_u24 v4, 1792, v4
  v_lshl_add_u32 v4, v6, 4, v4
  s_mul_i32 s46, s40, 896
  s_lshl_b32 s47, s42, 7
  s_add_u32 s46, s46, s47
  s_lshl_b32 s47, s44, 6
  s_add_u32 s46, s46, s47
  s_waitcnt lgkmcnt(0)
  v_add_f32 v16, v16, v64
  v_add_f32 v17, v17, v65
  v_add_f32 v18, v18, v66
  v_add_f32 v19, v19, v67
  v_add_f32 v20, v20, v68
  v_add_f32 v21, v21, v69
  v_add_f32 v22, v22, v70
  v_add_f32 v23, v23, v71
  v_add_f32 v24, v24, v72
  v_add_f32 v25, v25, v73
  v_add_f32 v26, v26, v74
  v_add_f32 v27, v27, v75
  v_add_f32 v28, v28, v76
  v_add_f32 v29, v29, v77
  v_add_f32 v30, v30, v78
  v_add_f32 v31, v31, v79
  v_cvt_pk_bf16_f32 v48, v16, v17
  v_cvt_pk_bf16_f32 v49, v18, v19
  v_cvt_pk_bf16_f32 v50, v20, v21
  v_cvt_pk_bf16_f32 v51, v22, v23
  v_cvt_pk_bf16_f32 v52, v24, v25
  v_cvt_pk_bf16_f32 v53, v26, v27
  v_cvt_pk_bf16_f32 v54, v28, v29
  v_cvt_pk_bf16_f32 v55, v30, v31
  s_nop 1
  v_permlane32_swap_b32 v48, v50
  v_permlane32_swap_b32 v49, v51
  v_permlane32_swap_b32 v52, v54
  v_permlane32_swap_b32 v53, v55
  s_nop 1
  buffer_store_dwordx4 v[48:51], v4, s[24:27], s46 offen offset:0
  buffer_store_dwordx4 v[52:55], v4, s[24:27], s46 offen offset:32
Lend:
Lexit:
  s_endpgm
.section .rodata,"a"
.p2align 6
.amdhsa_kernel concat_heads__sliding_block__softmax_full_mha__prompt_kernel
  .amdhsa_next_free_vgpr 232
  .amdhsa_next_free_sgpr 102
  .amdhsa_accum_offset 232
  .amdhsa_group_segment_fixed_size 0
  .amdhsa_kernarg_size 72
  .amdhsa_user_sgpr_count 2
  .amdhsa_user_sgpr_kernarg_segment_ptr 1
  .amdhsa_system_sgpr_workgroup_id_x 1
.end_amdhsa_kernel
```
